```python
import torch

def _softmax(x, axis=-1):
    return torch.softmax(x, dim=axis)

def _gelu(x):
    return torch.nn.functional.gelu(x, approximate='tanh')

def _silu(x):
    return torch.nn.functional.silu(x)

def _sigmoid(x):
    return torch.sigmoid(x)

def _layernorm(x, axis=-1, eps=1e-05):
    m = x.mean(dim=axis, keepdim=True)
    v = x.var(dim=axis, keepdim=True, unbiased=False)
    return (x - m) / torch.sqrt(v + eps)

def _scatter_add(tgt, idx, src, axis=0):
    return tgt.clone().index_add_(axis, idx, src)

def _segment_sum(src, seg, n):
    out = torch.zeros((n,) + src.shape[1:], dtype=src.dtype)
    return out.index_add_(0, seg, src)

def _pad(x, pw):
    flat = tuple((v for pair in reversed(pw) for v in pair))
    return torch.nn.functional.pad(x, flat)
kernel_name = 'gated_mix__linear_kernel_hedgehog__memory_aug_recurrent_mem_tr__prompt'

def setup_inputs():

    _w = lambda a: (lambda t: t.to(torch.bfloat16) if t.is_floating_point() else t)(torch.as_tensor(a))

    def _A_setup():
        B, S, D, H = (1, 2048, 448, 16)
        Dh = D // H
        return {'x': _w((lambda *s: torch.randn(*s, dtype=torch.bfloat16) * 0.05)(B, S, D)), 'wqkv': _w((lambda *s: torch.randn(*s, dtype=torch.bfloat16) * 1.6)(D, 3 * D)), 'w_phi': _w((lambda *s: torch.randn(*s, dtype=torch.bfloat16) * 1.6)(H, Dh, Dh) * Dh ** (-0.5)), 'wo': _w((lambda *s: torch.randn(*s, dtype=torch.bfloat16) * 0.05)(D, D))}
    _A_in = _A_setup()

    def _B_setup():
        B, S, Dm = (1, 2048, 448)
        H, Dh = (16, 256)
        M, seg = (8, 32)
        seg = min(seg, S)
        S = S // seg * seg
        return {'x': _w((lambda *s: torch.randn(*s, dtype=torch.bfloat16) * 0.05)(B, S, Dm)), 'mem0': _w((lambda *s: torch.randn(*s, dtype=torch.bfloat16) * 0.8)(B, M, Dm)), 'Wq': _w((lambda *s: torch.randn(*s, dtype=torch.bfloat16) * 1.6)(Dm, H, Dh) * Dm ** (-0.5)), 'Wk': _w((lambda *s: torch.randn(*s, dtype=torch.bfloat16) * 1.6)(Dm, H, Dh) * Dm ** (-0.5)), 'Wv': _w((lambda *s: torch.randn(*s, dtype=torch.bfloat16) * 0.8)(Dm, H, Dh) * Dm ** (-0.5)), 'Wo': _w((lambda *s: torch.randn(*s, dtype=torch.bfloat16) * 0.8)(H, Dh, Dm) * (H * Dh) ** (-0.5)), 'seg_len': seg}
    _B_in = _B_setup()
    return {'A_x': _A_in['x'], 'A_wqkv': _A_in['wqkv'], 'A_w_phi': _A_in['w_phi'], 'A_wo': _A_in['wo'], 'B_x': _B_in['x'], 'B_mem0': _B_in['mem0'], 'B_Wq': _B_in['Wq'], 'B_Wk': _B_in['Wk'], 'B_Wv': _B_in['Wv'], 'B_Wo': _B_in['Wo'], 'B_seg_len': _B_in['seg_len'], 'gate_w': _w((lambda *s: torch.randn(*s, dtype=torch.bfloat16) * 0.05)(448) * 16.0)}

def reference(A_x, A_wqkv, A_w_phi, A_wo, B_x, B_mem0, B_Wq, B_Wk, B_Wv, B_Wo, B_seg_len, gate_w):

    def _A_ref(x, wqkv, w_phi, wo):
        B, S, D = x.shape
        H = 16
        Dh = D // H
        qkv = (lambda x, *d: x.permute(*d))((x @ wqkv).reshape(B, S, 3, H, Dh), 2, 0, 3, 1, 4)
        q, k, v = (qkv[0], qkv[1], qkv[2])
        pq = torch.einsum('bhsd,hdf->bhsf', q, w_phi)
        pk = torch.einsum('bhsd,hdf->bhsf', k, w_phi)
        phi_q = torch.concatenate([_softmax(pq, axis=-1), _softmax(-pq, axis=-1)], axis=-1)
        phi_k = torch.concatenate([_softmax(pk, axis=-1), _softmax(-pk, axis=-1)], axis=-1)
        kv = torch.einsum('bhsf,bhsd->bhfd', phi_k, v)
        z = torch.einsum('bhsf->bhf', phi_k)
        num = torch.einsum('bhqf,bhfd->bhqd', phi_q, kv)
        den = torch.einsum('bhqf,bhf->bhq', phi_q, z)[..., None] + 1e-06
        o = num / den
        return (lambda x, *d: x.permute(*d))(o, 0, 2, 1, 3).reshape(B, S, D) @ wo

    def _B_ref(x, mem0, Wq, Wk, Wv, Wo, seg_len):
        B, S, Dm = x.shape
        H, Dh = (Wq.shape[1], Wq.shape[2])
        M = mem0.shape[1]
        scale = Dh ** (-0.5)
        n_seg = S // seg_len
        L = M + seg_len
        idx = torch.arange(L)
        mask = (idx[:, None] < M) | (idx[:, None] >= idx[None, :])
        mem = mem0
        outs = []
        for s in range(n_seg):
            xs = x[:, s * seg_len:(s + 1) * seg_len, :].clone()
            h = torch.concatenate([mem, xs], axis=1)
            q = torch.einsum('btd,dhe->bhte', h, Wq)
            k = torch.einsum('btd,dhe->bhte', h, Wk)
            v = torch.einsum('btd,dhe->bhte', h, Wv)
            scores = torch.einsum('bhqe,bhke->bhqk', q, k) * scale
            scores = torch.where(mask[None, None], scores, -1000000000.0)
            p = _softmax(scores, axis=-1)
            o = torch.einsum('bhqk,bhke->bhqe', p, v)
            o = torch.einsum('bhte,hed->btd', o, Wo)
            mem = o[:, :M, :].clone()
            outs.append(o[:, M:, :])
        return torch.concatenate(outs, axis=1)
    x = A_x
    g = _sigmoid((x * gate_w).sum(-1, keepdims=True))
    a = _A_ref(x, A_wqkv, A_w_phi, A_wo)
    b = _B_ref(x, B_mem0, B_Wq, B_Wk, B_Wv, B_Wo, B_seg_len)
    return g * a + (1 - g) * b
```

```asm
; @launch kernel=prep_kernel grid=(256,1,1) block=(512,1,1) lds=158992
; @launch kernel=main_kernel grid=(256,1,1) block=(256,1,1) lds=131072
.amdgcn_target "amdgcn-amd-amdhsa--gfx950"
.text
.globl prep_kernel
.p2align 8
.type prep_kernel,@function
prep_kernel:
    s_cmp_ge_u32 s2, 256
    s_cbranch_scc1 prep_kernel_end
    s_load_dwordx2 s[4:5], s[0:1], 112
    s_load_dwordx4 s[44:47], s[0:1], 48
    s_load_dwordx4 s[48:51], s[0:1], 64
    s_load_dwordx2 s[56:57], s[0:1], 40
    s_mov_b32 s58, 7168
    s_mov_b32 s59, 0x20000
    s_load_dwordx2 s[52:53], s[0:1], 0
    s_load_dwordx2 s[60:61], s[0:1], 88
    v_lshrrev_b32 v1, 6, v0
    v_and_b32 v0, 63, v0
    v_readfirstlane_b32 s16, v1
    v_lshlrev_b32 v1, 4, v0
    v_and_b32 v2, 15, v0
    v_lshrrev_b32 v3, 4, v0
    s_mov_b32 s6, 268435456
    s_mov_b32 s7, 0x20000
    s_mov_b32 s10, 3670016
    s_mov_b32 s11, 0x20000
    s_mov_b32 s14, 3670016
    s_mov_b32 s15, 0x20000
    s_and_b32 s17, s2, 31
    s_bfe_u32 s18, s2, 0x10005
    s_lshr_b32 s20, s2, 6
    s_and_b32 s19, s2, 7
    s_lshl_b32 s19, s19, 1
    s_lshr_b32 s21, s17, 3
    s_add_u32 s19, s19, s21
    s_and_b32 s19, s19, 15
    s_lshl_b32 s21, s19, 9
    v_lshrrev_b32 v4, 3, v0
    v_and_b32 v5, 7, v0
    v_xor_b32 v5, v5, v4
    v_lshlrev_b32 v5, 4, v5
    v_lshl_add_u32 v4, v4, 13, v5
    s_lshr_b32 s33, s2, 5
    s_lshl_b32 s33, s33, 4
    s_and_b32 s22, s2, 15
    s_add_u32 s33, s33, s22
    s_cmp_eq_u32 s16, 7
    s_cbranch_scc1 prep_kernel_misc
    s_lshl_b32 s22, s16, 6
    v_add_u32 v5, s22, v0
    v_mul_u32_u24 v6, 4682, v5
    v_lshrrev_b32 v6, 16, v6
    v_mul_u32_u24 v7, 14, v6
    v_sub_u32 v5, v5, v7
    v_lshlrev_b32 v5, 4, v5
    v_mul_u32_u24 v6, 896, v6
    v_add_u32 v5, v5, v6
    s_mul_i32 s24, s18, 7
    s_add_u32 s24, s24, s16
    s_lshl_b32 s25, s24, 18
    s_add_u32 s25, s25, s21
    s_mul_i32 s26, s16, 12288
    s_add_u32 s26, s26, 57344
    s_waitcnt lgkmcnt(0)
    s_cmp_ge_u32 s17, 16
    s_cbranch_scc1 prep_kernel_B
    s_mov_b32 s8, s44
    s_mov_b32 s9, s45
    s_mov_b32 s12, s46
    s_mov_b32 s13, s47
    s_mul_i32 s27, s20, 7
    s_add_u32 s27, s27, s16
    s_lshl_b32 s27, s27, 17
    s_add_u32 s27, s27, s21
    s_lshl_b32 s28, s16, 11
    s_add_u32 s29, s27, 65536
    s_add_u32 s34, s28, 1024
    s_cmp_eq_u32 s18, 1
    s_cselect_b32 s22, s29, s27
    s_cselect_b32 s29, s27, s29
    s_mov_b32 s27, s22
    s_cselect_b32 s22, s34, s28
    s_cselect_b32 s34, s28, s34
    s_mov_b32 s28, s22
    s_add_u32 m0, s28, 0
    s_add_u32 s23, s27, 0
    buffer_load_dwordx4 v4, s[12:15], s23 offen lds
    s_add_u32 s22, s20, 0
    s_and_b32 s22, s22, 3
    s_lshl_b32 s23, s22, 16
    s_add_u32 s36, s25, s23
    s_lshl_b32 s23, s22, 10
    s_add_u32 s40, s26, s23
    s_add_u32 m0, s40, 0
    s_add_u32 s23, s36, 0
    buffer_load_dwordx4 v4, s[8:11], s23 offen lds
    s_add_u32 s22, s20, 1
    s_and_b32 s22, s22, 3
    s_lshl_b32 s23, s22, 16
    s_add_u32 s37, s25, s23
    s_lshl_b32 s23, s22, 10
    s_add_u32 s41, s26, s23
    s_add_u32 m0, s41, 0
    s_add_u32 s23, s37, 0
    buffer_load_dwordx4 v4, s[8:11], s23 offen lds
    s_add_u32 m0, s34, 0
    s_add_u32 s23, s29, 0
    buffer_load_dwordx4 v4, s[12:15], s23 offen lds
    s_add_u32 s22, s20, 2
    s_and_b32 s22, s22, 3
    s_lshl_b32 s23, s22, 16
    s_add_u32 s38, s25, s23
    s_lshl_b32 s23, s22, 10
    s_add_u32 s42, s26, s23
    s_add_u32 m0, s42, 0
    s_add_u32 s23, s38, 0
    buffer_load_dwordx4 v4, s[8:11], s23 offen lds
    s_add_u32 s22, s20, 3
    s_and_b32 s22, s22, 3
    s_lshl_b32 s23, s22, 16
    s_add_u32 s39, s25, s23
    s_lshl_b32 s23, s22, 10
    s_add_u32 s43, s26, s23
    s_add_u32 m0, s43, 0
    s_add_u32 s23, s39, 0
    buffer_load_dwordx4 v4, s[8:11], s23 offen lds
    s_lshl_b32 s22, s2, 3
    s_add_u32 s22, s22, s16
    s_cmp_lg_u32 s22, 72
    s_cbranch_scc1 Larm_1
    v_lshrrev_b32 v238, 2, v2
    v_lshlrev_b32 v238, 1, v238
    v_and_b32 v239, 1, v0
    v_add_u32 v238, v238, v239
    v_mul_u32_u24 v238, 896, v238
    v_lshl_add_u32 v238, v3, 5, v238
    v_bfe_u32 v239, v0, 1, 1
    v_lshl_add_u32 v238, v239, 4, v238
    buffer_load_dwordx4 v[124:127], v238, s[56:59], 0 offen offset:0
    buffer_load_dwordx4 v[128:131], v238, s[56:59], 0 offen offset:128
    buffer_load_dwordx4 v[132:135], v238, s[56:59], 0 offen offset:256
    buffer_load_dwordx4 v[136:139], v238, s[56:59], 0 offen offset:384
    buffer_load_dwordx4 v[140:143], v238, s[56:59], 0 offen offset:512
    buffer_load_dwordx4 v[144:147], v238, s[56:59], 0 offen offset:640
    buffer_load_dwordx4 v[148:151], v238, s[56:59], 0 offen offset:768
    s_mov_b32 s66, 42205184
    s_mov_b32 s67, 42209280
    s_mov_b32 s68, 45314048
    s_mov_b32 s69, 45318144
    s_waitcnt vmcnt(0)
    v_min_u32 v124, 0xfffffffe, v124
    v_min_u32 v125, 0xfffffffe, v125
    v_min_u32 v126, 0xfffffffe, v126
    v_min_u32 v127, 0xfffffffe, v127
    v_min_u32 v128, 0xfffffffe, v128
    v_min_u32 v129, 0xfffffffe, v129
    v_min_u32 v130, 0xfffffffe, v130
    v_min_u32 v131, 0xfffffffe, v131
    v_min_u32 v132, 0xfffffffe, v132
    v_min_u32 v133, 0xfffffffe, v133
    v_min_u32 v134, 0xfffffffe, v134
    v_min_u32 v135, 0xfffffffe, v135
    v_min_u32 v136, 0xfffffffe, v136
    v_min_u32 v137, 0xfffffffe, v137
    v_min_u32 v138, 0xfffffffe, v138
    v_min_u32 v139, 0xfffffffe, v139
    v_min_u32 v140, 0xfffffffe, v140
    v_min_u32 v141, 0xfffffffe, v141
    v_min_u32 v142, 0xfffffffe, v142
    v_min_u32 v143, 0xfffffffe, v143
    v_min_u32 v144, 0xfffffffe, v144
    v_min_u32 v145, 0xfffffffe, v145
    v_min_u32 v146, 0xfffffffe, v146
    v_min_u32 v147, 0xfffffffe, v147
    v_min_u32 v148, 0xfffffffe, v148
    v_min_u32 v149, 0xfffffffe, v149
    v_min_u32 v150, 0xfffffffe, v150
    v_min_u32 v151, 0xfffffffe, v151
    buffer_store_dwordx4 v[124:127], v1, s[4:7], s66 offen offset:0 sc1
    buffer_store_dwordx4 v[124:127], v1, s[4:7], s68 offen offset:0 sc1
    buffer_store_dwordx4 v[128:131], v1, s[4:7], s66 offen offset:1024 sc1
    buffer_store_dwordx4 v[128:131], v1, s[4:7], s68 offen offset:1024 sc1
    buffer_store_dwordx4 v[132:135], v1, s[4:7], s66 offen offset:2048 sc1
    buffer_store_dwordx4 v[132:135], v1, s[4:7], s68 offen offset:2048 sc1
    buffer_store_dwordx4 v[136:139], v1, s[4:7], s66 offen offset:3072 sc1
    buffer_store_dwordx4 v[136:139], v1, s[4:7], s68 offen offset:3072 sc1
    buffer_store_dwordx4 v[140:143], v1, s[4:7], s67 offen offset:0 sc1
    buffer_store_dwordx4 v[140:143], v1, s[4:7], s69 offen offset:0 sc1
    buffer_store_dwordx4 v[144:147], v1, s[4:7], s67 offen offset:1024 sc1
    buffer_store_dwordx4 v[144:147], v1, s[4:7], s69 offen offset:1024 sc1
    buffer_store_dwordx4 v[148:151], v1, s[4:7], s67 offen offset:2048 sc1
    buffer_store_dwordx4 v[148:151], v1, s[4:7], s69 offen offset:2048 sc1
Larm_1:
    v_bfe_u32 v6, v0, 3, 1
    v_lshlrev_b32 v6, 4, v6
    v_bfe_u32 v7, v0, 1, 1
    v_lshl_add_u32 v6, v7, 3, v6
    v_bfe_u32 v7, v0, 2, 1
    v_lshl_add_u32 v6, v7, 2, v6
    v_and_b32 v7, 1, v0
    v_add_u32 v6, v6, v7
    v_add_u32 v7, 0, v6
    v_add_u32 v8, 0, v3
    v_xor_b32 v8, v8, v7
    v_and_b32 v8, 7, v8
    v_lshlrev_b32 v8, 4, v8
    v_lshl_add_u32 v8, v7, 7, v8
    v_add_u32 v8, s26, v8
    v_add_u32 v7, 0, v6
    v_add_u32 v9, 4, v3
    v_xor_b32 v9, v9, v7
    v_and_b32 v9, 7, v9
    v_lshlrev_b32 v9, 4, v9
    v_lshl_add_u32 v9, v7, 7, v9
    v_add_u32 v9, s26, v9
    v_add_u32 v7, 2, v6
    v_add_u32 v10, 0, v3
    v_xor_b32 v10, v10, v7
    v_and_b32 v10, 7, v10
    v_lshlrev_b32 v10, 4, v10
    v_lshl_add_u32 v10, v7, 7, v10
    v_add_u32 v10, s26, v10
    v_add_u32 v7, 2, v6
    v_add_u32 v11, 4, v3
    v_xor_b32 v11, v11, v7
    v_and_b32 v11, 7, v11
    v_lshlrev_b32 v11, 4, v11
    v_lshl_add_u32 v11, v7, 7, v11
    v_add_u32 v11, s26, v11
    v_add_u32 v14, 0, v3
    v_xor_b32 v14, v14, v2
    v_and_b32 v14, 7, v14
    v_lshlrev_b32 v14, 4, v14
    v_lshl_add_u32 v14, v2, 7, v14
    v_add_u32 v15, 4, v3
    v_xor_b32 v15, v15, v2
    v_and_b32 v15, 7, v15
    v_lshlrev_b32 v15, 4, v15
    v_lshl_add_u32 v15, v2, 7, v15
    s_mov_b32 s30, 0x3db8aa3b
    s_mul_i32 s31, s19, 401408
    s_mul_i32 s22, s20, 100352
    s_add_u32 s31, s31, s22
    s_add_u32 s31, s31, 0
    s_lshl_b32 s22, s24, 10
    s_add_u32 s31, s31, s22
    s_waitcnt vmcnt(0)
    s_barrier
    ds_read_b128 v[88:91], v8 offset:0
    ds_read_b128 v[92:95], v10 offset:0
    ds_read_b128 v[96:99], v9 offset:0
    ds_read_b128 v[100:103], v11 offset:0
    ds_read_b128 v[128:131], v14 offset:0
    ds_read_b128 v[132:135], v14 offset:2048
    ds_read_b128 v[136:139], v14 offset:4096
    ds_read_b128 v[140:143], v14 offset:6144
    ds_read_b128 v[144:147], v14 offset:8192
    ds_read_b128 v[148:151], v14 offset:10240
    ds_read_b128 v[152:155], v14 offset:12288
    ds_read_b128 v[156:159], v15 offset:0
    ds_read_b128 v[160:163], v15 offset:2048
    ds_read_b128 v[164:167], v15 offset:4096
    ds_read_b128 v[168:171], v15 offset:6144
    ds_read_b128 v[172:175], v15 offset:8192
    ds_read_b128 v[176:179], v15 offset:10240
    ds_read_b128 v[180:183], v15 offset:12288
    s_waitcnt lgkmcnt(0)
    s_barrier
    ds_read_b128 v[104:107], v8 offset:4096
    ds_read_b128 v[108:111], v10 offset:4096
    ds_read_b128 v[112:115], v9 offset:4096
    ds_read_b128 v[116:119], v11 offset:4096
    v_mfma_f32_16x16x32_bf16 v[32:35], v[88:91], v[128:131], 0
    ds_read_b128 v[184:187], v14 offset:14336
    v_mfma_f32_16x16x32_bf16 v[60:63], v[92:95], v[128:131], 0
    v_mfma_f32_16x16x32_bf16 v[36:39], v[88:91], v[132:135], 0
    ds_read_b128 v[188:191], v14 offset:16384
    v_mfma_f32_16x16x32_bf16 v[64:67], v[92:95], v[132:135], 0
    v_mfma_f32_16x16x32_bf16 v[40:43], v[88:91], v[136:139], 0
    ds_read_b128 v[192:195], v14 offset:18432
    v_mfma_f32_16x16x32_bf16 v[68:71], v[92:95], v[136:139], 0
    v_mfma_f32_16x16x32_bf16 v[44:47], v[88:91], v[140:143], 0
    ds_read_b128 v[196:199], v14 offset:20480
    v_mfma_f32_16x16x32_bf16 v[72:75], v[92:95], v[140:143], 0
    v_mfma_f32_16x16x32_bf16 v[48:51], v[88:91], v[144:147], 0
    ds_read_b128 v[200:203], v14 offset:22528
    v_mfma_f32_16x16x32_bf16 v[76:79], v[92:95], v[144:147], 0
    v_mfma_f32_16x16x32_bf16 v[52:55], v[88:91], v[148:151], 0
    ds_read_b128 v[204:207], v14 offset:24576
    v_mfma_f32_16x16x32_bf16 v[80:83], v[92:95], v[148:151], 0
    v_mfma_f32_16x16x32_bf16 v[56:59], v[88:91], v[152:155], 0
    ds_read_b128 v[208:211], v14 offset:26624
    v_mfma_f32_16x16x32_bf16 v[84:87], v[92:95], v[152:155], 0
    v_mfma_f32_16x16x32_bf16 v[32:35], v[96:99], v[156:159], v[32:35]
    ds_read_b128 v[212:215], v15 offset:14336
    v_mfma_f32_16x16x32_bf16 v[60:63], v[100:103], v[156:159], v[60:63]
    v_mfma_f32_16x16x32_bf16 v[36:39], v[96:99], v[160:163], v[36:39]
    ds_read_b128 v[216:219], v15 offset:16384
    v_mfma_f32_16x16x32_bf16 v[64:67], v[100:103], v[160:163], v[64:67]
    v_mfma_f32_16x16x32_bf16 v[40:43], v[96:99], v[164:167], v[40:43]
    ds_read_b128 v[220:223], v15 offset:18432
    v_mfma_f32_16x16x32_bf16 v[68:71], v[100:103], v[164:167], v[68:71]
    v_mfma_f32_16x16x32_bf16 v[44:47], v[96:99], v[168:171], v[44:47]
    ds_read_b128 v[224:227], v15 offset:20480
    v_mfma_f32_16x16x32_bf16 v[72:75], v[100:103], v[168:171], v[72:75]
    v_mfma_f32_16x16x32_bf16 v[48:51], v[96:99], v[172:175], v[48:51]
    ds_read_b128 v[228:231], v15 offset:22528
    v_mfma_f32_16x16x32_bf16 v[76:79], v[100:103], v[172:175], v[76:79]
    v_mfma_f32_16x16x32_bf16 v[52:55], v[96:99], v[176:179], v[52:55]
    ds_read_b128 v[232:235], v15 offset:24576
    v_mfma_f32_16x16x32_bf16 v[80:83], v[100:103], v[176:179], v[80:83]
    v_mfma_f32_16x16x32_bf16 v[56:59], v[96:99], v[180:183], v[56:59]
    ds_read_b128 v[236:239], v15 offset:26624
    v_mfma_f32_16x16x32_bf16 v[84:87], v[100:103], v[180:183], v[84:87]
    s_waitcnt lgkmcnt(0)
    s_barrier
    ds_read_b128 v[88:91], v8 offset:8192
    ds_read_b128 v[92:95], v10 offset:8192
    ds_read_b128 v[96:99], v9 offset:8192
    ds_read_b128 v[100:103], v11 offset:8192
    v_mfma_f32_16x16x32_bf16 v[32:35], v[104:107], v[184:187], v[32:35]
    ds_read_b128 v[128:131], v14 offset:28672
    v_mfma_f32_16x16x32_bf16 v[60:63], v[108:111], v[184:187], v[60:63]
    v_mfma_f32_16x16x32_bf16 v[36:39], v[104:107], v[188:191], v[36:39]
    ds_read_b128 v[132:135], v14 offset:30720
    v_mfma_f32_16x16x32_bf16 v[64:67], v[108:111], v[188:191], v[64:67]
    v_mfma_f32_16x16x32_bf16 v[40:43], v[104:107], v[192:195], v[40:43]
    ds_read_b128 v[136:139], v14 offset:32768
    v_mfma_f32_16x16x32_bf16 v[68:71], v[108:111], v[192:195], v[68:71]
    v_mfma_f32_16x16x32_bf16 v[44:47], v[104:107], v[196:199], v[44:47]
    ds_read_b128 v[140:143], v14 offset:34816
    v_mfma_f32_16x16x32_bf16 v[72:75], v[108:111], v[196:199], v[72:75]
    v_mfma_f32_16x16x32_bf16 v[48:51], v[104:107], v[200:203], v[48:51]
    ds_read_b128 v[144:147], v14 offset:36864
    v_mfma_f32_16x16x32_bf16 v[76:79], v[108:111], v[200:203], v[76:79]
    v_mfma_f32_16x16x32_bf16 v[52:55], v[104:107], v[204:207], v[52:55]
    ds_read_b128 v[148:151], v14 offset:38912
    v_mfma_f32_16x16x32_bf16 v[80:83], v[108:111], v[204:207], v[80:83]
    v_mfma_f32_16x16x32_bf16 v[56:59], v[104:107], v[208:211], v[56:59]
    ds_read_b128 v[152:155], v14 offset:40960
    v_mfma_f32_16x16x32_bf16 v[84:87], v[108:111], v[208:211], v[84:87]
    v_mfma_f32_16x16x32_bf16 v[32:35], v[112:115], v[212:215], v[32:35]
    ds_read_b128 v[156:159], v15 offset:28672
    v_mfma_f32_16x16x32_bf16 v[60:63], v[116:119], v[212:215], v[60:63]
    v_mfma_f32_16x16x32_bf16 v[36:39], v[112:115], v[216:219], v[36:39]
    ds_read_b128 v[160:163], v15 offset:30720
    v_mfma_f32_16x16x32_bf16 v[64:67], v[116:119], v[216:219], v[64:67]
    v_mfma_f32_16x16x32_bf16 v[40:43], v[112:115], v[220:223], v[40:43]
    ds_read_b128 v[164:167], v15 offset:32768
    v_mfma_f32_16x16x32_bf16 v[68:71], v[116:119], v[220:223], v[68:71]
    v_mfma_f32_16x16x32_bf16 v[44:47], v[112:115], v[224:227], v[44:47]
    ds_read_b128 v[168:171], v15 offset:34816
    v_mfma_f32_16x16x32_bf16 v[72:75], v[116:119], v[224:227], v[72:75]
    v_mfma_f32_16x16x32_bf16 v[48:51], v[112:115], v[228:231], v[48:51]
    ds_read_b128 v[172:175], v15 offset:36864
    v_mfma_f32_16x16x32_bf16 v[76:79], v[116:119], v[228:231], v[76:79]
    v_mfma_f32_16x16x32_bf16 v[52:55], v[112:115], v[232:235], v[52:55]
    ds_read_b128 v[176:179], v15 offset:38912
    v_mfma_f32_16x16x32_bf16 v[80:83], v[116:119], v[232:235], v[80:83]
    v_mfma_f32_16x16x32_bf16 v[56:59], v[112:115], v[236:239], v[56:59]
    ds_read_b128 v[180:183], v15 offset:40960
    v_mfma_f32_16x16x32_bf16 v[84:87], v[116:119], v[236:239], v[84:87]
    s_waitcnt lgkmcnt(0)
    s_barrier
    ds_read_b128 v[104:107], v8 offset:0
    ds_read_b128 v[108:111], v10 offset:0
    ds_read_b128 v[112:115], v9 offset:0
    ds_read_b128 v[116:119], v11 offset:0
    v_mfma_f32_16x16x32_bf16 v[32:35], v[88:91], v[128:131], v[32:35]
    ds_read_b128 v[184:187], v14 offset:43008
    v_mfma_f32_16x16x32_bf16 v[60:63], v[92:95], v[128:131], v[60:63]
    v_mfma_f32_16x16x32_bf16 v[36:39], v[88:91], v[132:135], v[36:39]
    ds_read_b128 v[188:191], v14 offset:45056
    v_mfma_f32_16x16x32_bf16 v[64:67], v[92:95], v[132:135], v[64:67]
    v_mfma_f32_16x16x32_bf16 v[40:43], v[88:91], v[136:139], v[40:43]
    ds_read_b128 v[192:195], v14 offset:47104
    v_mfma_f32_16x16x32_bf16 v[68:71], v[92:95], v[136:139], v[68:71]
    v_mfma_f32_16x16x32_bf16 v[44:47], v[88:91], v[140:143], v[44:47]
    ds_read_b128 v[196:199], v14 offset:49152
    v_mfma_f32_16x16x32_bf16 v[72:75], v[92:95], v[140:143], v[72:75]
    v_mfma_f32_16x16x32_bf16 v[48:51], v[88:91], v[144:147], v[48:51]
    ds_read_b128 v[200:203], v14 offset:51200
    v_mfma_f32_16x16x32_bf16 v[76:79], v[92:95], v[144:147], v[76:79]
    v_mfma_f32_16x16x32_bf16 v[52:55], v[88:91], v[148:151], v[52:55]
    ds_read_b128 v[204:207], v14 offset:53248
    v_mfma_f32_16x16x32_bf16 v[80:83], v[92:95], v[148:151], v[80:83]
    v_mfma_f32_16x16x32_bf16 v[56:59], v[88:91], v[152:155], v[56:59]
    ds_read_b128 v[208:211], v14 offset:55296
    v_mfma_f32_16x16x32_bf16 v[84:87], v[92:95], v[152:155], v[84:87]
    v_mfma_f32_16x16x32_bf16 v[32:35], v[96:99], v[156:159], v[32:35]
    ds_read_b128 v[212:215], v15 offset:43008
    v_mfma_f32_16x16x32_bf16 v[60:63], v[100:103], v[156:159], v[60:63]
    v_mfma_f32_16x16x32_bf16 v[36:39], v[96:99], v[160:163], v[36:39]
    ds_read_b128 v[216:219], v15 offset:45056
    v_mfma_f32_16x16x32_bf16 v[64:67], v[100:103], v[160:163], v[64:67]
    v_mfma_f32_16x16x32_bf16 v[40:43], v[96:99], v[164:167], v[40:43]
    ds_read_b128 v[220:223], v15 offset:47104
    v_mfma_f32_16x16x32_bf16 v[68:71], v[100:103], v[164:167], v[68:71]
    v_mfma_f32_16x16x32_bf16 v[44:47], v[96:99], v[168:171], v[44:47]
    ds_read_b128 v[224:227], v15 offset:49152
    v_mfma_f32_16x16x32_bf16 v[72:75], v[100:103], v[168:171], v[72:75]
    v_mfma_f32_16x16x32_bf16 v[48:51], v[96:99], v[172:175], v[48:51]
    ds_read_b128 v[228:231], v15 offset:51200
    v_mfma_f32_16x16x32_bf16 v[76:79], v[100:103], v[172:175], v[76:79]
    v_mfma_f32_16x16x32_bf16 v[52:55], v[96:99], v[176:179], v[52:55]
    ds_read_b128 v[232:235], v15 offset:53248
    v_mfma_f32_16x16x32_bf16 v[80:83], v[100:103], v[176:179], v[80:83]
    v_mfma_f32_16x16x32_bf16 v[56:59], v[96:99], v[180:183], v[56:59]
    ds_read_b128 v[236:239], v15 offset:55296
    v_mfma_f32_16x16x32_bf16 v[84:87], v[100:103], v[180:183], v[84:87]
    s_waitcnt lgkmcnt(0)
    v_mfma_f32_16x16x32_bf16 v[32:35], v[104:107], v[184:187], v[32:35]
    v_mfma_f32_16x16x32_bf16 v[60:63], v[108:111], v[184:187], v[60:63]
    v_mfma_f32_16x16x32_bf16 v[36:39], v[104:107], v[188:191], v[36:39]
    v_mfma_f32_16x16x32_bf16 v[64:67], v[108:111], v[188:191], v[64:67]
    v_mfma_f32_16x16x32_bf16 v[40:43], v[104:107], v[192:195], v[40:43]
    v_mfma_f32_16x16x32_bf16 v[68:71], v[108:111], v[192:195], v[68:71]
    v_mfma_f32_16x16x32_bf16 v[44:47], v[104:107], v[196:199], v[44:47]
    v_mfma_f32_16x16x32_bf16 v[72:75], v[108:111], v[196:199], v[72:75]
    v_mfma_f32_16x16x32_bf16 v[48:51], v[104:107], v[200:203], v[48:51]
    v_mfma_f32_16x16x32_bf16 v[76:79], v[108:111], v[200:203], v[76:79]
    v_mfma_f32_16x16x32_bf16 v[52:55], v[104:107], v[204:207], v[52:55]
    v_mfma_f32_16x16x32_bf16 v[80:83], v[108:111], v[204:207], v[80:83]
    v_mfma_f32_16x16x32_bf16 v[56:59], v[104:107], v[208:211], v[56:59]
    v_mfma_f32_16x16x32_bf16 v[84:87], v[108:111], v[208:211], v[84:87]
    v_mfma_f32_16x16x32_bf16 v[32:35], v[112:115], v[212:215], v[32:35]
    v_mfma_f32_16x16x32_bf16 v[60:63], v[116:119], v[212:215], v[60:63]
    v_mfma_f32_16x16x32_bf16 v[36:39], v[112:115], v[216:219], v[36:39]
    v_mfma_f32_16x16x32_bf16 v[64:67], v[116:119], v[216:219], v[64:67]
    v_mfma_f32_16x16x32_bf16 v[40:43], v[112:115], v[220:223], v[40:43]
    v_mfma_f32_16x16x32_bf16 v[68:71], v[116:119], v[220:223], v[68:71]
    v_mfma_f32_16x16x32_bf16 v[44:47], v[112:115], v[224:227], v[44:47]
    v_mfma_f32_16x16x32_bf16 v[72:75], v[116:119], v[224:227], v[72:75]
    v_mfma_f32_16x16x32_bf16 v[48:51], v[112:115], v[228:231], v[48:51]
    v_mfma_f32_16x16x32_bf16 v[76:79], v[116:119], v[228:231], v[76:79]
    v_mfma_f32_16x16x32_bf16 v[52:55], v[112:115], v[232:235], v[52:55]
    v_mfma_f32_16x16x32_bf16 v[80:83], v[116:119], v[232:235], v[80:83]
    v_mfma_f32_16x16x32_bf16 v[56:59], v[112:115], v[236:239], v[56:59]
    v_mfma_f32_16x16x32_bf16 v[84:87], v[116:119], v[236:239], v[84:87]
    s_nop 7
    v_mul_f32 v32, s30, v32
    v_mul_f32 v60, s30, v60
    v_mul_f32 v33, s30, v33
    v_mul_f32 v61, s30, v61
    v_mul_f32 v34, s30, v34
    v_mul_f32 v62, s30, v62
    v_mul_f32 v35, s30, v35
    v_mul_f32 v63, s30, v63
    v_cvt_pk_bf16_f32 v32, v32, v33
    v_cvt_pk_bf16_f32 v33, v34, v35
    v_cvt_pk_bf16_f32 v34, v60, v61
    v_cvt_pk_bf16_f32 v35, v62, v63
    buffer_store_dwordx4 v[32:35], v1, s[4:7], s31 offen sc1
    s_add_u32 s31, s31, 14336
    v_mul_f32 v36, s30, v36
    v_mul_f32 v64, s30, v64
    v_mul_f32 v37, s30, v37
    v_mul_f32 v65, s30, v65
    v_mul_f32 v38, s30, v38
    v_mul_f32 v66, s30, v66
    v_mul_f32 v39, s30, v39
    v_mul_f32 v67, s30, v67
    v_cvt_pk_bf16_f32 v36, v36, v37
    v_cvt_pk_bf16_f32 v37, v38, v39
    v_cvt_pk_bf16_f32 v38, v64, v65
    v_cvt_pk_bf16_f32 v39, v66, v67
    buffer_store_dwordx4 v[36:39], v1, s[4:7], s31 offen sc1
    s_add_u32 s31, s31, 14336
    v_mul_f32 v40, s30, v40
    v_mul_f32 v68, s30, v68
    v_mul_f32 v41, s30, v41
    v_mul_f32 v69, s30, v69
    v_mul_f32 v42, s30, v42
    v_mul_f32 v70, s30, v70
    v_mul_f32 v43, s30, v43
    v_mul_f32 v71, s30, v71
    v_cvt_pk_bf16_f32 v40, v40, v41
    v_cvt_pk_bf16_f32 v41, v42, v43
    v_cvt_pk_bf16_f32 v42, v68, v69
    v_cvt_pk_bf16_f32 v43, v70, v71
    buffer_store_dwordx4 v[40:43], v1, s[4:7], s31 offen sc1
    s_add_u32 s31, s31, 14336
    v_mul_f32 v44, s30, v44
    v_mul_f32 v72, s30, v72
    v_mul_f32 v45, s30, v45
    v_mul_f32 v73, s30, v73
    v_mul_f32 v46, s30, v46
    v_mul_f32 v74, s30, v74
    v_mul_f32 v47, s30, v47
    v_mul_f32 v75, s30, v75
    v_cvt_pk_bf16_f32 v44, v44, v45
    v_cvt_pk_bf16_f32 v45, v46, v47
    v_cvt_pk_bf16_f32 v46, v72, v73
    v_cvt_pk_bf16_f32 v47, v74, v75
    buffer_store_dwordx4 v[44:47], v1, s[4:7], s31 offen sc1
    s_add_u32 s31, s31, 14336
    v_mul_f32 v48, s30, v48
    v_mul_f32 v76, s30, v76
    v_mul_f32 v49, s30, v49
    v_mul_f32 v77, s30, v77
    v_mul_f32 v50, s30, v50
    v_mul_f32 v78, s30, v78
    v_mul_f32 v51, s30, v51
    v_mul_f32 v79, s30, v79
    v_cvt_pk_bf16_f32 v48, v48, v49
    v_cvt_pk_bf16_f32 v49, v50, v51
    v_cvt_pk_bf16_f32 v50, v76, v77
    v_cvt_pk_bf16_f32 v51, v78, v79
    buffer_store_dwordx4 v[48:51], v1, s[4:7], s31 offen sc1
    s_add_u32 s31, s31, 14336
    v_mul_f32 v52, s30, v52
    v_mul_f32 v80, s30, v80
    v_mul_f32 v53, s30, v53
    v_mul_f32 v81, s30, v81
    v_mul_f32 v54, s30, v54
    v_mul_f32 v82, s30, v82
    v_mul_f32 v55, s30, v55
    v_mul_f32 v83, s30, v83
    v_cvt_pk_bf16_f32 v52, v52, v53
    v_cvt_pk_bf16_f32 v53, v54, v55
    v_cvt_pk_bf16_f32 v54, v80, v81
    v_cvt_pk_bf16_f32 v55, v82, v83
    buffer_store_dwordx4 v[52:55], v1, s[4:7], s31 offen sc1
    s_add_u32 s31, s31, 14336
    v_mul_f32 v56, s30, v56
    v_mul_f32 v84, s30, v84
    v_mul_f32 v57, s30, v57
    v_mul_f32 v85, s30, v85
    v_mul_f32 v58, s30, v58
    v_mul_f32 v86, s30, v86
    v_mul_f32 v59, s30, v59
    v_mul_f32 v87, s30, v87
    v_cvt_pk_bf16_f32 v56, v56, v57
    v_cvt_pk_bf16_f32 v57, v58, v59
    v_cvt_pk_bf16_f32 v58, v84, v85
    v_cvt_pk_bf16_f32 v59, v86, v87
    buffer_store_dwordx4 v[56:59], v1, s[4:7], s31 offen sc1
    s_add_u32 s31, s31, 14336
    s_endpgm
prep_kernel_B:
    s_mov_b32 s8, s48
    s_mov_b32 s9, s49
    s_mov_b32 s12, s50
    s_mov_b32 s13, s51
    s_mul_i32 s27, s19, 229376
    s_mul_i32 s22, s20, 224
    s_add_u32 s27, s27, s22
    s_lshl_b32 s28, s16, 10
    s_add_u32 s29, s27, 28672
    s_add_u32 s34, s28, 7168
    s_cmp_eq_u32 s18, 1
    s_cselect_b32 s22, s29, s27
    s_cselect_b32 s29, s27, s29
    s_mov_b32 s27, s22
    s_cselect_b32 s22, s34, s28
    s_cselect_b32 s34, s28, s34
    s_mov_b32 s28, s22
    s_add_u32 m0, s28, 0
    s_add_u32 s23, s27, 0
    buffer_load_dwordx4 v5, s[12:15], s23 offen lds
    s_add_u32 s22, s20, 0
    s_and_b32 s22, s22, 3
    s_lshl_b32 s23, s22, 16
    s_add_u32 s36, s25, s23
    s_lshl_b32 s23, s22, 10
    s_add_u32 s40, s26, s23
    s_add_u32 m0, s40, 0
    s_add_u32 s23, s36, 0
    buffer_load_dwordx4 v4, s[8:11], s23 offen lds
    s_add_u32 s22, s20, 1
    s_and_b32 s22, s22, 3
    s_lshl_b32 s23, s22, 16
    s_add_u32 s37, s25, s23
    s_lshl_b32 s23, s22, 10
    s_add_u32 s41, s26, s23
    s_add_u32 m0, s41, 0
    s_add_u32 s23, s37, 0
    buffer_load_dwordx4 v4, s[8:11], s23 offen lds
    s_add_u32 m0, s34, 0
    s_add_u32 s23, s29, 0
    buffer_load_dwordx4 v5, s[12:15], s23 offen lds
    s_add_u32 s22, s20, 2
    s_and_b32 s22, s22, 3
    s_lshl_b32 s23, s22, 16
    s_add_u32 s38, s25, s23
    s_lshl_b32 s23, s22, 10
    s_add_u32 s42, s26, s23
    s_add_u32 m0, s42, 0
    s_add_u32 s23, s38, 0
    buffer_load_dwordx4 v4, s[8:11], s23 offen lds
    s_add_u32 s22, s20, 3
    s_and_b32 s22, s22, 3
    s_lshl_b32 s23, s22, 16
    s_add_u32 s39, s25, s23
    s_lshl_b32 s23, s22, 10
    s_add_u32 s43, s26, s23
    s_add_u32 m0, s43, 0
    s_add_u32 s23, s39, 0
    buffer_load_dwordx4 v4, s[8:11], s23 offen lds
    v_bfe_u32 v6, v0, 3, 1
    v_lshlrev_b32 v6, 4, v6
    v_bfe_u32 v7, v0, 1, 1
    v_lshl_add_u32 v6, v7, 3, v6
    v_bfe_u32 v7, v0, 2, 1
    v_lshl_add_u32 v6, v7, 2, v6
    v_and_b32 v7, 1, v0
    v_add_u32 v6, v6, v7
    v_add_u32 v7, 0, v6
    v_add_u32 v8, 0, v3
    v_xor_b32 v8, v8, v7
    v_and_b32 v8, 7, v8
    v_lshlrev_b32 v8, 4, v8
    v_lshl_add_u32 v8, v7, 7, v8
    v_add_u32 v8, s26, v8
    v_add_u32 v7, 0, v6
    v_add_u32 v9, 4, v3
    v_xor_b32 v9, v9, v7
    v_and_b32 v9, 7, v9
    v_lshlrev_b32 v9, 4, v9
    v_lshl_add_u32 v9, v7, 7, v9
    v_add_u32 v9, s26, v9
    v_add_u32 v7, 2, v6
    v_add_u32 v10, 0, v3
    v_xor_b32 v10, v10, v7
    v_and_b32 v10, 7, v10
    v_lshlrev_b32 v10, 4, v10
    v_lshl_add_u32 v10, v7, 7, v10
    v_add_u32 v10, s26, v10
    v_add_u32 v7, 2, v6
    v_add_u32 v11, 4, v3
    v_xor_b32 v11, v11, v7
    v_and_b32 v11, 7, v11
    v_lshlrev_b32 v11, 4, v11
    v_lshl_add_u32 v11, v7, 7, v11
    v_add_u32 v11, s26, v11
    v_lshrrev_b32 v14, 2, v2
    v_lshl_add_u32 v14, v3, 3, v14
    v_mul_u32_u24 v14, 224, v14
    v_and_b32 v7, 3, v0
    v_lshl_add_u32 v14, v7, 3, v14
    s_mul_i32 s22, s20, 112
    s_and_b32 s30, s19, 3
    s_mul_i32 s30, s30, 28
    v_add_u32 v16, s22, v2
    v_add_u32 v16, 0, v16
    v_mul_u32_u24 v17, 2341, v16
    v_lshrrev_b32 v17, 16, v17
    v_mul_u32_u24 v18, 28, v17
    v_sub_u32 v16, v16, v18
    v_and_b32 v18, 1, v16
    v_mul_u32_u24 v18, 14, v18
    v_lshrrev_b32 v16, 1, v16
    v_add3_u32 v16, v16, v18, s30
    v_mul_u32_u24 v20, 401408, v17
    v_lshrrev_b32 v18, 4, v16
    v_mul_u32_u24 v18, 14336, v18
    v_add_u32 v20, v20, v18
    v_and_b32 v16, 15, v16
    v_lshl_add_u32 v16, v3, 4, v16
    v_lshl_add_u32 v20, v16, 4, v20
    v_add_u32 v16, s22, v2
    v_add_u32 v16, 16, v16
    v_mul_u32_u24 v17, 2341, v16
    v_lshrrev_b32 v17, 16, v17
    v_mul_u32_u24 v18, 28, v17
    v_sub_u32 v16, v16, v18
    v_and_b32 v18, 1, v16
    v_mul_u32_u24 v18, 14, v18
    v_lshrrev_b32 v16, 1, v16
    v_add3_u32 v16, v16, v18, s30
    v_mul_u32_u24 v21, 401408, v17
    v_lshrrev_b32 v18, 4, v16
    v_mul_u32_u24 v18, 14336, v18
    v_add_u32 v21, v21, v18
    v_and_b32 v16, 15, v16
    v_lshl_add_u32 v16, v3, 4, v16
    v_lshl_add_u32 v21, v16, 4, v21
    v_add_u32 v16, s22, v2
    v_add_u32 v16, 32, v16
    v_mul_u32_u24 v17, 2341, v16
    v_lshrrev_b32 v17, 16, v17
    v_mul_u32_u24 v18, 28, v17
    v_sub_u32 v16, v16, v18
    v_and_b32 v18, 1, v16
    v_mul_u32_u24 v18, 14, v18
    v_lshrrev_b32 v16, 1, v16
    v_add3_u32 v16, v16, v18, s30
    v_mul_u32_u24 v22, 401408, v17
    v_lshrrev_b32 v18, 4, v16
    v_mul_u32_u24 v18, 14336, v18
    v_add_u32 v22, v22, v18
    v_and_b32 v16, 15, v16
    v_lshl_add_u32 v16, v3, 4, v16
    v_lshl_add_u32 v22, v16, 4, v22
    v_add_u32 v16, s22, v2
    v_add_u32 v16, 48, v16
    v_mul_u32_u24 v17, 2341, v16
    v_lshrrev_b32 v17, 16, v17
    v_mul_u32_u24 v18, 28, v17
    v_sub_u32 v16, v16, v18
    v_and_b32 v18, 1, v16
    v_mul_u32_u24 v18, 14, v18
    v_lshrrev_b32 v16, 1, v16
    v_add3_u32 v16, v16, v18, s30
    v_mul_u32_u24 v23, 401408, v17
    v_lshrrev_b32 v18, 4, v16
    v_mul_u32_u24 v18, 14336, v18
    v_add_u32 v23, v23, v18
    v_and_b32 v16, 15, v16
    v_lshl_add_u32 v16, v3, 4, v16
    v_lshl_add_u32 v23, v16, 4, v23
    v_add_u32 v16, s22, v2
    v_add_u32 v16, 64, v16
    v_mul_u32_u24 v17, 2341, v16
    v_lshrrev_b32 v17, 16, v17
    v_mul_u32_u24 v18, 28, v17
    v_sub_u32 v16, v16, v18
    v_and_b32 v18, 1, v16
    v_mul_u32_u24 v18, 14, v18
    v_lshrrev_b32 v16, 1, v16
    v_add3_u32 v16, v16, v18, s30
    v_mul_u32_u24 v24, 401408, v17
    v_lshrrev_b32 v18, 4, v16
    v_mul_u32_u24 v18, 14336, v18
    v_add_u32 v24, v24, v18
    v_and_b32 v16, 15, v16
    v_lshl_add_u32 v16, v3, 4, v16
    v_lshl_add_u32 v24, v16, 4, v24
    v_add_u32 v16, s22, v2
    v_add_u32 v16, 80, v16
    v_mul_u32_u24 v17, 2341, v16
    v_lshrrev_b32 v17, 16, v17
    v_mul_u32_u24 v18, 28, v17
    v_sub_u32 v16, v16, v18
    v_and_b32 v18, 1, v16
    v_mul_u32_u24 v18, 14, v18
    v_lshrrev_b32 v16, 1, v16
    v_add3_u32 v16, v16, v18, s30
    v_mul_u32_u24 v25, 401408, v17
    v_lshrrev_b32 v18, 4, v16
    v_mul_u32_u24 v18, 14336, v18
    v_add_u32 v25, v25, v18
    v_and_b32 v16, 15, v16
    v_lshl_add_u32 v16, v3, 4, v16
    v_lshl_add_u32 v25, v16, 4, v25
    v_add_u32 v16, s22, v2
    v_add_u32 v16, 96, v16
    v_mul_u32_u24 v17, 2341, v16
    v_lshrrev_b32 v17, 16, v17
    v_mul_u32_u24 v18, 28, v17
    v_sub_u32 v16, v16, v18
    v_and_b32 v18, 1, v16
    v_mul_u32_u24 v18, 14, v18
    v_lshrrev_b32 v16, 1, v16
    v_add3_u32 v16, v16, v18, s30
    v_mul_u32_u24 v26, 401408, v17
    v_lshrrev_b32 v18, 4, v16
    v_mul_u32_u24 v18, 14336, v18
    v_add_u32 v26, v26, v18
    v_and_b32 v16, 15, v16
    v_lshl_add_u32 v16, v3, 4, v16
    v_lshl_add_u32 v26, v16, 4, v26
    s_lshr_b32 s31, s19, 2
    s_mul_i32 s31, s31, 100352
    s_add_u32 s31, s31, 6422528
    s_lshl_b32 s22, s24, 10
    s_add_u32 s31, s31, s22
    s_waitcnt vmcnt(0)
    s_barrier
    ds_read_b128 v[88:91], v8 offset:0
    ds_read_b128 v[92:95], v10 offset:0
    ds_read_b128 v[96:99], v9 offset:0
    ds_read_b128 v[100:103], v11 offset:0
    ds_read_b64_tr_b16 v[128:129], v14 offset:0
    ds_read_b64_tr_b16 v[130:131], v14 offset:896
    ds_read_b64_tr_b16 v[132:133], v14 offset:32
    ds_read_b64_tr_b16 v[134:135], v14 offset:928
    ds_read_b64_tr_b16 v[136:137], v14 offset:64
    ds_read_b64_tr_b16 v[138:139], v14 offset:960
    ds_read_b64_tr_b16 v[140:141], v14 offset:96
    ds_read_b64_tr_b16 v[142:143], v14 offset:992
    ds_read_b64_tr_b16 v[144:145], v14 offset:128
    ds_read_b64_tr_b16 v[146:147], v14 offset:1024
    ds_read_b64_tr_b16 v[148:149], v14 offset:160
    ds_read_b64_tr_b16 v[150:151], v14 offset:1056
    ds_read_b64_tr_b16 v[152:153], v14 offset:192
    ds_read_b64_tr_b16 v[154:155], v14 offset:1088
    ds_read_b64_tr_b16 v[156:157], v14 offset:7168
    ds_read_b64_tr_b16 v[158:159], v14 offset:8064
    ds_read_b64_tr_b16 v[160:161], v14 offset:7200
    ds_read_b64_tr_b16 v[162:163], v14 offset:8096
    ds_read_b64_tr_b16 v[164:165], v14 offset:7232
    ds_read_b64_tr_b16 v[166:167], v14 offset:8128
    ds_read_b64_tr_b16 v[168:169], v14 offset:7264
    ds_read_b64_tr_b16 v[170:171], v14 offset:8160
    ds_read_b64_tr_b16 v[172:173], v14 offset:7296
    ds_read_b64_tr_b16 v[174:175], v14 offset:8192
    ds_read_b64_tr_b16 v[176:177], v14 offset:7328
    ds_read_b64_tr_b16 v[178:179], v14 offset:8224
    ds_read_b64_tr_b16 v[180:181], v14 offset:7360
    ds_read_b64_tr_b16 v[182:183], v14 offset:8256
    s_waitcnt lgkmcnt(0)
    s_barrier
    ds_read_b128 v[104:107], v8 offset:4096
    ds_read_b128 v[108:111], v10 offset:4096
    ds_read_b128 v[112:115], v9 offset:4096
    ds_read_b128 v[116:119], v11 offset:4096
    v_mfma_f32_16x16x32_bf16 v[32:35], v[88:91], v[128:131], 0
    ds_read_b64_tr_b16 v[184:185], v14 offset:14336
    ds_read_b64_tr_b16 v[186:187], v14 offset:15232
    v_mfma_f32_16x16x32_bf16 v[60:63], v[92:95], v[128:131], 0
    v_mfma_f32_16x16x32_bf16 v[36:39], v[88:91], v[132:135], 0
    ds_read_b64_tr_b16 v[188:189], v14 offset:14368
    ds_read_b64_tr_b16 v[190:191], v14 offset:15264
    v_mfma_f32_16x16x32_bf16 v[64:67], v[92:95], v[132:135], 0
    v_mfma_f32_16x16x32_bf16 v[40:43], v[88:91], v[136:139], 0
    ds_read_b64_tr_b16 v[192:193], v14 offset:14400
    ds_read_b64_tr_b16 v[194:195], v14 offset:15296
    v_mfma_f32_16x16x32_bf16 v[68:71], v[92:95], v[136:139], 0
    v_mfma_f32_16x16x32_bf16 v[44:47], v[88:91], v[140:143], 0
    ds_read_b64_tr_b16 v[196:197], v14 offset:14432
    ds_read_b64_tr_b16 v[198:199], v14 offset:15328
    v_mfma_f32_16x16x32_bf16 v[72:75], v[92:95], v[140:143], 0
    v_mfma_f32_16x16x32_bf16 v[48:51], v[88:91], v[144:147], 0
    ds_read_b64_tr_b16 v[200:201], v14 offset:14464
    ds_read_b64_tr_b16 v[202:203], v14 offset:15360
    v_mfma_f32_16x16x32_bf16 v[76:79], v[92:95], v[144:147], 0
    v_mfma_f32_16x16x32_bf16 v[52:55], v[88:91], v[148:151], 0
    ds_read_b64_tr_b16 v[204:205], v14 offset:14496
    ds_read_b64_tr_b16 v[206:207], v14 offset:15392
    v_mfma_f32_16x16x32_bf16 v[80:83], v[92:95], v[148:151], 0
    v_mfma_f32_16x16x32_bf16 v[56:59], v[88:91], v[152:155], 0
    ds_read_b64_tr_b16 v[208:209], v14 offset:14528
    ds_read_b64_tr_b16 v[210:211], v14 offset:15424
    v_mfma_f32_16x16x32_bf16 v[84:87], v[92:95], v[152:155], 0
    v_mfma_f32_16x16x32_bf16 v[32:35], v[96:99], v[156:159], v[32:35]
    ds_read_b64_tr_b16 v[212:213], v14 offset:21504
    ds_read_b64_tr_b16 v[214:215], v14 offset:22400
    v_mfma_f32_16x16x32_bf16 v[60:63], v[100:103], v[156:159], v[60:63]
    v_mfma_f32_16x16x32_bf16 v[36:39], v[96:99], v[160:163], v[36:39]
    ds_read_b64_tr_b16 v[216:217], v14 offset:21536
    ds_read_b64_tr_b16 v[218:219], v14 offset:22432
    v_mfma_f32_16x16x32_bf16 v[64:67], v[100:103], v[160:163], v[64:67]
    v_mfma_f32_16x16x32_bf16 v[40:43], v[96:99], v[164:167], v[40:43]
    ds_read_b64_tr_b16 v[220:221], v14 offset:21568
    ds_read_b64_tr_b16 v[222:223], v14 offset:22464
    v_mfma_f32_16x16x32_bf16 v[68:71], v[100:103], v[164:167], v[68:71]
    v_mfma_f32_16x16x32_bf16 v[44:47], v[96:99], v[168:171], v[44:47]
    ds_read_b64_tr_b16 v[224:225], v14 offset:21600
    ds_read_b64_tr_b16 v[226:227], v14 offset:22496
    v_mfma_f32_16x16x32_bf16 v[72:75], v[100:103], v[168:171], v[72:75]
    v_mfma_f32_16x16x32_bf16 v[48:51], v[96:99], v[172:175], v[48:51]
    ds_read_b64_tr_b16 v[228:229], v14 offset:21632
    ds_read_b64_tr_b16 v[230:231], v14 offset:22528
    v_mfma_f32_16x16x32_bf16 v[76:79], v[100:103], v[172:175], v[76:79]
    v_mfma_f32_16x16x32_bf16 v[52:55], v[96:99], v[176:179], v[52:55]
    ds_read_b64_tr_b16 v[232:233], v14 offset:21664
    ds_read_b64_tr_b16 v[234:235], v14 offset:22560
    v_mfma_f32_16x16x32_bf16 v[80:83], v[100:103], v[176:179], v[80:83]
    v_mfma_f32_16x16x32_bf16 v[56:59], v[96:99], v[180:183], v[56:59]
    ds_read_b64_tr_b16 v[236:237], v14 offset:21696
    ds_read_b64_tr_b16 v[238:239], v14 offset:22592
    v_mfma_f32_16x16x32_bf16 v[84:87], v[100:103], v[180:183], v[84:87]
    s_waitcnt lgkmcnt(0)
    s_barrier
    ds_read_b128 v[88:91], v8 offset:8192
    ds_read_b128 v[92:95], v10 offset:8192
    ds_read_b128 v[96:99], v9 offset:8192
    ds_read_b128 v[100:103], v11 offset:8192
    v_mfma_f32_16x16x32_bf16 v[32:35], v[104:107], v[184:187], v[32:35]
    ds_read_b64_tr_b16 v[128:129], v14 offset:28672
    ds_read_b64_tr_b16 v[130:131], v14 offset:29568
    v_mfma_f32_16x16x32_bf16 v[60:63], v[108:111], v[184:187], v[60:63]
    v_mfma_f32_16x16x32_bf16 v[36:39], v[104:107], v[188:191], v[36:39]
    ds_read_b64_tr_b16 v[132:133], v14 offset:28704
    ds_read_b64_tr_b16 v[134:135], v14 offset:29600
    v_mfma_f32_16x16x32_bf16 v[64:67], v[108:111], v[188:191], v[64:67]
    v_mfma_f32_16x16x32_bf16 v[40:43], v[104:107], v[192:195], v[40:43]
    ds_read_b64_tr_b16 v[136:137], v14 offset:28736
    ds_read_b64_tr_b16 v[138:139], v14 offset:29632
    v_mfma_f32_16x16x32_bf16 v[68:71], v[108:111], v[192:195], v[68:71]
    v_mfma_f32_16x16x32_bf16 v[44:47], v[104:107], v[196:199], v[44:47]
    ds_read_b64_tr_b16 v[140:141], v14 offset:28768
    ds_read_b64_tr_b16 v[142:143], v14 offset:29664
    v_mfma_f32_16x16x32_bf16 v[72:75], v[108:111], v[196:199], v[72:75]
    v_mfma_f32_16x16x32_bf16 v[48:51], v[104:107], v[200:203], v[48:51]
    ds_read_b64_tr_b16 v[144:145], v14 offset:28800
    ds_read_b64_tr_b16 v[146:147], v14 offset:29696
    v_mfma_f32_16x16x32_bf16 v[76:79], v[108:111], v[200:203], v[76:79]
    v_mfma_f32_16x16x32_bf16 v[52:55], v[104:107], v[204:207], v[52:55]
    ds_read_b64_tr_b16 v[148:149], v14 offset:28832
    ds_read_b64_tr_b16 v[150:151], v14 offset:29728
    v_mfma_f32_16x16x32_bf16 v[80:83], v[108:111], v[204:207], v[80:83]
    v_mfma_f32_16x16x32_bf16 v[56:59], v[104:107], v[208:211], v[56:59]
    ds_read_b64_tr_b16 v[152:153], v14 offset:28864
    ds_read_b64_tr_b16 v[154:155], v14 offset:29760
    v_mfma_f32_16x16x32_bf16 v[84:87], v[108:111], v[208:211], v[84:87]
    v_mfma_f32_16x16x32_bf16 v[32:35], v[112:115], v[212:215], v[32:35]
    ds_read_b64_tr_b16 v[156:157], v14 offset:35840
    ds_read_b64_tr_b16 v[158:159], v14 offset:36736
    v_mfma_f32_16x16x32_bf16 v[60:63], v[116:119], v[212:215], v[60:63]
    v_mfma_f32_16x16x32_bf16 v[36:39], v[112:115], v[216:219], v[36:39]
    ds_read_b64_tr_b16 v[160:161], v14 offset:35872
    ds_read_b64_tr_b16 v[162:163], v14 offset:36768
    v_mfma_f32_16x16x32_bf16 v[64:67], v[116:119], v[216:219], v[64:67]
    v_mfma_f32_16x16x32_bf16 v[40:43], v[112:115], v[220:223], v[40:43]
    ds_read_b64_tr_b16 v[164:165], v14 offset:35904
    ds_read_b64_tr_b16 v[166:167], v14 offset:36800
    v_mfma_f32_16x16x32_bf16 v[68:71], v[116:119], v[220:223], v[68:71]
    v_mfma_f32_16x16x32_bf16 v[44:47], v[112:115], v[224:227], v[44:47]
    ds_read_b64_tr_b16 v[168:169], v14 offset:35936
    ds_read_b64_tr_b16 v[170:171], v14 offset:36832
    v_mfma_f32_16x16x32_bf16 v[72:75], v[116:119], v[224:227], v[72:75]
    v_mfma_f32_16x16x32_bf16 v[48:51], v[112:115], v[228:231], v[48:51]
    ds_read_b64_tr_b16 v[172:173], v14 offset:35968
    ds_read_b64_tr_b16 v[174:175], v14 offset:36864
    v_mfma_f32_16x16x32_bf16 v[76:79], v[116:119], v[228:231], v[76:79]
    v_mfma_f32_16x16x32_bf16 v[52:55], v[112:115], v[232:235], v[52:55]
    ds_read_b64_tr_b16 v[176:177], v14 offset:36000
    ds_read_b64_tr_b16 v[178:179], v14 offset:36896
    v_mfma_f32_16x16x32_bf16 v[80:83], v[116:119], v[232:235], v[80:83]
    v_mfma_f32_16x16x32_bf16 v[56:59], v[112:115], v[236:239], v[56:59]
    ds_read_b64_tr_b16 v[180:181], v14 offset:36032
    ds_read_b64_tr_b16 v[182:183], v14 offset:36928
    v_mfma_f32_16x16x32_bf16 v[84:87], v[116:119], v[236:239], v[84:87]
    s_waitcnt lgkmcnt(0)
    s_barrier
    ds_read_b128 v[104:107], v8 offset:0
    ds_read_b128 v[108:111], v10 offset:0
    ds_read_b128 v[112:115], v9 offset:0
    ds_read_b128 v[116:119], v11 offset:0
    v_mfma_f32_16x16x32_bf16 v[32:35], v[88:91], v[128:131], v[32:35]
    ds_read_b64_tr_b16 v[184:185], v14 offset:43008
    ds_read_b64_tr_b16 v[186:187], v14 offset:43904
    v_mfma_f32_16x16x32_bf16 v[60:63], v[92:95], v[128:131], v[60:63]
    v_mfma_f32_16x16x32_bf16 v[36:39], v[88:91], v[132:135], v[36:39]
    ds_read_b64_tr_b16 v[188:189], v14 offset:43040
    ds_read_b64_tr_b16 v[190:191], v14 offset:43936
    v_mfma_f32_16x16x32_bf16 v[64:67], v[92:95], v[132:135], v[64:67]
    v_mfma_f32_16x16x32_bf16 v[40:43], v[88:91], v[136:139], v[40:43]
    ds_read_b64_tr_b16 v[192:193], v14 offset:43072
    ds_read_b64_tr_b16 v[194:195], v14 offset:43968
    v_mfma_f32_16x16x32_bf16 v[68:71], v[92:95], v[136:139], v[68:71]
    v_mfma_f32_16x16x32_bf16 v[44:47], v[88:91], v[140:143], v[44:47]
    ds_read_b64_tr_b16 v[196:197], v14 offset:43104
    ds_read_b64_tr_b16 v[198:199], v14 offset:44000
    v_mfma_f32_16x16x32_bf16 v[72:75], v[92:95], v[140:143], v[72:75]
    v_mfma_f32_16x16x32_bf16 v[48:51], v[88:91], v[144:147], v[48:51]
    ds_read_b64_tr_b16 v[200:201], v14 offset:43136
    ds_read_b64_tr_b16 v[202:203], v14 offset:44032
    v_mfma_f32_16x16x32_bf16 v[76:79], v[92:95], v[144:147], v[76:79]
    v_mfma_f32_16x16x32_bf16 v[52:55], v[88:91], v[148:151], v[52:55]
    ds_read_b64_tr_b16 v[204:205], v14 offset:43168
    ds_read_b64_tr_b16 v[206:207], v14 offset:44064
    v_mfma_f32_16x16x32_bf16 v[80:83], v[92:95], v[148:151], v[80:83]
    v_mfma_f32_16x16x32_bf16 v[56:59], v[88:91], v[152:155], v[56:59]
    ds_read_b64_tr_b16 v[208:209], v14 offset:43200
    ds_read_b64_tr_b16 v[210:211], v14 offset:44096
    v_mfma_f32_16x16x32_bf16 v[84:87], v[92:95], v[152:155], v[84:87]
    v_mfma_f32_16x16x32_bf16 v[32:35], v[96:99], v[156:159], v[32:35]
    ds_read_b64_tr_b16 v[212:213], v14 offset:50176
    ds_read_b64_tr_b16 v[214:215], v14 offset:51072
    v_mfma_f32_16x16x32_bf16 v[60:63], v[100:103], v[156:159], v[60:63]
    v_mfma_f32_16x16x32_bf16 v[36:39], v[96:99], v[160:163], v[36:39]
    ds_read_b64_tr_b16 v[216:217], v14 offset:50208
    ds_read_b64_tr_b16 v[218:219], v14 offset:51104
    v_mfma_f32_16x16x32_bf16 v[64:67], v[100:103], v[160:163], v[64:67]
    v_mfma_f32_16x16x32_bf16 v[40:43], v[96:99], v[164:167], v[40:43]
    ds_read_b64_tr_b16 v[220:221], v14 offset:50240
    ds_read_b64_tr_b16 v[222:223], v14 offset:51136
    v_mfma_f32_16x16x32_bf16 v[68:71], v[100:103], v[164:167], v[68:71]
    v_mfma_f32_16x16x32_bf16 v[44:47], v[96:99], v[168:171], v[44:47]
    ds_read_b64_tr_b16 v[224:225], v14 offset:50272
    ds_read_b64_tr_b16 v[226:227], v14 offset:51168
    v_mfma_f32_16x16x32_bf16 v[72:75], v[100:103], v[168:171], v[72:75]
    v_mfma_f32_16x16x32_bf16 v[48:51], v[96:99], v[172:175], v[48:51]
    ds_read_b64_tr_b16 v[228:229], v14 offset:50304
    ds_read_b64_tr_b16 v[230:231], v14 offset:51200
    v_mfma_f32_16x16x32_bf16 v[76:79], v[100:103], v[172:175], v[76:79]
    v_mfma_f32_16x16x32_bf16 v[52:55], v[96:99], v[176:179], v[52:55]
    ds_read_b64_tr_b16 v[232:233], v14 offset:50336
    ds_read_b64_tr_b16 v[234:235], v14 offset:51232
    v_mfma_f32_16x16x32_bf16 v[80:83], v[100:103], v[176:179], v[80:83]
    v_mfma_f32_16x16x32_bf16 v[56:59], v[96:99], v[180:183], v[56:59]
    ds_read_b64_tr_b16 v[236:237], v14 offset:50368
    ds_read_b64_tr_b16 v[238:239], v14 offset:51264
    v_mfma_f32_16x16x32_bf16 v[84:87], v[100:103], v[180:183], v[84:87]
    s_waitcnt lgkmcnt(0)
    v_mfma_f32_16x16x32_bf16 v[32:35], v[104:107], v[184:187], v[32:35]
    v_mfma_f32_16x16x32_bf16 v[60:63], v[108:111], v[184:187], v[60:63]
    v_mfma_f32_16x16x32_bf16 v[36:39], v[104:107], v[188:191], v[36:39]
    v_mfma_f32_16x16x32_bf16 v[64:67], v[108:111], v[188:191], v[64:67]
    v_mfma_f32_16x16x32_bf16 v[40:43], v[104:107], v[192:195], v[40:43]
    v_mfma_f32_16x16x32_bf16 v[68:71], v[108:111], v[192:195], v[68:71]
    v_mfma_f32_16x16x32_bf16 v[44:47], v[104:107], v[196:199], v[44:47]
    v_mfma_f32_16x16x32_bf16 v[72:75], v[108:111], v[196:199], v[72:75]
    v_mfma_f32_16x16x32_bf16 v[48:51], v[104:107], v[200:203], v[48:51]
    v_mfma_f32_16x16x32_bf16 v[76:79], v[108:111], v[200:203], v[76:79]
    v_mfma_f32_16x16x32_bf16 v[52:55], v[104:107], v[204:207], v[52:55]
    v_mfma_f32_16x16x32_bf16 v[80:83], v[108:111], v[204:207], v[80:83]
    v_mfma_f32_16x16x32_bf16 v[56:59], v[104:107], v[208:211], v[56:59]
    v_mfma_f32_16x16x32_bf16 v[84:87], v[108:111], v[208:211], v[84:87]
    v_mfma_f32_16x16x32_bf16 v[32:35], v[112:115], v[212:215], v[32:35]
    v_mfma_f32_16x16x32_bf16 v[60:63], v[116:119], v[212:215], v[60:63]
    v_mfma_f32_16x16x32_bf16 v[36:39], v[112:115], v[216:219], v[36:39]
    v_mfma_f32_16x16x32_bf16 v[64:67], v[116:119], v[216:219], v[64:67]
    v_mfma_f32_16x16x32_bf16 v[40:43], v[112:115], v[220:223], v[40:43]
    v_mfma_f32_16x16x32_bf16 v[68:71], v[116:119], v[220:223], v[68:71]
    v_mfma_f32_16x16x32_bf16 v[44:47], v[112:115], v[224:227], v[44:47]
    v_mfma_f32_16x16x32_bf16 v[72:75], v[116:119], v[224:227], v[72:75]
    v_mfma_f32_16x16x32_bf16 v[48:51], v[112:115], v[228:231], v[48:51]
    v_mfma_f32_16x16x32_bf16 v[76:79], v[116:119], v[228:231], v[76:79]
    v_mfma_f32_16x16x32_bf16 v[52:55], v[112:115], v[232:235], v[52:55]
    v_mfma_f32_16x16x32_bf16 v[80:83], v[116:119], v[232:235], v[80:83]
    v_mfma_f32_16x16x32_bf16 v[56:59], v[112:115], v[236:239], v[56:59]
    v_mfma_f32_16x16x32_bf16 v[84:87], v[116:119], v[236:239], v[84:87]
    s_nop 7
    v_cvt_pk_bf16_f32 v32, v32, v33
    v_cvt_pk_bf16_f32 v33, v34, v35
    v_cvt_pk_bf16_f32 v34, v60, v61
    v_cvt_pk_bf16_f32 v35, v62, v63
    buffer_store_dwordx4 v[32:35], v20, s[4:7], s31 offen
    v_cvt_pk_bf16_f32 v36, v36, v37
    v_cvt_pk_bf16_f32 v37, v38, v39
    v_cvt_pk_bf16_f32 v38, v64, v65
    v_cvt_pk_bf16_f32 v39, v66, v67
    buffer_store_dwordx4 v[36:39], v21, s[4:7], s31 offen
    v_cvt_pk_bf16_f32 v40, v40, v41
    v_cvt_pk_bf16_f32 v41, v42, v43
    v_cvt_pk_bf16_f32 v42, v68, v69
    v_cvt_pk_bf16_f32 v43, v70, v71
    buffer_store_dwordx4 v[40:43], v22, s[4:7], s31 offen
    v_cvt_pk_bf16_f32 v44, v44, v45
    v_cvt_pk_bf16_f32 v45, v46, v47
    v_cvt_pk_bf16_f32 v46, v72, v73
    v_cvt_pk_bf16_f32 v47, v74, v75
    buffer_store_dwordx4 v[44:47], v23, s[4:7], s31 offen
    v_cvt_pk_bf16_f32 v48, v48, v49
    v_cvt_pk_bf16_f32 v49, v50, v51
    v_cvt_pk_bf16_f32 v50, v76, v77
    v_cvt_pk_bf16_f32 v51, v78, v79
    buffer_store_dwordx4 v[48:51], v24, s[4:7], s31 offen
    v_cvt_pk_bf16_f32 v52, v52, v53
    v_cvt_pk_bf16_f32 v53, v54, v55
    v_cvt_pk_bf16_f32 v54, v80, v81
    v_cvt_pk_bf16_f32 v55, v82, v83
    buffer_store_dwordx4 v[52:55], v25, s[4:7], s31 offen
    v_cvt_pk_bf16_f32 v56, v56, v57
    v_cvt_pk_bf16_f32 v57, v58, v59
    v_cvt_pk_bf16_f32 v58, v84, v85
    v_cvt_pk_bf16_f32 v59, v86, v87
    buffer_store_dwordx4 v[56:59], v26, s[4:7], s31 offen
    s_endpgm
prep_kernel_misc:
    s_mov_b32 s54, 1835008
    s_mov_b32 s55, 0x20000
    s_mov_b32 s62, 896
    s_mov_b32 s63, 0x20000
    s_mul_i32 s35, s33, 14336
    s_waitcnt lgkmcnt(0)
    s_cmp_ge_u32 s17, 16
    s_cselect_b32 s8, s48, s44
    s_cselect_b32 s9, s49, s45
    s_cselect_b32 s12, s50, s46
    s_cselect_b32 s13, s51, s47
    s_cselect_b64 vcc, -1, 0
    s_bitcmp1_b32 s2, 4
    s_cbranch_scc1 prep_kernel_nox
    s_mov_b32 exec_hi, 0x00ffffff
    s_mov_b32 m0, 143360
    s_add_u32 s22, s35, 0
    buffer_load_dwordx4 v1, s[52:55], s22 offen lds
    s_mov_b32 m0, 144272
    s_add_u32 s22, s35, 896
    buffer_load_dwordx4 v1, s[52:55], s22 offen lds
    s_mov_b32 m0, 145184
    s_add_u32 s22, s35, 1792
    buffer_load_dwordx4 v1, s[52:55], s22 offen lds
    s_mov_b32 m0, 146096
    s_add_u32 s22, s35, 2688
    buffer_load_dwordx4 v1, s[52:55], s22 offen lds
    s_mov_b32 m0, 147008
    s_add_u32 s22, s35, 3584
    buffer_load_dwordx4 v1, s[52:55], s22 offen lds
    s_mov_b32 m0, 147920
    s_add_u32 s22, s35, 4480
    buffer_load_dwordx4 v1, s[52:55], s22 offen lds
    s_mov_b32 m0, 148832
    s_add_u32 s22, s35, 5376
    buffer_load_dwordx4 v1, s[52:55], s22 offen lds
    s_mov_b32 m0, 149744
    s_add_u32 s22, s35, 6272
    buffer_load_dwordx4 v1, s[52:55], s22 offen lds
    s_mov_b32 m0, 150656
    s_add_u32 s22, s35, 7168
    buffer_load_dwordx4 v1, s[52:55], s22 offen lds
    s_mov_b32 m0, 151568
    s_add_u32 s22, s35, 8064
    buffer_load_dwordx4 v1, s[52:55], s22 offen lds
    s_mov_b32 m0, 152480
    s_add_u32 s22, s35, 8960
    buffer_load_dwordx4 v1, s[52:55], s22 offen lds
    s_mov_b32 m0, 153392
    s_add_u32 s22, s35, 9856
    buffer_load_dwordx4 v1, s[52:55], s22 offen lds
    s_mov_b32 m0, 154304
    s_add_u32 s22, s35, 10752
    buffer_load_dwordx4 v1, s[52:55], s22 offen lds
    s_mov_b32 m0, 155216
    s_add_u32 s22, s35, 11648
    buffer_load_dwordx4 v1, s[52:55], s22 offen lds
    s_mov_b32 m0, 156128
    s_add_u32 s22, s35, 12544
    buffer_load_dwordx4 v1, s[52:55], s22 offen lds
    s_mov_b32 m0, 157040
    s_add_u32 s22, s35, 13440
    buffer_load_dwordx4 v1, s[52:55], s22 offen lds
    s_mov_b32 m0, 157952
    s_nop 0
    buffer_load_dwordx4 v1, s[60:63], 0 offen lds
    s_mov_b64 exec, -1
prep_kernel_nox:
    v_add_u32 v5, 0, v0
    v_mul_u32_u24 v6, 4682, v5
    v_lshrrev_b32 v6, 16, v6
    v_mul_u32_u24 v7, 14, v6
    v_sub_u32 v5, v5, v7
    v_lshlrev_b32 v5, 4, v5
    v_mul_u32_u24 v6, 896, v6
    v_add_u32 v5, v5, v6
    v_add_u32 v6, 0, v4
    v_cndmask_b32 v20, v6, v5, vcc
    v_add_u32 v5, 64, v0
    v_mul_u32_u24 v6, 4682, v5
    v_lshrrev_b32 v6, 16, v6
    v_mul_u32_u24 v7, 14, v6
    v_sub_u32 v5, v5, v7
    v_lshlrev_b32 v5, 4, v5
    v_mul_u32_u24 v6, 896, v6
    v_add_u32 v5, v5, v6
    v_add_u32 v6, 131072, v4
    v_cndmask_b32 v21, v6, v5, vcc
    v_add_u32 v5, 128, v0
    v_mul_u32_u24 v6, 4682, v5
    v_lshrrev_b32 v6, 16, v6
    v_mul_u32_u24 v7, 14, v6
    v_sub_u32 v5, v5, v7
    v_lshlrev_b32 v5, 4, v5
    v_mul_u32_u24 v6, 896, v6
    v_add_u32 v5, v5, v6
    v_add_u32 v6, 262144, v4
    v_cndmask_b32 v22, v6, v5, vcc
    v_add_u32 v5, 192, v0
    v_mul_u32_u24 v6, 4682, v5
    v_lshrrev_b32 v6, 16, v6
    v_mul_u32_u24 v7, 14, v6
    v_sub_u32 v5, v5, v7
    v_lshlrev_b32 v5, 4, v5
    v_mul_u32_u24 v6, 896, v6
    v_add_u32 v5, v5, v6
    v_add_u32 v6, 393216, v4
    v_cndmask_b32 v23, v6, v5, vcc
    v_add_u32 v5, 256, v0
    v_mul_u32_u24 v6, 4682, v5
    v_lshrrev_b32 v6, 16, v6
    v_mul_u32_u24 v7, 14, v6
    v_sub_u32 v5, v5, v7
    v_lshlrev_b32 v5, 4, v5
    v_mul_u32_u24 v6, 896, v6
    v_add_u32 v5, v5, v6
    v_add_u32 v6, 524288, v4
    v_cndmask_b32 v24, v6, v5, vcc
    v_add_u32 v5, 320, v0
    v_mul_u32_u24 v6, 4682, v5
    v_lshrrev_b32 v6, 16, v6
    v_mul_u32_u24 v7, 14, v6
    v_sub_u32 v5, v5, v7
    v_lshlrev_b32 v5, 4, v5
    v_mul_u32_u24 v6, 896, v6
    v_add_u32 v5, v5, v6
    v_add_u32 v6, 655360, v4
    v_cndmask_b32 v25, v6, v5, vcc
    v_add_u32 v5, 384, v0
    v_mul_u32_u24 v6, 4682, v5
    v_lshrrev_b32 v6, 16, v6
    v_mul_u32_u24 v7, 14, v6
    v_sub_u32 v5, v5, v7
    v_lshlrev_b32 v5, 4, v5
    v_mul_u32_u24 v6, 896, v6
    v_add_u32 v5, v5, v6
    v_add_u32 v6, 786432, v4
    v_cndmask_b32 v26, v6, v5, vcc
    s_mul_i32 s27, s19, 229376
    s_mul_i32 s22, s20, 224
    s_add_u32 s27, s27, s22
    s_mul_i32 s22, s20, 917504
    s_add_u32 s22, s22, s21
    s_mov_b32 s23, 65536
    s_mov_b32 s24, 1024
    s_mov_b32 s30, 2048
    s_mov_b32 s31, 128
    s_cmp_ge_u32 s17, 16
    s_cselect_b32 s27, s27, s22
    s_cselect_b32 s23, 28672, s23
    s_cselect_b32 s24, 7168, s24
    s_cselect_b32 s30, 1024, s30
    s_cselect_b32 s31, 57344, s31
    s_add_u32 s29, s27, s23
    s_cmp_eq_u32 s18, 1
    s_cselect_b32 s22, s29, s27
    s_cselect_b32 s29, s27, s29
    s_mov_b32 s27, s22
    s_cselect_b32 s28, s24, 0
    s_cselect_b32 s34, 0, s24
    s_mul_i32 s25, s18, 1835008
    s_add_u32 s25, s25, s21
    s_add_u32 s22, s20, 0
    s_and_b32 s22, s22, 3
    s_lshl_b32 s23, s22, 16
    s_add_u32 s36, s25, s23
    s_lshl_b32 s40, s22, 10
    s_add_u32 s22, s20, 1
    s_and_b32 s22, s22, 3
    s_lshl_b32 s23, s22, 16
    s_add_u32 s37, s25, s23
    s_lshl_b32 s41, s22, 10
    s_add_u32 s22, s20, 2
    s_and_b32 s22, s22, 3
    s_lshl_b32 s23, s22, 16
    s_add_u32 s38, s25, s23
    s_lshl_b32 s42, s22, 10
    s_add_u32 s22, s20, 3
    s_and_b32 s22, s22, 3
    s_lshl_b32 s23, s22, 16
    s_add_u32 s39, s25, s23
    s_lshl_b32 s43, s22, 10
    s_add_u32 s27, s27, s31
    s_add_u32 s22, s28, 14336
    s_mov_b32 m0, s22
    s_add_u32 s22, s22, s30
    buffer_load_dwordx4 v20, s[12:15], s27 offen lds
    s_mov_b32 m0, s22
    s_add_u32 s22, s22, s30
    buffer_load_dwordx4 v21, s[12:15], s27 offen lds
    s_mov_b32 m0, s22
    s_add_u32 s22, s22, s30
    buffer_load_dwordx4 v22, s[12:15], s27 offen lds
    s_mov_b32 m0, s22
    s_add_u32 s22, s22, s30
    buffer_load_dwordx4 v23, s[12:15], s27 offen lds
    s_mov_b32 m0, s22
    s_add_u32 s22, s22, s30
    buffer_load_dwordx4 v24, s[12:15], s27 offen lds
    s_mov_b32 m0, s22
    s_add_u32 s22, s22, s30
    buffer_load_dwordx4 v25, s[12:15], s27 offen lds
    s_mov_b32 m0, s22
    s_add_u32 s22, s22, s30
    buffer_load_dwordx4 v26, s[12:15], s27 offen lds
    s_add_u32 m0, s40, 61440
    s_add_u32 s23, s36, 128
    buffer_load_dwordx4 v4, s[8:11], s23 offen lds
    s_add_u32 m0, s40, 73728
    s_add_u32 s23, s36, 262272
    buffer_load_dwordx4 v4, s[8:11], s23 offen lds
    s_add_u32 m0, s40, 86016
    s_add_u32 s23, s36, 524416
    buffer_load_dwordx4 v4, s[8:11], s23 offen lds
    s_add_u32 m0, s40, 98304
    s_add_u32 s23, s36, 786560
    buffer_load_dwordx4 v4, s[8:11], s23 offen lds
    s_add_u32 m0, s40, 110592
    s_add_u32 s23, s36, 1048704
    buffer_load_dwordx4 v4, s[8:11], s23 offen lds
    s_add_u32 m0, s40, 122880
    s_add_u32 s23, s36, 1310848
    buffer_load_dwordx4 v4, s[8:11], s23 offen lds
    s_add_u32 m0, s40, 135168
    s_add_u32 s23, s36, 1572992
    buffer_load_dwordx4 v4, s[8:11], s23 offen lds
    s_add_u32 m0, s41, 61440
    s_add_u32 s23, s37, 128
    buffer_load_dwordx4 v4, s[8:11], s23 offen lds
    s_add_u32 m0, s41, 73728
    s_add_u32 s23, s37, 262272
    buffer_load_dwordx4 v4, s[8:11], s23 offen lds
    s_add_u32 m0, s41, 86016
    s_add_u32 s23, s37, 524416
    buffer_load_dwordx4 v4, s[8:11], s23 offen lds
    s_add_u32 m0, s41, 98304
    s_add_u32 s23, s37, 786560
    buffer_load_dwordx4 v4, s[8:11], s23 offen lds
    s_add_u32 m0, s41, 110592
    s_add_u32 s23, s37, 1048704
    buffer_load_dwordx4 v4, s[8:11], s23 offen lds
    s_add_u32 m0, s41, 122880
    s_add_u32 s23, s37, 1310848
    buffer_load_dwordx4 v4, s[8:11], s23 offen lds
    s_add_u32 m0, s41, 135168
    s_add_u32 s23, s37, 1572992
    buffer_load_dwordx4 v4, s[8:11], s23 offen lds
    s_add_u32 s29, s29, s31
    s_add_u32 s22, s34, 14336
    s_mov_b32 m0, s22
    s_add_u32 s22, s22, s30
    buffer_load_dwordx4 v20, s[12:15], s29 offen lds
    s_mov_b32 m0, s22
    s_add_u32 s22, s22, s30
    buffer_load_dwordx4 v21, s[12:15], s29 offen lds
    s_mov_b32 m0, s22
    s_add_u32 s22, s22, s30
    buffer_load_dwordx4 v22, s[12:15], s29 offen lds
    s_mov_b32 m0, s22
    s_add_u32 s22, s22, s30
    buffer_load_dwordx4 v23, s[12:15], s29 offen lds
    s_mov_b32 m0, s22
    s_add_u32 s22, s22, s30
    buffer_load_dwordx4 v24, s[12:15], s29 offen lds
    s_mov_b32 m0, s22
    s_add_u32 s22, s22, s30
    buffer_load_dwordx4 v25, s[12:15], s29 offen lds
    s_mov_b32 m0, s22
    s_add_u32 s22, s22, s30
    buffer_load_dwordx4 v26, s[12:15], s29 offen lds
    s_add_u32 m0, s42, 61440
    s_add_u32 s23, s38, 128
    buffer_load_dwordx4 v4, s[8:11], s23 offen lds
    s_add_u32 m0, s42, 73728
    s_add_u32 s23, s38, 262272
    buffer_load_dwordx4 v4, s[8:11], s23 offen lds
    s_add_u32 m0, s42, 86016
    s_add_u32 s23, s38, 524416
    buffer_load_dwordx4 v4, s[8:11], s23 offen lds
    s_add_u32 m0, s42, 98304
    s_add_u32 s23, s38, 786560
    buffer_load_dwordx4 v4, s[8:11], s23 offen lds
    s_add_u32 m0, s42, 110592
    s_add_u32 s23, s38, 1048704
    buffer_load_dwordx4 v4, s[8:11], s23 offen lds
    s_add_u32 m0, s42, 122880
    s_add_u32 s23, s38, 1310848
    buffer_load_dwordx4 v4, s[8:11], s23 offen lds
    s_add_u32 m0, s42, 135168
    s_add_u32 s23, s38, 1572992
    buffer_load_dwordx4 v4, s[8:11], s23 offen lds
    s_add_u32 m0, s43, 61440
    s_add_u32 s23, s39, 128
    buffer_load_dwordx4 v4, s[8:11], s23 offen lds
    s_add_u32 m0, s43, 73728
    s_add_u32 s23, s39, 262272
    buffer_load_dwordx4 v4, s[8:11], s23 offen lds
    s_add_u32 m0, s43, 86016
    s_add_u32 s23, s39, 524416
    buffer_load_dwordx4 v4, s[8:11], s23 offen lds
    s_add_u32 m0, s43, 98304
    s_add_u32 s23, s39, 786560
    buffer_load_dwordx4 v4, s[8:11], s23 offen lds
    s_add_u32 m0, s43, 110592
    s_add_u32 s23, s39, 1048704
    buffer_load_dwordx4 v4, s[8:11], s23 offen lds
    s_add_u32 m0, s43, 122880
    s_add_u32 s23, s39, 1310848
    buffer_load_dwordx4 v4, s[8:11], s23 offen lds
    s_add_u32 m0, s43, 135168
    s_add_u32 s23, s39, 1572992
    buffer_load_dwordx4 v4, s[8:11], s23 offen lds
    s_barrier
    s_waitcnt vmcnt(42)
    s_add_u32 s27, s27, s31
    s_add_u32 s22, s28, 28672
    s_mov_b32 m0, s22
    s_add_u32 s22, s22, s30
    buffer_load_dwordx4 v20, s[12:15], s27 offen lds
    s_mov_b32 m0, s22
    s_add_u32 s22, s22, s30
    buffer_load_dwordx4 v21, s[12:15], s27 offen lds
    s_mov_b32 m0, s22
    s_add_u32 s22, s22, s30
    buffer_load_dwordx4 v22, s[12:15], s27 offen lds
    s_mov_b32 m0, s22
    s_add_u32 s22, s22, s30
    buffer_load_dwordx4 v23, s[12:15], s27 offen lds
    s_mov_b32 m0, s22
    s_add_u32 s22, s22, s30
    buffer_load_dwordx4 v24, s[12:15], s27 offen lds
    s_mov_b32 m0, s22
    s_add_u32 s22, s22, s30
    buffer_load_dwordx4 v25, s[12:15], s27 offen lds
    s_mov_b32 m0, s22
    s_add_u32 s22, s22, s30
    buffer_load_dwordx4 v26, s[12:15], s27 offen lds
    s_add_u32 m0, s40, 65536
    s_add_u32 s23, s36, 256
    buffer_load_dwordx4 v4, s[8:11], s23 offen lds
    s_add_u32 m0, s40, 77824
    s_add_u32 s23, s36, 262400
    buffer_load_dwordx4 v4, s[8:11], s23 offen lds
    s_add_u32 m0, s40, 90112
    s_add_u32 s23, s36, 524544
    buffer_load_dwordx4 v4, s[8:11], s23 offen lds
    s_add_u32 m0, s40, 102400
    s_add_u32 s23, s36, 786688
    buffer_load_dwordx4 v4, s[8:11], s23 offen lds
    s_add_u32 m0, s40, 114688
    s_add_u32 s23, s36, 1048832
    buffer_load_dwordx4 v4, s[8:11], s23 offen lds
    s_add_u32 m0, s40, 126976
    s_add_u32 s23, s36, 1310976
    buffer_load_dwordx4 v4, s[8:11], s23 offen lds
    s_add_u32 m0, s40, 139264
    s_add_u32 s23, s36, 1573120
    buffer_load_dwordx4 v4, s[8:11], s23 offen lds
    s_add_u32 m0, s41, 65536
    s_add_u32 s23, s37, 256
    buffer_load_dwordx4 v4, s[8:11], s23 offen lds
    s_add_u32 m0, s41, 77824
    s_add_u32 s23, s37, 262400
    buffer_load_dwordx4 v4, s[8:11], s23 offen lds
    s_add_u32 m0, s41, 90112
    s_add_u32 s23, s37, 524544
    buffer_load_dwordx4 v4, s[8:11], s23 offen lds
    s_add_u32 m0, s41, 102400
    s_add_u32 s23, s37, 786688
    buffer_load_dwordx4 v4, s[8:11], s23 offen lds
    s_add_u32 m0, s41, 114688
    s_add_u32 s23, s37, 1048832
    buffer_load_dwordx4 v4, s[8:11], s23 offen lds
    s_add_u32 m0, s41, 126976
    s_add_u32 s23, s37, 1310976
    buffer_load_dwordx4 v4, s[8:11], s23 offen lds
    s_add_u32 m0, s41, 139264
    s_add_u32 s23, s37, 1573120
    buffer_load_dwordx4 v4, s[8:11], s23 offen lds
    s_waitcnt vmcnt(21)
    s_barrier
    s_add_u32 s29, s29, s31
    s_add_u32 s22, s34, 28672
    s_mov_b32 m0, s22
    s_add_u32 s22, s22, s30
    buffer_load_dwordx4 v20, s[12:15], s29 offen lds
    s_mov_b32 m0, s22
    s_add_u32 s22, s22, s30
    buffer_load_dwordx4 v21, s[12:15], s29 offen lds
    s_mov_b32 m0, s22
    s_add_u32 s22, s22, s30
    buffer_load_dwordx4 v22, s[12:15], s29 offen lds
    s_mov_b32 m0, s22
    s_add_u32 s22, s22, s30
    buffer_load_dwordx4 v23, s[12:15], s29 offen lds
    s_mov_b32 m0, s22
    s_add_u32 s22, s22, s30
    buffer_load_dwordx4 v24, s[12:15], s29 offen lds
    s_mov_b32 m0, s22
    s_add_u32 s22, s22, s30
    buffer_load_dwordx4 v25, s[12:15], s29 offen lds
    s_mov_b32 m0, s22
    s_add_u32 s22, s22, s30
    buffer_load_dwordx4 v26, s[12:15], s29 offen lds
    s_add_u32 m0, s42, 65536
    s_add_u32 s23, s38, 256
    buffer_load_dwordx4 v4, s[8:11], s23 offen lds
    s_add_u32 m0, s42, 77824
    s_add_u32 s23, s38, 262400
    buffer_load_dwordx4 v4, s[8:11], s23 offen lds
    s_add_u32 m0, s42, 90112
    s_add_u32 s23, s38, 524544
    buffer_load_dwordx4 v4, s[8:11], s23 offen lds
    s_add_u32 m0, s42, 102400
    s_add_u32 s23, s38, 786688
    buffer_load_dwordx4 v4, s[8:11], s23 offen lds
    s_add_u32 m0, s42, 114688
    s_add_u32 s23, s38, 1048832
    buffer_load_dwordx4 v4, s[8:11], s23 offen lds
    s_add_u32 m0, s42, 126976
    s_add_u32 s23, s38, 1310976
    buffer_load_dwordx4 v4, s[8:11], s23 offen lds
    s_add_u32 m0, s42, 139264
    s_add_u32 s23, s38, 1573120
    buffer_load_dwordx4 v4, s[8:11], s23 offen lds
    s_add_u32 m0, s43, 65536
    s_add_u32 s23, s39, 256
    buffer_load_dwordx4 v4, s[8:11], s23 offen lds
    s_add_u32 m0, s43, 77824
    s_add_u32 s23, s39, 262400
    buffer_load_dwordx4 v4, s[8:11], s23 offen lds
    s_add_u32 m0, s43, 90112
    s_add_u32 s23, s39, 524544
    buffer_load_dwordx4 v4, s[8:11], s23 offen lds
    s_add_u32 m0, s43, 102400
    s_add_u32 s23, s39, 786688
    buffer_load_dwordx4 v4, s[8:11], s23 offen lds
    s_add_u32 m0, s43, 114688
    s_add_u32 s23, s39, 1048832
    buffer_load_dwordx4 v4, s[8:11], s23 offen lds
    s_add_u32 m0, s43, 126976
    s_add_u32 s23, s39, 1310976
    buffer_load_dwordx4 v4, s[8:11], s23 offen lds
    s_add_u32 m0, s43, 139264
    s_add_u32 s23, s39, 1573120
    buffer_load_dwordx4 v4, s[8:11], s23 offen lds
    s_add_u32 s27, s27, s31
    s_add_u32 s22, s28, 43008
    s_mov_b32 m0, s22
    s_add_u32 s22, s22, s30
    buffer_load_dwordx4 v20, s[12:15], s27 offen lds
    s_mov_b32 m0, s22
    s_add_u32 s22, s22, s30
    buffer_load_dwordx4 v21, s[12:15], s27 offen lds
    s_mov_b32 m0, s22
    s_add_u32 s22, s22, s30
    buffer_load_dwordx4 v22, s[12:15], s27 offen lds
    s_mov_b32 m0, s22
    s_add_u32 s22, s22, s30
    buffer_load_dwordx4 v23, s[12:15], s27 offen lds
    s_mov_b32 m0, s22
    s_add_u32 s22, s22, s30
    buffer_load_dwordx4 v24, s[12:15], s27 offen lds
    s_mov_b32 m0, s22
    s_add_u32 s22, s22, s30
    buffer_load_dwordx4 v25, s[12:15], s27 offen lds
    s_mov_b32 m0, s22
    s_add_u32 s22, s22, s30
    buffer_load_dwordx4 v26, s[12:15], s27 offen lds
    s_add_u32 m0, s40, 57344
    s_add_u32 s23, s36, 384
    buffer_load_dwordx4 v4, s[8:11], s23 offen lds
    s_add_u32 m0, s40, 69632
    s_add_u32 s23, s36, 262528
    buffer_load_dwordx4 v4, s[8:11], s23 offen lds
    s_add_u32 m0, s40, 81920
    s_add_u32 s23, s36, 524672
    buffer_load_dwordx4 v4, s[8:11], s23 offen lds
    s_add_u32 m0, s40, 94208
    s_add_u32 s23, s36, 786816
    buffer_load_dwordx4 v4, s[8:11], s23 offen lds
    s_add_u32 m0, s40, 106496
    s_add_u32 s23, s36, 1048960
    buffer_load_dwordx4 v4, s[8:11], s23 offen lds
    s_add_u32 m0, s40, 118784
    s_add_u32 s23, s36, 1311104
    buffer_load_dwordx4 v4, s[8:11], s23 offen lds
    s_add_u32 m0, s40, 131072
    s_add_u32 s23, s36, 1573248
    buffer_load_dwordx4 v4, s[8:11], s23 offen lds
    s_add_u32 m0, s41, 57344
    s_add_u32 s23, s37, 384
    buffer_load_dwordx4 v4, s[8:11], s23 offen lds
    s_add_u32 m0, s41, 69632
    s_add_u32 s23, s37, 262528
    buffer_load_dwordx4 v4, s[8:11], s23 offen lds
    s_add_u32 m0, s41, 81920
    s_add_u32 s23, s37, 524672
    buffer_load_dwordx4 v4, s[8:11], s23 offen lds
    s_add_u32 m0, s41, 94208
    s_add_u32 s23, s37, 786816
    buffer_load_dwordx4 v4, s[8:11], s23 offen lds
    s_add_u32 m0, s41, 106496
    s_add_u32 s23, s37, 1048960
    buffer_load_dwordx4 v4, s[8:11], s23 offen lds
    s_add_u32 m0, s41, 118784
    s_add_u32 s23, s37, 1311104
    buffer_load_dwordx4 v4, s[8:11], s23 offen lds
    s_add_u32 m0, s41, 131072
    s_add_u32 s23, s37, 1573248
    buffer_load_dwordx4 v4, s[8:11], s23 offen lds
    s_waitcnt vmcnt(21)
    s_barrier
    s_add_u32 s29, s29, s31
    s_add_u32 s22, s34, 43008
    s_mov_b32 m0, s22
    s_add_u32 s22, s22, s30
    buffer_load_dwordx4 v20, s[12:15], s29 offen lds
    s_mov_b32 m0, s22
    s_add_u32 s22, s22, s30
    buffer_load_dwordx4 v21, s[12:15], s29 offen lds
    s_mov_b32 m0, s22
    s_add_u32 s22, s22, s30
    buffer_load_dwordx4 v22, s[12:15], s29 offen lds
    s_mov_b32 m0, s22
    s_add_u32 s22, s22, s30
    buffer_load_dwordx4 v23, s[12:15], s29 offen lds
    s_mov_b32 m0, s22
    s_add_u32 s22, s22, s30
    buffer_load_dwordx4 v24, s[12:15], s29 offen lds
    s_mov_b32 m0, s22
    s_add_u32 s22, s22, s30
    buffer_load_dwordx4 v25, s[12:15], s29 offen lds
    s_mov_b32 m0, s22
    s_add_u32 s22, s22, s30
    buffer_load_dwordx4 v26, s[12:15], s29 offen lds
    s_add_u32 m0, s42, 57344
    s_add_u32 s23, s38, 384
    buffer_load_dwordx4 v4, s[8:11], s23 offen lds
    s_add_u32 m0, s42, 69632
    s_add_u32 s23, s38, 262528
    buffer_load_dwordx4 v4, s[8:11], s23 offen lds
    s_add_u32 m0, s42, 81920
    s_add_u32 s23, s38, 524672
    buffer_load_dwordx4 v4, s[8:11], s23 offen lds
    s_add_u32 m0, s42, 94208
    s_add_u32 s23, s38, 786816
    buffer_load_dwordx4 v4, s[8:11], s23 offen lds
    s_add_u32 m0, s42, 106496
    s_add_u32 s23, s38, 1048960
    buffer_load_dwordx4 v4, s[8:11], s23 offen lds
    s_add_u32 m0, s42, 118784
    s_add_u32 s23, s38, 1311104
    buffer_load_dwordx4 v4, s[8:11], s23 offen lds
    s_add_u32 m0, s42, 131072
    s_add_u32 s23, s38, 1573248
    buffer_load_dwordx4 v4, s[8:11], s23 offen lds
    s_add_u32 m0, s43, 57344
    s_add_u32 s23, s39, 384
    buffer_load_dwordx4 v4, s[8:11], s23 offen lds
    s_add_u32 m0, s43, 69632
    s_add_u32 s23, s39, 262528
    buffer_load_dwordx4 v4, s[8:11], s23 offen lds
    s_add_u32 m0, s43, 81920
    s_add_u32 s23, s39, 524672
    buffer_load_dwordx4 v4, s[8:11], s23 offen lds
    s_add_u32 m0, s43, 94208
    s_add_u32 s23, s39, 786816
    buffer_load_dwordx4 v4, s[8:11], s23 offen lds
    s_add_u32 m0, s43, 106496
    s_add_u32 s23, s39, 1048960
    buffer_load_dwordx4 v4, s[8:11], s23 offen lds
    s_add_u32 m0, s43, 118784
    s_add_u32 s23, s39, 1311104
    buffer_load_dwordx4 v4, s[8:11], s23 offen lds
    s_add_u32 m0, s43, 131072
    s_add_u32 s23, s39, 1573248
    buffer_load_dwordx4 v4, s[8:11], s23 offen lds
    s_waitcnt vmcnt(0)
    s_barrier
    s_bitcmp1_b32 s2, 4
    s_cbranch_scc1 prep_kernel_arm
    s_mov_b32 s17, s33
    s_mov_b32 s18, s35
    v_lshlrev_b32 v4, 4, v3
    v_add_u32 v4, 157952, v4
    v_mul_u32_u24 v5, 912, v2
    v_lshl_add_u32 v5, v3, 4, v5
    v_add_u32 v5, 143360, v5
    v_and_b32 v6, 8, v0
    v_and_b32 v7, 1, v0
    v_lshl_add_u32 v6, v7, 2, v6
    v_bfe_u32 v7, v0, 2, 1
    v_lshl_add_u32 v6, v7, 1, v6
    v_bfe_u32 v7, v0, 1, 1
    v_add_u32 v6, v6, v7
    v_mul_u32_u24 v6, 912, v6
    v_lshrrev_b32 v7, 1, v3
    v_lshl_add_u32 v6, v7, 5, v6
    v_and_b32 v7, 1, v3
    v_lshl_add_u32 v6, v7, 3, v6
    v_add_u32 v6, 143360, v6
    s_lshr_b32 s20, s17, 1
    s_mul_i32 s20, s20, 47104
    s_and_b32 s21, s17, 1
    s_mul_i32 s21, s21, 14336
    s_add_u32 s20, s20, s21
    s_add_u32 s20, s20, 42223616
    s_add_u32 s21, s18, 48402432
    s_waitcnt vmcnt(0)
    ds_read_b128 v[96:99], v5 offset:0
    ds_read_b128 v[100:103], v5 offset:64
    ds_read_b128 v[104:107], v5 offset:128
    ds_read_b128 v[108:111], v5 offset:192
    ds_read_b128 v[112:115], v5 offset:256
    ds_read_b128 v[116:119], v5 offset:320
    ds_read_b128 v[120:123], v5 offset:384
    ds_read_b128 v[124:127], v5 offset:448
    ds_read_b128 v[128:131], v5 offset:512
    ds_read_b128 v[132:135], v5 offset:576
    ds_read_b128 v[136:139], v5 offset:640
    ds_read_b128 v[140:143], v5 offset:704
    ds_read_b128 v[144:147], v5 offset:768
    ds_read_b128 v[148:151], v5 offset:832
    ds_read_b128 v[32:35], v4 offset:0
    ds_read_b128 v[36:39], v4 offset:64
    ds_read_b128 v[40:43], v4 offset:128
    ds_read_b128 v[44:47], v4 offset:192
    ds_read_b128 v[48:51], v4 offset:256
    ds_read_b128 v[52:55], v4 offset:320
    ds_read_b128 v[56:59], v4 offset:384
    ds_read_b128 v[60:63], v4 offset:448
    ds_read_b128 v[64:67], v4 offset:512
    ds_read_b128 v[68:71], v4 offset:576
    ds_read_b128 v[72:75], v4 offset:640
    ds_read_b128 v[76:79], v4 offset:704
    ds_read_b128 v[80:83], v4 offset:768
    ds_read_b128 v[84:87], v4 offset:832
    s_waitcnt lgkmcnt(0)
    ds_read2_b32 v[152:153], v6 offset0:0 offset1:4
    ds_read2_b32 v[154:155], v6 offset0:1 offset1:5
    buffer_store_dwordx4 v[96:99], v1, s[4:7], s20 offen offset:0 sc1
    ds_read2_b32 v[156:157], v6 offset0:16 offset1:20
    ds_read2_b32 v[158:159], v6 offset0:17 offset1:21
    buffer_store_dwordx4 v[100:103], v1, s[4:7], s20 offen offset:1024 sc1
    ds_read2_b32 v[160:161], v6 offset0:32 offset1:36
    ds_read2_b32 v[162:163], v6 offset0:33 offset1:37
    buffer_store_dwordx4 v[104:107], v1, s[4:7], s20 offen offset:2048 sc1
    ds_read2_b32 v[164:165], v6 offset0:48 offset1:52
    ds_read2_b32 v[166:167], v6 offset0:49 offset1:53
    buffer_store_dwordx4 v[108:111], v1, s[4:7], s20 offen offset:3072 sc1
    s_add_u32 s20, s20, 4096
    ds_read2_b32 v[168:169], v6 offset0:64 offset1:68
    ds_read2_b32 v[170:171], v6 offset0:65 offset1:69
    buffer_store_dwordx4 v[112:115], v1, s[4:7], s20 offen offset:0 sc1
    ds_read2_b32 v[172:173], v6 offset0:80 offset1:84
    ds_read2_b32 v[174:175], v6 offset0:81 offset1:85
    buffer_store_dwordx4 v[116:119], v1, s[4:7], s20 offen offset:1024 sc1
    ds_read2_b32 v[176:177], v6 offset0:96 offset1:100
    ds_read2_b32 v[178:179], v6 offset0:97 offset1:101
    buffer_store_dwordx4 v[120:123], v1, s[4:7], s20 offen offset:2048 sc1
    ds_read2_b32 v[180:181], v6 offset0:112 offset1:116
    ds_read2_b32 v[182:183], v6 offset0:113 offset1:117
    buffer_store_dwordx4 v[124:127], v1, s[4:7], s20 offen offset:3072 sc1
    s_add_u32 s20, s20, 4096
    ds_read2_b32 v[184:185], v6 offset0:128 offset1:132
    ds_read2_b32 v[186:187], v6 offset0:129 offset1:133
    buffer_store_dwordx4 v[128:131], v1, s[4:7], s20 offen offset:0 sc1
    ds_read2_b32 v[188:189], v6 offset0:144 offset1:148
    ds_read2_b32 v[190:191], v6 offset0:145 offset1:149
    buffer_store_dwordx4 v[132:135], v1, s[4:7], s20 offen offset:1024 sc1
    ds_read2_b32 v[192:193], v6 offset0:160 offset1:164
    ds_read2_b32 v[194:195], v6 offset0:161 offset1:165
    buffer_store_dwordx4 v[136:139], v1, s[4:7], s20 offen offset:2048 sc1
    ds_read2_b32 v[196:197], v6 offset0:176 offset1:180
    ds_read2_b32 v[198:199], v6 offset0:177 offset1:181
    buffer_store_dwordx4 v[140:143], v1, s[4:7], s20 offen offset:3072 sc1
    s_add_u32 s20, s20, 4096
    ds_read2_b32 v[200:201], v6 offset0:192 offset1:196
    ds_read2_b32 v[202:203], v6 offset0:193 offset1:197
    buffer_store_dwordx4 v[144:147], v1, s[4:7], s20 offen offset:0 sc1
    ds_read2_b32 v[204:205], v6 offset0:208 offset1:212
    ds_read2_b32 v[206:207], v6 offset0:209 offset1:213
    buffer_store_dwordx4 v[148:151], v1, s[4:7], s20 offen offset:1024 sc1
    v_mov_b32 v8, 0
    v_mov_b32 v9, 0
    v_dot2_f32_bf16 v8, v96, v32, v8
    v_dot2_f32_bf16 v9, v97, v33, v9
    v_dot2_f32_bf16 v8, v98, v34, v8
    v_dot2_f32_bf16 v9, v99, v35, v9
    v_dot2_f32_bf16 v8, v100, v36, v8
    v_dot2_f32_bf16 v9, v101, v37, v9
    v_dot2_f32_bf16 v8, v102, v38, v8
    v_dot2_f32_bf16 v9, v103, v39, v9
    v_dot2_f32_bf16 v8, v104, v40, v8
    v_dot2_f32_bf16 v9, v105, v41, v9
    v_dot2_f32_bf16 v8, v106, v42, v8
    v_dot2_f32_bf16 v9, v107, v43, v9
    v_dot2_f32_bf16 v8, v108, v44, v8
    v_dot2_f32_bf16 v9, v109, v45, v9
    v_dot2_f32_bf16 v8, v110, v46, v8
    v_dot2_f32_bf16 v9, v111, v47, v9
    v_dot2_f32_bf16 v8, v112, v48, v8
    v_dot2_f32_bf16 v9, v113, v49, v9
    v_dot2_f32_bf16 v8, v114, v50, v8
    v_dot2_f32_bf16 v9, v115, v51, v9
    v_dot2_f32_bf16 v8, v116, v52, v8
    v_dot2_f32_bf16 v9, v117, v53, v9
    v_dot2_f32_bf16 v8, v118, v54, v8
    v_dot2_f32_bf16 v9, v119, v55, v9
    v_dot2_f32_bf16 v8, v120, v56, v8
    v_dot2_f32_bf16 v9, v121, v57, v9
    v_dot2_f32_bf16 v8, v122, v58, v8
    v_dot2_f32_bf16 v9, v123, v59, v9
    v_dot2_f32_bf16 v8, v124, v60, v8
    v_dot2_f32_bf16 v9, v125, v61, v9
    v_dot2_f32_bf16 v8, v126, v62, v8
    v_dot2_f32_bf16 v9, v127, v63, v9
    v_dot2_f32_bf16 v8, v128, v64, v8
    v_dot2_f32_bf16 v9, v129, v65, v9
    v_dot2_f32_bf16 v8, v130, v66, v8
    v_dot2_f32_bf16 v9, v131, v67, v9
    v_dot2_f32_bf16 v8, v132, v68, v8
    v_dot2_f32_bf16 v9, v133, v69, v9
    v_dot2_f32_bf16 v8, v134, v70, v8
    v_dot2_f32_bf16 v9, v135, v71, v9
    v_dot2_f32_bf16 v8, v136, v72, v8
    v_dot2_f32_bf16 v9, v137, v73, v9
    v_dot2_f32_bf16 v8, v138, v74, v8
    v_dot2_f32_bf16 v9, v139, v75, v9
    v_dot2_f32_bf16 v8, v140, v76, v8
    v_dot2_f32_bf16 v9, v141, v77, v9
    v_dot2_f32_bf16 v8, v142, v78, v8
    v_dot2_f32_bf16 v9, v143, v79, v9
    v_dot2_f32_bf16 v8, v144, v80, v8
    v_dot2_f32_bf16 v9, v145, v81, v9
    v_dot2_f32_bf16 v8, v146, v82, v8
    v_dot2_f32_bf16 v9, v147, v83, v9
    v_dot2_f32_bf16 v8, v148, v84, v8
    v_dot2_f32_bf16 v9, v149, v85, v9
    v_dot2_f32_bf16 v8, v150, v86, v8
    v_dot2_f32_bf16 v9, v151, v87, v9
    s_waitcnt lgkmcnt(0)
    buffer_store_dwordx4 v[152:155], v1, s[4:7], s21 offen offset:0 sc1
    buffer_store_dwordx4 v[156:159], v1, s[4:7], s21 offen offset:1024 sc1
    buffer_store_dwordx4 v[160:163], v1, s[4:7], s21 offen offset:2048 sc1
    buffer_store_dwordx4 v[164:167], v1, s[4:7], s21 offen offset:3072 sc1
    s_add_u32 s21, s21, 4096
    buffer_store_dwordx4 v[168:171], v1, s[4:7], s21 offen offset:0 sc1
    buffer_store_dwordx4 v[172:175], v1, s[4:7], s21 offen offset:1024 sc1
    buffer_store_dwordx4 v[176:179], v1, s[4:7], s21 offen offset:2048 sc1
    buffer_store_dwordx4 v[180:183], v1, s[4:7], s21 offen offset:3072 sc1
    s_add_u32 s21, s21, 4096
    buffer_store_dwordx4 v[184:187], v1, s[4:7], s21 offen offset:0 sc1
    buffer_store_dwordx4 v[188:191], v1, s[4:7], s21 offen offset:1024 sc1
    buffer_store_dwordx4 v[192:195], v1, s[4:7], s21 offen offset:2048 sc1
    buffer_store_dwordx4 v[196:199], v1, s[4:7], s21 offen offset:3072 sc1
    s_add_u32 s21, s21, 4096
    buffer_store_dwordx4 v[200:203], v1, s[4:7], s21 offen offset:0 sc1
    buffer_store_dwordx4 v[204:207], v1, s[4:7], s21 offen offset:1024 sc1
    v_add_f32 v8, v8, v9
    v_xor_b32 v10, 16, v0
    v_lshlrev_b32 v10, 2, v10
    ds_bpermute_b32 v9, v10, v8
    v_xor_b32 v10, 32, v0
    v_lshlrev_b32 v10, 2, v10
    s_waitcnt lgkmcnt(0)
    v_add_f32 v8, v8, v9
    ds_bpermute_b32 v9, v10, v8
    s_waitcnt lgkmcnt(0)
    v_add_f32 v8, v8, v9
    v_mul_f32 v8, 0xbfb8aa3b, v8
    v_exp_f32 v8, v8
    s_nop 0
    v_add_f32 v8, 1.0, v8
    v_rcp_f32 v8, v8
    v_lshlrev_b32 v10, 2, v2
    s_lshl_b32 s22, s17, 6
    s_add_u32 s22, s22, 54759424
    buffer_store_dword v8, v10, s[4:7], s22 offen
    s_endpgm
prep_kernel_arm:
    s_lshr_b32 s64, s33, 1
    s_and_b32 s65, s33, 1
    s_mul_i32 s65, s65, 33
    s_add_u32 s71, s65, 33
    s_min_u32 s71, s71, 65
    s_mul_i32 s66, s64, 47104
    s_add_u32 s66, s66, 42205184
    s_mul_i32 s67, s64, 48128
    s_add_u32 s67, s67, 45295616
    v_mov_b32 v240, -1
    v_mov_b32 v241, -1
    v_mov_b32 v242, -1
    v_mov_b32 v243, -1
prep_kernel_a1:
    s_cmp_lt_u32 s65, 18
    s_cselect_b32 s69, s66, s67
    s_cselect_b32 s70, 0, 18
    s_sub_u32 s70, s65, s70
    s_lshl_b32 s68, s64, 3
    s_add_u32 s70, s70, s68
    s_cmp_lt_u32 s70, 7
    s_cbranch_scc1 prep_kernel_a4
    s_lshl_b32 s68, s65, 10
    s_add_u32 s69, s69, s68
    buffer_store_dwordx4 v[240:243], v1, s[4:7], s69 offen sc1
prep_kernel_a4:
    s_add_u32 s65, s65, 1
    s_cmp_lt_u32 s65, s71
    s_cbranch_scc1 prep_kernel_a1
    s_cmp_eq_u32 s33, 127
    s_cbranch_scc0 prep_kernel_a2
    v_mov_b32 v244, 0
    v_mov_b32 v245, 0
    v_mov_b32 v246, 0
    v_mov_b32 v247, 0
    s_mov_b32 s69, 54767616
    s_mov_b32 s70, 54771712
    buffer_store_dwordx4 v[244:247], v1, s[4:7], s69 offen offset:0 sc1
    buffer_store_dwordx4 v[244:247], v1, s[4:7], s69 offen offset:1024 sc1
    buffer_store_dwordx4 v[244:247], v1, s[4:7], s69 offen offset:2048 sc1
    buffer_store_dwordx4 v[244:247], v1, s[4:7], s69 offen offset:3072 sc1
    buffer_store_dwordx4 v[244:247], v1, s[4:7], s70 offen offset:0 sc1
    buffer_store_dwordx4 v[244:247], v1, s[4:7], s70 offen offset:1024 sc1
    buffer_store_dwordx4 v[244:247], v1, s[4:7], s70 offen offset:2048 sc1
    buffer_store_dwordx4 v[244:247], v1, s[4:7], s70 offen offset:3072 sc1
prep_kernel_a2:
    s_endpgm
prep_kernel_end:
    s_endpgm
.globl main_kernel
.p2align 8
.type main_kernel,@function
main_kernel:
    s_cmp_ge_u32 s2, 256
    s_cbranch_scc1 main_kernel_end
    s_load_dwordx2 s[4:5], s[0:1], 112
    s_load_dwordx2 s[8:9], s[0:1], 96
    s_load_dwordx2 s[12:13], s[0:1], 104
    s_load_dwordx2 s[44:45], s[0:1], 24
    s_getreg_b32 s3, hwreg(HW_REG_XCC_ID)
    s_and_b32 s3, s3, 15
    s_mov_b32 s6, 268435456
    s_mov_b32 s7, 0x20000
    s_mov_b32 s10, 1835008
    s_mov_b32 s11, 0x20000
    s_mov_b32 s14, 256
    s_mov_b32 s15, 0x20000
    s_mov_b32 s46, 401408
    s_mov_b32 s47, 0x20000
    s_mov_b32 s19, 400000
    v_lshrrev_b32 v1, 6, v0
    v_and_b32 v0, 63, v0
    v_readfirstlane_b32 s16, v1
    s_waitcnt lgkmcnt(0)
    s_and_b32 s22, s2, 7
    s_lshl_b32 s22, s22, 5
    s_lshr_b32 s23, s2, 3
    s_add_u32 s22, s22, s23
    s_mov_b32 s94, 0
    s_cmp_ge_u32 s22, 32
    s_cbranch_scc1 main_kernel_go
    s_cmp_lg_u32 s16, 0
    s_cbranch_scc1 main_kernel_go
    s_add_u32 s23, s3, 1
    v_mov_b32 v2, s23
    s_lshl_b32 s23, s22, 2
    v_mov_b32 v3, s23
    s_mov_b64 exec, 1
    buffer_store_dword v2, v3, s[12:15], 0 offen offset:128 sc1
    s_mov_b64 exec, -1
    s_branch main_kernel_go
main_kernel_census:
    s_mov_b32 s94, 1
    s_waitcnt vmcnt(0) lgkmcnt(0)
    s_barrier
    v_mbcnt_lo_u32_b32 v0, -1, 0
    v_mbcnt_hi_u32_b32 v0, -1, v0
    s_cmp_lg_u32 s16, 0
    s_cbranch_scc1 main_kernel_c2
    v_mov_b32 v2, 1
    v_mov_b32 v3, 0
    s_lshl_b32 s20, s3, 2
    s_mov_b64 exec, 1
    buffer_atomic_add v2, v3, s[12:15], s20 offen sc0
    s_mov_b64 exec, -1
    v_and_b32 v3, 15, v0
    v_lshlrev_b32 v3, 2, v3
    s_waitcnt vmcnt(0)
    v_readfirstlane_b32 s21, v2
main_kernel_c1:
    buffer_load_dword v4, v3, s[12:15], 0 offen sc1
    s_sub_u32 s19, s19, 1
    s_cbranch_scc1 main_kernel_end
    s_waitcnt vmcnt(0)
    v_mov_b32 v5, v4
    s_nop 1
    v_add_u32_dpp v5, v5, v5 row_ror:8 row_mask:0xf bank_mask:0xf
    s_nop 1
    v_add_u32_dpp v5, v5, v5 row_ror:4 row_mask:0xf bank_mask:0xf
    s_nop 1
    v_add_u32_dpp v5, v5, v5 row_ror:2 row_mask:0xf bank_mask:0xf
    s_nop 1
    v_add_u32_dpp v5, v5, v5 row_ror:1 row_mask:0xf bank_mask:0xf
    v_cmp_gt_u32 vcc, 256, v5
    s_cbranch_vccnz main_kernel_c1
    v_and_b32 v6, 15, v0
    v_cmp_gt_u32 vcc, s3, v6
    s_nop 1
    v_cndmask_b32 v5, 0, v4, vcc
    s_nop 1
    v_add_u32_dpp v5, v5, v5 row_ror:8 row_mask:0xf bank_mask:0xf
    s_nop 1
    v_add_u32_dpp v5, v5, v5 row_ror:4 row_mask:0xf bank_mask:0xf
    s_nop 1
    v_add_u32_dpp v5, v5, v5 row_ror:2 row_mask:0xf bank_mask:0xf
    s_nop 1
    v_add_u32_dpp v5, v5, v5 row_ror:1 row_mask:0xf bank_mask:0xf
    v_cmp_le_u32 vcc, 32, v4
    s_nop 0
    v_readfirstlane_b32 s22, v5
    s_ff1_i32_b32 s23, vcc_lo
    s_add_u32 s22, s22, s21
    s_cmp_lt_i32 s23, 0
    s_cbranch_scc1 main_kernel_c3
    s_add_u32 s24, s22, 32
    s_cmp_ge_u32 s3, s23
    s_cselect_b32 s22, s22, s24
    s_cmp_lt_u32 s21, 32
    s_cselect_b32 s24, s21, s22
    s_cmp_eq_u32 s3, s23
    s_cselect_b32 s22, s24, s22
    s_branch main_kernel_c4
main_kernel_c3:
    s_or_b32 s22, s22, 0x10000
main_kernel_c4:
    v_mov_b32 v2, s22
    v_mov_b32 v3, 0
    ds_write_b32 v3, v2
    s_waitcnt lgkmcnt(0)
main_kernel_c2:
    s_barrier
    v_mov_b32 v3, 0
    ds_read_b32 v2, v3
    s_waitcnt lgkmcnt(0)
    v_readfirstlane_b32 s22, v2
    s_barrier
main_kernel_go:
    s_lshr_b32 s37, s22, 16
    s_and_b32 s37, s37, 1
    s_and_b32 s22, s22, 255
    s_mov_b32 s85, s22
    s_cmp_ge_u32 s22, 32
    s_cbranch_scc1 main_kernel_w
    s_mov_b32 s17, s22
    s_cmp_ge_u32 s17, 16
    s_cbranch_scc1 LteamB_11
    s_cmp_eq_u32 s16, 1
    s_cbranch_scc1 LteamA1_4
    s_cmp_eq_u32 s16, 2
    s_cbranch_scc1 LteamA2_5
    s_cmp_eq_u32 s16, 3
    s_cbranch_scc1 LteamA3_6
    s_branch LteamA0_3
LteamB_11:
    s_cmp_eq_u32 s16, 1
    s_cbranch_scc1 LteamB1_8
    s_cmp_eq_u32 s16, 2
    s_cbranch_scc1 LteamB2_9
    s_cmp_eq_u32 s16, 3
    s_cbranch_scc1 LteamB3_10
    s_branch LteamB0_7
.p2align 6
LteamA0_3:
    v_lshlrev_b32 v1, 4, v0
    v_mov_b32 v2, 0x44444444
    v_mov_b32 v13, 0xeeeeeeee
    v_and_b32 v14, 2, v0
    v_cmp_ne_u32 vcc, 0, v14
    s_nop 1
    v_cndmask_b32 v2, v2, v13, vcc
    v_mov_b32 v13, 0
    v_lshlrev_b32 v14, 2, v0
    ds_write_b32 v14, v13 offset:24064
    s_mov_b32 s18, 0
    s_mov_b32 s34, 42222592
    s_mov_b64 s[82:83], 0
    s_and_b32 s84, s17, 15
    s_lshl_b32 s84, s84, 8
    s_add_u32 s84, s84, 54767616
    s_mov_b32 s20, 42205184
    s_mov_b32 s21, 42206208
    v_and_b32 v13, 15, v0
    v_lshrrev_b32 v14, 4, v0
    v_and_b32 v15, 1, v14
    v_and_b32 v6, 0x1f0, v1
    v_lshrrev_b32 v3, 2, v13
    v_lshlrev_b32 v3, 6, v3
    v_and_b32 v5, 1, v0
    v_lshl_add_u32 v3, v5, 5, v3
    v_lshl_add_u32 v3, v14, 3, v3
    v_bfe_u32 v5, v0, 1, 1
    v_lshl_add_u32 v3, v5, 2, v3
    v_add_u32 v3, 7424, v3
    v_lshlrev_b32 v4, 8, v14
    v_lshl_add_u32 v4, v13, 3, v4
    v_add_u32 v4, 7424, v4
    v_bfe_u32 v7, v0, 1, 1
    v_lshlrev_b32 v7, 7, v7
    v_bfe_u32 v5, v0, 2, 1
    v_lshl_add_u32 v7, v5, 6, v7
    v_lshl_add_u32 v7, v15, 5, v7
    v_and_b32 v5, 1, v0
    v_lshl_add_u32 v7, v5, 4, v7
    v_lshrrev_b32 v5, 5, v0
    v_lshl_add_u32 v7, v5, 8, v7
    v_lshlrev_b32 v5, 6, v14
    v_bfe_u32 v8, v0, 2, 1
    v_lshl_add_u32 v5, v8, 5, v5
    v_add_u32 v5, 0, v5
    v_lshrrev_b32 v8, 3, v13
    v_lshl_add_u32 v11, v8, 8, v5
    v_and_b32 v8, 3, v0
    v_lshl_add_u32 v11, v8, 2, v11
    v_lshl_add_u32 v12, v8, 1, v5
    s_and_b32 s24, s17, 3
    s_lshl_b32 s25, s24, 9
    v_add_u32 v11, s25, v11
    s_lshr_b32 s25, s24, 1
    s_lshl_b32 s25, s25, 8
    s_and_b32 s24, s24, 1
    s_lshl_b32 s24, s24, 3
    s_add_u32 s25, s25, s24
    v_add_u32 v12, s25, v12
    s_lshr_b32 s26, s17, 2
    s_mul_i32 s26, s26, 2560
    s_add_u32 s26, s26, 42212352
    v_lshlrev_b32 v9, 3, v0
    v_mov_b32 v10, 0
    v_mov_b32 v13, 0
    v_lshlrev_b32 v14, 2, v0
    ds_write_b32 v14, v13 offset:9216
    ds_write_b32 v14, v13 offset:7168
    s_mul_i32 s22, s17, 401408
    s_add_u32 s22, s22, 0
    v_lshlrev_b32 v8, 7, v0
    v_min_u32 v5, 2816, v8
    s_mul_i32 s30, s17, 2944
    s_add_u32 s30, s30, 42252288
    s_mul_i32 s38, s17, 28672
    s_add_u32 s38, s38, 12845056
    v_min_u32 v8, 7040, v8
    v_lshlrev_b32 v8, 2, v8
    s_mov_b32 s27, 42223616
    s_mov_b32 s28, 42237952
    s_add_u32 s23, s22, 0
    buffer_load_dwordx4 a[0:3], v1, s[4:7], s23 offen offset:0
    buffer_load_dwordx4 a[4:7], v1, s[4:7], s23 offen offset:1024
    s_add_u32 s23, s22, 2048
    buffer_load_dwordx4 a[8:11], v1, s[4:7], s23 offen offset:0
    buffer_load_dwordx4 a[12:15], v1, s[4:7], s23 offen offset:1024
    s_add_u32 s23, s22, 4096
    buffer_load_dwordx4 a[16:19], v1, s[4:7], s23 offen offset:0
    buffer_load_dwordx4 a[20:23], v1, s[4:7], s23 offen offset:1024
    s_add_u32 s23, s22, 6144
    buffer_load_dwordx4 a[24:27], v1, s[4:7], s23 offen offset:0
    buffer_load_dwordx4 a[28:31], v1, s[4:7], s23 offen offset:1024
    s_add_u32 s23, s22, 8192
    buffer_load_dwordx4 a[32:35], v1, s[4:7], s23 offen offset:0
    buffer_load_dwordx4 a[36:39], v1, s[4:7], s23 offen offset:1024
    s_add_u32 s23, s22, 10240
    buffer_load_dwordx4 a[40:43], v1, s[4:7], s23 offen offset:0
    buffer_load_dwordx4 a[44:47], v1, s[4:7], s23 offen offset:1024
    s_add_u32 s23, s22, 12288
    buffer_load_dwordx4 a[48:51], v1, s[4:7], s23 offen offset:0
    buffer_load_dwordx4 a[52:55], v1, s[4:7], s23 offen offset:1024
    s_add_u32 s23, s22, 14336
    buffer_load_dwordx4 a[56:59], v1, s[4:7], s23 offen offset:0
    buffer_load_dwordx4 a[60:63], v1, s[4:7], s23 offen offset:1024
    s_add_u32 s23, s22, 16384
    buffer_load_dwordx4 a[64:67], v1, s[4:7], s23 offen offset:0
    buffer_load_dwordx4 a[68:71], v1, s[4:7], s23 offen offset:1024
    s_add_u32 s23, s22, 18432
    buffer_load_dwordx4 a[72:75], v1, s[4:7], s23 offen offset:0
    buffer_load_dwordx4 a[76:79], v1, s[4:7], s23 offen offset:1024
    s_add_u32 s23, s22, 20480
    buffer_load_dwordx4 a[80:83], v1, s[4:7], s23 offen offset:0
    buffer_load_dwordx4 a[84:87], v1, s[4:7], s23 offen offset:1024
    s_add_u32 s23, s22, 22528
    buffer_load_dwordx4 a[88:91], v1, s[4:7], s23 offen offset:0
    buffer_load_dwordx4 a[92:95], v1, s[4:7], s23 offen offset:1024
    s_add_u32 s23, s22, 24576
    buffer_load_dwordx4 a[96:99], v1, s[4:7], s23 offen offset:0
    buffer_load_dwordx4 a[100:103], v1, s[4:7], s23 offen offset:1024
    s_add_u32 s23, s22, 26624
    buffer_load_dwordx4 a[104:107], v1, s[4:7], s23 offen offset:0
    buffer_load_dwordx4 a[108:111], v1, s[4:7], s23 offen offset:1024
    s_add_u32 s23, s22, 28672
    buffer_load_dwordx4 a[112:115], v1, s[4:7], s23 offen offset:0
    buffer_load_dwordx4 a[116:119], v1, s[4:7], s23 offen offset:1024
    s_add_u32 s23, s22, 30720
    buffer_load_dwordx4 a[120:123], v1, s[4:7], s23 offen offset:0
    buffer_load_dwordx4 a[124:127], v1, s[4:7], s23 offen offset:1024
    s_add_u32 s23, s22, 32768
    buffer_load_dwordx4 a[128:131], v1, s[4:7], s23 offen offset:0
    buffer_load_dwordx4 a[132:135], v1, s[4:7], s23 offen offset:1024
    s_add_u32 s23, s22, 34816
    buffer_load_dwordx4 a[136:139], v1, s[4:7], s23 offen offset:0
    buffer_load_dwordx4 a[140:143], v1, s[4:7], s23 offen offset:1024
    s_add_u32 s23, s22, 36864
    buffer_load_dwordx4 a[144:147], v1, s[4:7], s23 offen offset:0
    buffer_load_dwordx4 a[148:151], v1, s[4:7], s23 offen offset:1024
    s_add_u32 s23, s22, 38912
    buffer_load_dwordx4 a[152:155], v1, s[4:7], s23 offen offset:0
    buffer_load_dwordx4 a[156:159], v1, s[4:7], s23 offen offset:1024
    s_add_u32 s23, s22, 40960
    buffer_load_dwordx4 a[160:163], v1, s[4:7], s23 offen offset:0
    buffer_load_dwordx4 a[164:167], v1, s[4:7], s23 offen offset:1024
    s_waitcnt vmcnt(40)
    s_add_u32 s23, s22, 43008
    buffer_load_dwordx4 a[168:171], v1, s[4:7], s23 offen offset:0
    buffer_load_dwordx4 a[172:175], v1, s[4:7], s23 offen offset:1024
    s_add_u32 s23, s22, 45056
    buffer_load_dwordx4 a[176:179], v1, s[4:7], s23 offen offset:0
    buffer_load_dwordx4 a[180:183], v1, s[4:7], s23 offen offset:1024
    s_add_u32 s23, s22, 47104
    buffer_load_dwordx4 a[184:187], v1, s[4:7], s23 offen offset:0
    buffer_load_dwordx4 a[188:191], v1, s[4:7], s23 offen offset:1024
    s_add_u32 s23, s22, 49152
    buffer_load_dwordx4 a[192:195], v1, s[4:7], s23 offen offset:0
    buffer_load_dwordx4 a[196:199], v1, s[4:7], s23 offen offset:1024
    s_add_u32 s23, s22, 51200
    buffer_load_dwordx4 a[200:203], v1, s[4:7], s23 offen offset:0
    buffer_load_dwordx4 a[204:207], v1, s[4:7], s23 offen offset:1024
    s_add_u32 s23, s22, 53248
    buffer_load_dwordx4 a[208:211], v1, s[4:7], s23 offen offset:0
    buffer_load_dwordx4 a[212:215], v1, s[4:7], s23 offen offset:1024
    s_add_u32 s23, s22, 55296
    buffer_load_dwordx4 a[216:219], v1, s[4:7], s23 offen offset:0
    buffer_load_dwordx4 a[220:223], v1, s[4:7], s23 offen offset:1024
    s_waitcnt vmcnt(40)
    s_add_u32 s23, s22, 57344
    buffer_load_dwordx4 a[224:227], v1, s[4:7], s23 offen offset:0
    buffer_load_dwordx4 a[228:231], v1, s[4:7], s23 offen offset:1024
    s_add_u32 s23, s22, 59392
    buffer_load_dwordx4 a[232:235], v1, s[4:7], s23 offen offset:0
    buffer_load_dwordx4 a[236:239], v1, s[4:7], s23 offen offset:1024
    s_add_u32 s23, s22, 61440
    buffer_load_dwordx4 a[240:243], v1, s[4:7], s23 offen offset:0
    buffer_load_dwordx4 a[244:247], v1, s[4:7], s23 offen offset:1024
    s_add_u32 s23, s22, 63488
    buffer_load_dwordx4 a[248:251], v1, s[4:7], s23 offen offset:0
    buffer_load_dwordx4 a[252:255], v1, s[4:7], s23 offen offset:1024
    s_add_u32 s23, s22, 65536
    buffer_load_dwordx4 v[120:123], v1, s[4:7], s23 offen offset:0
    buffer_load_dwordx4 v[124:127], v1, s[4:7], s23 offen offset:1024
    s_add_u32 s23, s22, 67584
    buffer_load_dwordx4 v[128:131], v1, s[4:7], s23 offen offset:0
    buffer_load_dwordx4 v[132:135], v1, s[4:7], s23 offen offset:1024
    s_add_u32 s23, s22, 69632
    buffer_load_dwordx4 v[136:139], v1, s[4:7], s23 offen offset:0
    buffer_load_dwordx4 v[140:143], v1, s[4:7], s23 offen offset:1024
    s_waitcnt vmcnt(40)
    s_add_u32 s23, s22, 71680
    buffer_load_dwordx4 v[144:147], v1, s[4:7], s23 offen offset:0
    buffer_load_dwordx4 v[148:151], v1, s[4:7], s23 offen offset:1024
    s_add_u32 s23, s22, 73728
    buffer_load_dwordx4 v[152:155], v1, s[4:7], s23 offen offset:0
    buffer_load_dwordx4 v[156:159], v1, s[4:7], s23 offen offset:1024
    s_add_u32 s23, s22, 75776
    buffer_load_dwordx4 v[160:163], v1, s[4:7], s23 offen offset:0
    buffer_load_dwordx4 v[164:167], v1, s[4:7], s23 offen offset:1024
    s_add_u32 s23, s22, 77824
    buffer_load_dwordx4 v[168:171], v1, s[4:7], s23 offen offset:0
    buffer_load_dwordx4 v[172:175], v1, s[4:7], s23 offen offset:1024
    s_add_u32 s23, s22, 79872
    buffer_load_dwordx4 v[176:179], v1, s[4:7], s23 offen offset:0
    buffer_load_dwordx4 v[180:183], v1, s[4:7], s23 offen offset:1024
    s_add_u32 s23, s22, 81920
    buffer_load_dwordx4 v[184:187], v1, s[4:7], s23 offen offset:0
    buffer_load_dwordx4 v[188:191], v1, s[4:7], s23 offen offset:1024
    s_add_u32 s23, s22, 83968
    buffer_load_dwordx4 v[192:195], v1, s[4:7], s23 offen offset:0
    buffer_load_dwordx4 v[196:199], v1, s[4:7], s23 offen offset:1024
    s_waitcnt vmcnt(40)
    s_add_u32 s23, s22, 86016
    buffer_load_dwordx4 v[200:203], v1, s[4:7], s23 offen offset:0
    buffer_load_dwordx4 v[204:207], v1, s[4:7], s23 offen offset:1024
    s_add_u32 s23, s22, 88064
    buffer_load_dwordx4 v[208:211], v1, s[4:7], s23 offen offset:0
    buffer_load_dwordx4 v[212:215], v1, s[4:7], s23 offen offset:1024
    s_add_u32 s23, s22, 90112
    buffer_load_dwordx4 v[216:219], v1, s[4:7], s23 offen offset:0
    buffer_load_dwordx4 v[220:223], v1, s[4:7], s23 offen offset:1024
    s_add_u32 s23, s22, 92160
    buffer_load_dwordx4 v[224:227], v1, s[4:7], s23 offen offset:0
    buffer_load_dwordx4 v[228:231], v1, s[4:7], s23 offen offset:1024
    s_add_u32 s23, s22, 94208
    buffer_load_dwordx4 v[232:235], v1, s[4:7], s23 offen offset:0
    buffer_load_dwordx4 v[236:239], v1, s[4:7], s23 offen offset:1024
    s_add_u32 s23, s22, 96256
    buffer_load_dwordx4 v[240:243], v1, s[4:7], s23 offen offset:0
    buffer_load_dwordx4 v[244:247], v1, s[4:7], s23 offen offset:1024
    s_add_u32 s23, s22, 98304
    buffer_load_dwordx4 v[248:251], v1, s[4:7], s23 offen offset:0
    buffer_load_dwordx4 v[252:255], v1, s[4:7], s23 offen offset:1024
    s_waitcnt vmcnt(40)
    s_cmp_lg_u32 s94, 0
    s_cbranch_scc1 Lvf_13
    v_and_b32 v45, 31, v0
    v_lshlrev_b32 v45, 2, v45
Lvf_12:
    buffer_load_dword v44, v45, s[12:15], 0 offen offset:128 sc1
    s_sub_u32 s19, s19, 1
    s_cbranch_scc1 main_kernel_exit
    s_waitcnt vmcnt(0)
    v_cmp_eq_u32 vcc, 0, v44
    s_cbranch_vccnz Lvf_12
    v_readfirstlane_b32 s94, v44
    s_nop 1
    v_cmp_ne_u32 vcc, s94, v44
    s_cbranch_vccnz main_kernel_census
Lvf_13:
    v_and_b32 v5, 0x37, v0
    v_lshlrev_b32 v5, 2, v5
    v_add_u32 v5, 19968, v5
    v_lshlrev_b32 v14, 2, v0
    v_mov_b32 v44, 0
    v_mov_b32 v45, 0
    v_mov_b32 v46, 0
    v_mov_b32 v47, 0
    v_mov_b32 v48, 0
    v_mov_b32 v49, 0
    v_mov_b32 v50, 0
    v_mov_b32 v51, 0
    v_mov_b32 v52, 0
    v_mov_b32 v53, 0
    v_mov_b32 v54, 0
    v_mov_b32 v55, 0
    v_mov_b32 v56, 0
    v_mov_b32 v57, 0
    v_mov_b32 v58, 0
    v_mov_b32 v59, 0
    v_mov_b32 v60, 0
    v_mov_b32 v61, 0
    v_mov_b32 v62, 0
    v_mov_b32 v63, 0
    v_mov_b32 v64, 0
    v_mov_b32 v65, 0
    v_mov_b32 v66, 0
    v_mov_b32 v67, 0
    v_mov_b32 v68, 0
    v_mov_b32 v69, 0
    v_mov_b32 v70, 0
    v_mov_b32 v71, 0
    s_waitcnt vmcnt(0) lgkmcnt(0)
    buffer_load_dwordx4 v[16:19], v1, s[4:7], s20 offen sc1
    buffer_load_dwordx4 v[20:23], v1, s[4:7], s21 offen sc1
    buffer_load_dwordx4 v[16:19], v1, s[4:7], s20 offen sc1
    buffer_load_dwordx4 v[20:23], v1, s[4:7], s21 offen sc1
LA_14:
    s_branch Lok_16
Lpm_15:
    buffer_load_dwordx4 v[16:19], v1, s[4:7], s20 offen sc1
    buffer_load_dwordx4 v[20:23], v1, s[4:7], s21 offen sc1
    s_sub_u32 s19, s19, 1
    s_cbranch_scc1 main_kernel_exit
    s_nop 2
    v_mov_b32 v44, 0
    v_mov_b32 v45, 0
    v_mov_b32 v46, 0
    v_mov_b32 v47, 0
    v_mov_b32 v48, 0
    v_mov_b32 v49, 0
    v_mov_b32 v50, 0
    v_mov_b32 v51, 0
Lok_16:
    s_waitcnt vmcnt(3)
    v_max3_u32 v13, v16, v17, v18
    s_waitcnt vmcnt(2)
    v_max3_u32 v15, v20, v21, v22
    v_max3_u32 v13, v19, v23, v13
    v_smfmac_f32_16x16x64_bf16 v[44:47], v[16:19], a[0:7], v2
    v_max_u32 v13, v13, v15
    v_cmp_eq_u32 vcc, -1, v13
    v_smfmac_f32_16x16x64_bf16 v[48:51], v[16:19], a[56:63], v2
    ds_write_b128 v1, v[16:19] offset:0
    s_cbranch_vccnz Lpm_15
    v_smfmac_f32_16x16x64_bf16 v[52:55], v[16:19], a[112:119], v2
    v_smfmac_f32_16x16x64_bf16 v[56:59], v[16:19], a[168:175], v2
    v_smfmac_f32_16x16x64_bf16 v[60:63], v[16:19], a[224:231], v2
    ds_write_b128 v1, v[20:23] offset:1024
    v_smfmac_f32_16x16x64_bf16 v[64:67], v[16:19], v[144:151], v2
    buffer_load_dwordx4 v[72:75], v1, s[4:7], s27 offen offset:0
    v_smfmac_f32_16x16x64_bf16 v[68:71], v[16:19], v[200:207], v2
    buffer_load_dwordx4 v[76:79], v1, s[4:7], s27 offen offset:1024
    v_smfmac_f32_16x16x64_bf16 v[44:47], v[20:23], a[8:15], v2
    buffer_load_dwordx4 v[88:91], v1, s[4:7], s28 offen offset:0
    v_smfmac_f32_16x16x64_bf16 v[48:51], v[20:23], a[64:71], v2
    buffer_load_dwordx4 v[92:95], v1, s[4:7], s28 offen offset:1024
    v_smfmac_f32_16x16x64_bf16 v[52:55], v[20:23], a[120:127], v2
    s_waitcnt lgkmcnt(0)
    s_barrier
    ds_read_b128 v[24:27], v1 offset:2048
    v_smfmac_f32_16x16x64_bf16 v[56:59], v[20:23], a[176:183], v2
    ds_read_b128 v[28:31], v1 offset:3072
    v_smfmac_f32_16x16x64_bf16 v[60:63], v[20:23], a[232:239], v2
    ds_read_b128 v[32:35], v1 offset:4096
    v_smfmac_f32_16x16x64_bf16 v[64:67], v[20:23], v[152:159], v2
    ds_read_b128 v[36:39], v1 offset:5120
    v_smfmac_f32_16x16x64_bf16 v[68:71], v[20:23], v[208:215], v2
    ds_read_b128 v[40:43], v1 offset:6144
    s_waitcnt lgkmcnt(4)
    v_smfmac_f32_16x16x64_bf16 v[44:47], v[24:27], a[16:23], v2
    s_waitcnt lgkmcnt(3)
    v_smfmac_f32_16x16x64_bf16 v[44:47], v[28:31], a[24:31], v2
    s_waitcnt lgkmcnt(1)
    v_smfmac_f32_16x16x64_bf16 v[44:47], v[32:35], a[32:39], v2
    buffer_load_dwordx4 v[80:83], v1, s[4:7], s27 offen offset:2048
    v_smfmac_f32_16x16x64_bf16 v[44:47], v[36:39], a[40:47], v2
    s_waitcnt lgkmcnt(0)
    v_smfmac_f32_16x16x64_bf16 v[44:47], v[40:43], a[48:55], v2
    ds_read_b128 v[104:107], v7 offset:0
    v_smfmac_f32_16x16x64_bf16 v[48:51], v[24:27], a[72:79], v2
    buffer_load_dwordx4 v[84:87], v6, s[4:7], s27 offen offset:3072
    v_smfmac_f32_16x16x64_bf16 v[48:51], v[28:31], a[80:87], v2
    ds_read_b128 v[108:111], v7 offset:512
    v_smfmac_f32_16x16x64_bf16 v[48:51], v[32:35], a[88:95], v2
    v_add_f32 v44, v44, v46
    v_smfmac_f32_16x16x64_bf16 v[48:51], v[36:39], a[96:103], v2
    v_add_f32 v45, v45, v47
    v_smfmac_f32_16x16x64_bf16 v[48:51], v[40:43], a[104:111], v2
    v_cvt_pk_bf16_f32 v44, v44, v45
    v_smfmac_f32_16x16x64_bf16 v[52:55], v[24:27], a[128:135], v2
    ds_write_b32 v3, v44 offset:0
    ds_read_b128 v[112:115], v7 offset:1024
    v_smfmac_f32_16x16x64_bf16 v[52:55], v[28:31], a[136:143], v2
    buffer_load_dwordx4 v[96:99], v1, s[4:7], s28 offen offset:2048
    v_smfmac_f32_16x16x64_bf16 v[52:55], v[32:35], a[144:151], v2
    v_add_f32 v48, v48, v50
    v_smfmac_f32_16x16x64_bf16 v[52:55], v[36:39], a[152:159], v2
    v_add_f32 v49, v49, v51
    v_smfmac_f32_16x16x64_bf16 v[52:55], v[40:43], a[160:167], v2
    v_cvt_pk_bf16_f32 v48, v48, v49
    v_smfmac_f32_16x16x64_bf16 v[56:59], v[24:27], a[184:191], v2
    ds_write_b32 v3, v48 offset:256
    ds_read_b128 v[116:119], v7 offset:1536
    v_smfmac_f32_16x16x64_bf16 v[56:59], v[28:31], a[192:199], v2
    buffer_load_dwordx4 v[100:103], v6, s[4:7], s28 offen offset:3072
    v_smfmac_f32_16x16x64_bf16 v[56:59], v[32:35], a[200:207], v2
    v_add_f32 v52, v52, v54
    v_smfmac_f32_16x16x64_bf16 v[56:59], v[36:39], a[208:215], v2
    v_add_f32 v53, v53, v55
    v_smfmac_f32_16x16x64_bf16 v[56:59], v[40:43], a[216:223], v2
    v_cvt_pk_bf16_f32 v52, v52, v53
    v_smfmac_f32_16x16x64_bf16 v[60:63], v[24:27], a[240:247], v2
    ds_write_b32 v3, v52 offset:512
    s_waitcnt vmcnt(8)
    v_smfmac_f32_16x16x64_bf16 v[60:63], v[28:31], a[248:255], v2
    ds_read_b128 v[16:19], v1 offset:24064
    v_smfmac_f32_16x16x64_bf16 v[60:63], v[32:35], v[120:127], v2
    v_add_f32 v56, v56, v58
    v_smfmac_f32_16x16x64_bf16 v[60:63], v[36:39], v[128:135], v2
    v_add_f32 v57, v57, v59
    v_smfmac_f32_16x16x64_bf16 v[60:63], v[40:43], v[136:143], v2
    v_cvt_pk_bf16_f32 v56, v56, v57
    v_smfmac_f32_16x16x64_bf16 v[64:67], v[24:27], v[160:167], v2
    ds_write_b32 v3, v56 offset:768
    ds_read_b128 v[20:23], v1 offset:24064
    v_smfmac_f32_16x16x64_bf16 v[64:67], v[28:31], v[168:175], v2
    ds_read_b64_tr_b16 v[48:49], v4
    v_smfmac_f32_16x16x64_bf16 v[64:67], v[32:35], v[176:183], v2
    v_add_f32 v60, v60, v62
    v_smfmac_f32_16x16x64_bf16 v[64:67], v[36:39], v[184:191], v2
    v_add_f32 v61, v61, v63
    v_smfmac_f32_16x16x64_bf16 v[64:67], v[40:43], v[192:199], v2
    v_cvt_pk_bf16_f32 v60, v60, v61
    v_smfmac_f32_16x16x64_bf16 v[68:71], v[24:27], v[216:223], v2
    ds_write_b32 v3, v60 offset:1024
    ds_read_b128 v[44:47], v1 offset:24064
    v_smfmac_f32_16x16x64_bf16 v[68:71], v[28:31], v[224:231], v2
    ds_read_b64_tr_b16 v[50:51], v4 offset:128
    v_smfmac_f32_16x16x64_bf16 v[68:71], v[32:35], v[232:239], v2
    v_add_f32 v64, v64, v66
    v_smfmac_f32_16x16x64_bf16 v[68:71], v[36:39], v[240:247], v2
    v_add_f32 v65, v65, v67
    v_smfmac_f32_16x16x64_bf16 v[68:71], v[40:43], v[248:255], v2
    v_cvt_pk_bf16_f32 v64, v64, v65
    ds_write_b32 v3, v64 offset:1280
    s_waitcnt vmcnt(4) lgkmcnt(1)
    v_smfmac_f32_16x16x64_bf16 v[16:19], v[48:51], v[72:79], v2
    v_smfmac_f32_16x16x64_bf16 v[20:23], v[48:51], v[88:95], v2
    v_add_f32 v68, v68, v70
    v_add_f32 v69, v69, v71
    v_cvt_pk_bf16_f32 v68, v68, v69
    ds_write_b32 v3, v68 offset:1536
    ds_read_b64_tr_b16 v[52:53], v4 offset:1024
    ds_read_b64_tr_b16 v[54:55], v4 offset:1152
    v_smfmac_f32_16x16x64_bf16 v[44:47], v[48:51], v[104:111], v2
    s_nop 1
    v_mov_b32 v64, 0
    s_nop 1
    v_mov_b32 v65, 0
    s_nop 1
    v_mov_b32 v66, 0
    s_waitcnt vmcnt(0) lgkmcnt(0)
    v_smfmac_f32_16x16x64_bf16 v[16:19], v[52:55], v[80:87], v2
    v_smfmac_f32_16x16x64_bf16 v[20:23], v[52:55], v[96:103], v2
    v_smfmac_f32_16x16x64_bf16 v[44:47], v[52:55], v[112:119], v2
    s_cmp_eq_u32 s37, 1
    v_add_f32 v60, v17, v19
    v_add_f32 v56, v16, v18
    s_nop 1
    v_add_f32 v61, v21, v23
    ds_write_b64 v9, v[60:61] offset:17920
    v_add_f32 v57, v20, v22
    v_add_f32_dpp v58, v44, v46 quad_perm:[0,1,2,3] row_mask:0xf bank_mask:3
    v_add_f32_dpp v58, v45, v47 quad_perm:[0,1,2,3] row_mask:0xf bank_mask:12
    ds_write_b32 v14, v58 offset:19968
    s_nop 2
    v_mov_b32 v68, 0
    s_nop 2
    v_mov_b32 v69, 0
    s_nop 2
    v_mov_b32 v70, 0
    s_waitcnt lgkmcnt(0)
    s_barrier
    ds_read2st64_b64 v[24:27], v9 offset0:33 offset1:34
    ds_read_b64 v[28:29], v9 offset:16384
    ds_read2st64_b32 v[30:31], v5 offset0:0 offset1:1
    ds_read2st64_b32 v[32:33], v5 offset0:2 offset1:3
    s_waitcnt lgkmcnt(3)
    v_pk_add_f32 v[56:57], v[56:57], v[24:25]
    v_pk_add_f32 v[56:57], v[56:57], v[26:27]
    s_waitcnt lgkmcnt(2)
    v_pk_add_f32 v[56:57], v[56:57], v[28:29]
    v_exp_f32 v36, v56
    s_waitcnt lgkmcnt(0)
    v_pk_add_f32 v[30:31], v[30:31], v[32:33]
    v_exp_f32 v37, v57
    v_add_f32 v58, v30, v31
    v_exp_f32 v38, v58
    v_add_f32 v39, v36, v37
    v_fma_f32 v39, v38, 0.5, v39
    v_max3_f32 v13, |v56|, |v57|, |v58|
    v_cmp_nge_f32 vcc, 0x42800000, v13
    v_add_f32_dpp v39, v39, v39 row_ror:8 row_mask:0xf bank_mask:0xf
    s_nop 1
    v_add_f32_dpp v39, v39, v39 row_ror:4 row_mask:0xf bank_mask:0xf
    s_nop 1
    v_add_f32_dpp v39, v39, v39 row_ror:2 row_mask:0xf bank_mask:0xf
    s_nop 1
    v_add_f32_dpp v39, v39, v39 row_ror:1 row_mask:0xf bank_mask:0xf
    v_rcp_f32 v39, v39
    s_cbranch_vccnz Lslow_19
Lback_20:
    v_mul_f32 v36, v36, v39
    v_mul_f32 v37, v37, v39
    v_mul_f32 v38, v38, v39
    v_cvt_pk_bf16_f32 v36, |v36|, |v37|
    v_cvt_pk_bf16_f32 v38, |v38|, |v38|
    s_cbranch_scc1 Ls_17
    buffer_store_dword v36, v11, s[4:7], s26 offen
    buffer_store_short v38, v12, s[4:7], s26 offen offset:2048
Ls_18:
    s_add_u32 s26, s26, 47104
    s_barrier
    s_add_u32 s27, s27, 47104
    s_add_u32 s28, s28, 47104
    s_add_u32 s38, s38, 458752
    s_add_u32 s30, s30, 47104
    s_add_u32 s20, s20, 47104
    s_add_u32 s21, s21, 47104
    s_add_u32 s18, s18, 1
    s_cmp_ge_u32 s18, 63
    s_cbranch_scc1 main_kernel_exit
    v_cmp_ne_u32 s[82:83], 0, v10
    v_lshrrev_b32 v14, 2, v1
    buffer_load_dword v10, v14, s[4:7], s84 offen sc1
    s_bitcmp1_b64 s[82:83], s18
    s_cbranch_scc0 Lt_21
    buffer_load_dword v15, v8, s[4:7], s38 offen sc1
Lt_21:
    s_sleep 11
    v_mov_b32 v44, 0
    s_nop 1
    v_mov_b32 v45, 0
    s_nop 1
    v_mov_b32 v46, 0
    s_nop 1
    v_mov_b32 v47, 0
    s_nop 1
    v_mov_b32 v48, 0
    s_nop 1
    v_mov_b32 v49, 0
    s_nop 1
    v_mov_b32 v50, 0
    s_nop 1
    v_mov_b32 v51, 0
    s_nop 1
    v_mov_b32 v52, 0
    s_nop 1
    v_mov_b32 v53, 0
    s_nop 1
    v_mov_b32 v54, 0
    s_nop 1
    v_mov_b32 v55, 0
    s_nop 1
    v_mov_b32 v56, 0
    s_nop 1
    v_mov_b32 v57, 0
    s_nop 1
    v_mov_b32 v58, 0
    s_nop 1
    buffer_load_dwordx4 v[16:19], v1, s[4:7], s20 offen sc1
    buffer_load_dwordx4 v[20:23], v1, s[4:7], s21 offen sc1
    v_mov_b32 v59, 0
    s_nop 1
    v_mov_b32 v60, 0
    s_nop 1
    v_mov_b32 v61, 0
    s_nop 1
    v_mov_b32 v62, 0
    s_nop 1
    v_mov_b32 v63, 0
    s_nop 1
    v_mov_b32 v64, 0
    s_nop 1
    buffer_load_dwordx4 v[16:19], v1, s[4:7], s20 offen sc1
    buffer_load_dwordx4 v[20:23], v1, s[4:7], s21 offen sc1
    v_mov_b32 v65, 0
    s_nop 1
    v_mov_b32 v66, 0
    s_nop 1
    v_mov_b32 v67, 0
    s_nop 1
    v_mov_b32 v68, 0
    s_nop 1
    v_mov_b32 v69, 0
    s_nop 1
    v_mov_b32 v70, 0
    s_nop 1
    v_mov_b32 v71, 0
    s_nop 1
    s_branch LA_14
Ls_17:
    buffer_store_dword v36, v11, s[4:7], s26 offen sc1
    buffer_store_short v38, v12, s[4:7], s26 offen offset:2048 sc1
    s_branch Ls_18
Lslow_19:
    v_max3_f32 v13, v56, v57, v58
    s_nop 1
    v_max_f32_dpp v13, v13, v13 row_ror:8 row_mask:0xf bank_mask:0xf
    s_nop 1
    v_max_f32_dpp v13, v13, v13 row_ror:4 row_mask:0xf bank_mask:0xf
    s_nop 1
    v_max_f32_dpp v13, v13, v13 row_ror:2 row_mask:0xf bank_mask:0xf
    s_nop 1
    v_max_f32_dpp v13, v13, v13 row_ror:1 row_mask:0xf bank_mask:0xf
    v_sub_f32 v56, v56, v13
    v_exp_f32 v36, v56
    v_sub_f32 v57, v57, v13
    v_exp_f32 v37, v57
    v_sub_f32 v58, v58, v13
    v_exp_f32 v38, v58
    s_nop 0
    v_add_f32 v39, v36, v37
    v_fma_f32 v39, v38, 0.5, v39
    s_nop 1
    v_add_f32_dpp v39, v39, v39 row_ror:8 row_mask:0xf bank_mask:0xf
    s_nop 1
    v_add_f32_dpp v39, v39, v39 row_ror:4 row_mask:0xf bank_mask:0xf
    s_nop 1
    v_add_f32_dpp v39, v39, v39 row_ror:2 row_mask:0xf bank_mask:0xf
    s_nop 1
    v_add_f32_dpp v39, v39, v39 row_ror:1 row_mask:0xf bank_mask:0xf
    v_rcp_f32 v39, v39
    s_branch Lback_20
.p2align 6
LteamA1_4:
    v_lshlrev_b32 v1, 4, v0
    v_mov_b32 v2, 0x44444444
    v_mov_b32 v13, 0xeeeeeeee
    v_and_b32 v14, 2, v0
    v_cmp_ne_u32 vcc, 0, v14
    s_nop 1
    v_cndmask_b32 v2, v2, v13, vcc
    v_mov_b32 v13, 0
    v_lshlrev_b32 v14, 2, v0
    ds_write_b32 v14, v13 offset:24320
    s_mov_b32 s18, 0
    s_mov_b32 s34, 42222592
    s_mov_b64 s[82:83], 0
    s_and_b32 s84, s17, 15
    s_lshl_b32 s84, s84, 8
    s_add_u32 s84, s84, 54767616
    s_mov_b32 s20, 42207232
    s_mov_b32 s21, 42208256
    v_and_b32 v13, 15, v0
    v_lshrrev_b32 v14, 4, v0
    v_and_b32 v15, 1, v14
    v_and_b32 v6, 0x1f0, v1
    v_lshrrev_b32 v3, 2, v13
    v_lshlrev_b32 v3, 6, v3
    v_and_b32 v5, 1, v0
    v_lshl_add_u32 v3, v5, 5, v3
    v_lshl_add_u32 v3, v14, 3, v3
    v_bfe_u32 v5, v0, 1, 1
    v_lshl_add_u32 v3, v5, 2, v3
    v_add_u32 v3, 9472, v3
    v_lshlrev_b32 v4, 8, v14
    v_lshl_add_u32 v4, v13, 3, v4
    v_add_u32 v4, 9472, v4
    v_bfe_u32 v7, v0, 1, 1
    v_lshlrev_b32 v7, 7, v7
    v_bfe_u32 v5, v0, 2, 1
    v_lshl_add_u32 v7, v5, 6, v7
    v_lshl_add_u32 v7, v15, 5, v7
    v_and_b32 v5, 1, v0
    v_lshl_add_u32 v7, v5, 4, v7
    v_lshrrev_b32 v5, 5, v0
    v_lshl_add_u32 v7, v5, 8, v7
    v_lshlrev_b32 v5, 6, v14
    v_bfe_u32 v8, v0, 2, 1
    v_lshl_add_u32 v5, v8, 5, v5
    v_add_u32 v5, 16, v5
    v_lshrrev_b32 v8, 3, v13
    v_lshl_add_u32 v11, v8, 8, v5
    v_and_b32 v8, 3, v0
    v_lshl_add_u32 v11, v8, 2, v11
    v_lshl_add_u32 v12, v8, 1, v5
    s_and_b32 s24, s17, 3
    s_lshl_b32 s25, s24, 9
    v_add_u32 v11, s25, v11
    s_lshr_b32 s25, s24, 1
    s_lshl_b32 s25, s25, 8
    s_and_b32 s24, s24, 1
    s_lshl_b32 s24, s24, 3
    s_add_u32 s25, s25, s24
    v_add_u32 v12, s25, v12
    s_lshr_b32 s26, s17, 2
    s_mul_i32 s26, s26, 2560
    s_add_u32 s26, s26, 42212352
    v_lshlrev_b32 v9, 3, v0
    v_mov_b32 v10, 0
    v_mov_b32 v13, 0
    v_lshlrev_b32 v14, 2, v0
    ds_write_b32 v14, v13 offset:11264
    ds_write_b32 v14, v13 offset:7168
    s_mul_i32 s22, s17, 401408
    s_add_u32 s22, s22, 0
    v_lshlrev_b32 v8, 7, v0
    v_min_u32 v5, 2816, v8
    s_mul_i32 s30, s17, 2944
    s_add_u32 s30, s30, 42252288
    s_mul_i32 s38, s17, 28672
    s_add_u32 s38, s38, 12845184
    v_min_u32 v8, 7040, v8
    v_lshlrev_b32 v8, 2, v8
    s_mov_b32 s27, 42227200
    s_mov_b32 s28, 42241536
    s_add_u32 s23, s22, 104448
    buffer_load_dwordx4 a[0:3], v1, s[4:7], s23 offen offset:0
    buffer_load_dwordx4 a[4:7], v1, s[4:7], s23 offen offset:1024
    s_add_u32 s23, s22, 106496
    buffer_load_dwordx4 a[8:11], v1, s[4:7], s23 offen offset:0
    buffer_load_dwordx4 a[12:15], v1, s[4:7], s23 offen offset:1024
    s_add_u32 s23, s22, 108544
    buffer_load_dwordx4 a[16:19], v1, s[4:7], s23 offen offset:0
    buffer_load_dwordx4 a[20:23], v1, s[4:7], s23 offen offset:1024
    s_add_u32 s23, s22, 110592
    buffer_load_dwordx4 a[24:27], v1, s[4:7], s23 offen offset:0
    buffer_load_dwordx4 a[28:31], v1, s[4:7], s23 offen offset:1024
    s_add_u32 s23, s22, 112640
    buffer_load_dwordx4 a[32:35], v1, s[4:7], s23 offen offset:0
    buffer_load_dwordx4 a[36:39], v1, s[4:7], s23 offen offset:1024
    s_add_u32 s23, s22, 100352
    buffer_load_dwordx4 a[40:43], v1, s[4:7], s23 offen offset:0
    buffer_load_dwordx4 a[44:47], v1, s[4:7], s23 offen offset:1024
    s_add_u32 s23, s22, 102400
    buffer_load_dwordx4 a[48:51], v1, s[4:7], s23 offen offset:0
    buffer_load_dwordx4 a[52:55], v1, s[4:7], s23 offen offset:1024
    s_add_u32 s23, s22, 118784
    buffer_load_dwordx4 a[56:59], v1, s[4:7], s23 offen offset:0
    buffer_load_dwordx4 a[60:63], v1, s[4:7], s23 offen offset:1024
    s_add_u32 s23, s22, 120832
    buffer_load_dwordx4 a[64:67], v1, s[4:7], s23 offen offset:0
    buffer_load_dwordx4 a[68:71], v1, s[4:7], s23 offen offset:1024
    s_add_u32 s23, s22, 122880
    buffer_load_dwordx4 a[72:75], v1, s[4:7], s23 offen offset:0
    buffer_load_dwordx4 a[76:79], v1, s[4:7], s23 offen offset:1024
    s_add_u32 s23, s22, 124928
    buffer_load_dwordx4 a[80:83], v1, s[4:7], s23 offen offset:0
    buffer_load_dwordx4 a[84:87], v1, s[4:7], s23 offen offset:1024
    s_add_u32 s23, s22, 126976
    buffer_load_dwordx4 a[88:91], v1, s[4:7], s23 offen offset:0
    buffer_load_dwordx4 a[92:95], v1, s[4:7], s23 offen offset:1024
    s_add_u32 s23, s22, 114688
    buffer_load_dwordx4 a[96:99], v1, s[4:7], s23 offen offset:0
    buffer_load_dwordx4 a[100:103], v1, s[4:7], s23 offen offset:1024
    s_add_u32 s23, s22, 116736
    buffer_load_dwordx4 a[104:107], v1, s[4:7], s23 offen offset:0
    buffer_load_dwordx4 a[108:111], v1, s[4:7], s23 offen offset:1024
    s_add_u32 s23, s22, 133120
    buffer_load_dwordx4 a[112:115], v1, s[4:7], s23 offen offset:0
    buffer_load_dwordx4 a[116:119], v1, s[4:7], s23 offen offset:1024
    s_add_u32 s23, s22, 135168
    buffer_load_dwordx4 a[120:123], v1, s[4:7], s23 offen offset:0
    buffer_load_dwordx4 a[124:127], v1, s[4:7], s23 offen offset:1024
    s_add_u32 s23, s22, 137216
    buffer_load_dwordx4 a[128:131], v1, s[4:7], s23 offen offset:0
    buffer_load_dwordx4 a[132:135], v1, s[4:7], s23 offen offset:1024
    s_add_u32 s23, s22, 139264
    buffer_load_dwordx4 a[136:139], v1, s[4:7], s23 offen offset:0
    buffer_load_dwordx4 a[140:143], v1, s[4:7], s23 offen offset:1024
    s_add_u32 s23, s22, 141312
    buffer_load_dwordx4 a[144:147], v1, s[4:7], s23 offen offset:0
    buffer_load_dwordx4 a[148:151], v1, s[4:7], s23 offen offset:1024
    s_add_u32 s23, s22, 129024
    buffer_load_dwordx4 a[152:155], v1, s[4:7], s23 offen offset:0
    buffer_load_dwordx4 a[156:159], v1, s[4:7], s23 offen offset:1024
    s_add_u32 s23, s22, 131072
    buffer_load_dwordx4 a[160:163], v1, s[4:7], s23 offen offset:0
    buffer_load_dwordx4 a[164:167], v1, s[4:7], s23 offen offset:1024
    s_waitcnt vmcnt(40)
    s_add_u32 s23, s22, 147456
    buffer_load_dwordx4 a[168:171], v1, s[4:7], s23 offen offset:0
    buffer_load_dwordx4 a[172:175], v1, s[4:7], s23 offen offset:1024
    s_add_u32 s23, s22, 149504
    buffer_load_dwordx4 a[176:179], v1, s[4:7], s23 offen offset:0
    buffer_load_dwordx4 a[180:183], v1, s[4:7], s23 offen offset:1024
    s_add_u32 s23, s22, 151552
    buffer_load_dwordx4 a[184:187], v1, s[4:7], s23 offen offset:0
    buffer_load_dwordx4 a[188:191], v1, s[4:7], s23 offen offset:1024
    s_add_u32 s23, s22, 153600
    buffer_load_dwordx4 a[192:195], v1, s[4:7], s23 offen offset:0
    buffer_load_dwordx4 a[196:199], v1, s[4:7], s23 offen offset:1024
    s_add_u32 s23, s22, 155648
    buffer_load_dwordx4 a[200:203], v1, s[4:7], s23 offen offset:0
    buffer_load_dwordx4 a[204:207], v1, s[4:7], s23 offen offset:1024
    s_add_u32 s23, s22, 143360
    buffer_load_dwordx4 a[208:211], v1, s[4:7], s23 offen offset:0
    buffer_load_dwordx4 a[212:215], v1, s[4:7], s23 offen offset:1024
    s_add_u32 s23, s22, 145408
    buffer_load_dwordx4 a[216:219], v1, s[4:7], s23 offen offset:0
    buffer_load_dwordx4 a[220:223], v1, s[4:7], s23 offen offset:1024
    s_waitcnt vmcnt(40)
    s_add_u32 s23, s22, 161792
    buffer_load_dwordx4 a[224:227], v1, s[4:7], s23 offen offset:0
    buffer_load_dwordx4 a[228:231], v1, s[4:7], s23 offen offset:1024
    s_add_u32 s23, s22, 163840
    buffer_load_dwordx4 a[232:235], v1, s[4:7], s23 offen offset:0
    buffer_load_dwordx4 a[236:239], v1, s[4:7], s23 offen offset:1024
    s_add_u32 s23, s22, 165888
    buffer_load_dwordx4 a[240:243], v1, s[4:7], s23 offen offset:0
    buffer_load_dwordx4 a[244:247], v1, s[4:7], s23 offen offset:1024
    s_add_u32 s23, s22, 167936
    buffer_load_dwordx4 a[248:251], v1, s[4:7], s23 offen offset:0
    buffer_load_dwordx4 a[252:255], v1, s[4:7], s23 offen offset:1024
    s_add_u32 s23, s22, 169984
    buffer_load_dwordx4 v[120:123], v1, s[4:7], s23 offen offset:0
    buffer_load_dwordx4 v[124:127], v1, s[4:7], s23 offen offset:1024
    s_add_u32 s23, s22, 157696
    buffer_load_dwordx4 v[128:131], v1, s[4:7], s23 offen offset:0
    buffer_load_dwordx4 v[132:135], v1, s[4:7], s23 offen offset:1024
    s_add_u32 s23, s22, 159744
    buffer_load_dwordx4 v[136:139], v1, s[4:7], s23 offen offset:0
    buffer_load_dwordx4 v[140:143], v1, s[4:7], s23 offen offset:1024
    s_waitcnt vmcnt(40)
    s_add_u32 s23, s22, 176128
    buffer_load_dwordx4 v[144:147], v1, s[4:7], s23 offen offset:0
    buffer_load_dwordx4 v[148:151], v1, s[4:7], s23 offen offset:1024
    s_add_u32 s23, s22, 178176
    buffer_load_dwordx4 v[152:155], v1, s[4:7], s23 offen offset:0
    buffer_load_dwordx4 v[156:159], v1, s[4:7], s23 offen offset:1024
    s_add_u32 s23, s22, 180224
    buffer_load_dwordx4 v[160:163], v1, s[4:7], s23 offen offset:0
    buffer_load_dwordx4 v[164:167], v1, s[4:7], s23 offen offset:1024
    s_add_u32 s23, s22, 182272
    buffer_load_dwordx4 v[168:171], v1, s[4:7], s23 offen offset:0
    buffer_load_dwordx4 v[172:175], v1, s[4:7], s23 offen offset:1024
    s_add_u32 s23, s22, 184320
    buffer_load_dwordx4 v[176:179], v1, s[4:7], s23 offen offset:0
    buffer_load_dwordx4 v[180:183], v1, s[4:7], s23 offen offset:1024
    s_add_u32 s23, s22, 172032
    buffer_load_dwordx4 v[184:187], v1, s[4:7], s23 offen offset:0
    buffer_load_dwordx4 v[188:191], v1, s[4:7], s23 offen offset:1024
    s_add_u32 s23, s22, 174080
    buffer_load_dwordx4 v[192:195], v1, s[4:7], s23 offen offset:0
    buffer_load_dwordx4 v[196:199], v1, s[4:7], s23 offen offset:1024
    s_waitcnt vmcnt(40)
    s_add_u32 s23, s22, 190464
    buffer_load_dwordx4 v[200:203], v1, s[4:7], s23 offen offset:0
    buffer_load_dwordx4 v[204:207], v1, s[4:7], s23 offen offset:1024
    s_add_u32 s23, s22, 192512
    buffer_load_dwordx4 v[208:211], v1, s[4:7], s23 offen offset:0
    buffer_load_dwordx4 v[212:215], v1, s[4:7], s23 offen offset:1024
    s_add_u32 s23, s22, 194560
    buffer_load_dwordx4 v[216:219], v1, s[4:7], s23 offen offset:0
    buffer_load_dwordx4 v[220:223], v1, s[4:7], s23 offen offset:1024
    s_add_u32 s23, s22, 196608
    buffer_load_dwordx4 v[224:227], v1, s[4:7], s23 offen offset:0
    buffer_load_dwordx4 v[228:231], v1, s[4:7], s23 offen offset:1024
    s_add_u32 s23, s22, 198656
    buffer_load_dwordx4 v[232:235], v1, s[4:7], s23 offen offset:0
    buffer_load_dwordx4 v[236:239], v1, s[4:7], s23 offen offset:1024
    s_add_u32 s23, s22, 186368
    buffer_load_dwordx4 v[240:243], v1, s[4:7], s23 offen offset:0
    buffer_load_dwordx4 v[244:247], v1, s[4:7], s23 offen offset:1024
    s_add_u32 s23, s22, 188416
    buffer_load_dwordx4 v[248:251], v1, s[4:7], s23 offen offset:0
    buffer_load_dwordx4 v[252:255], v1, s[4:7], s23 offen offset:1024
    s_waitcnt vmcnt(40)
    s_cmp_lg_u32 s94, 0
    s_cbranch_scc1 Lvf_23
    v_and_b32 v45, 31, v0
    v_lshlrev_b32 v45, 2, v45
Lvf_22:
    buffer_load_dword v44, v45, s[12:15], 0 offen offset:128 sc1
    s_sub_u32 s19, s19, 1
    s_cbranch_scc1 main_kernel_exit
    s_waitcnt vmcnt(0)
    v_cmp_eq_u32 vcc, 0, v44
    s_cbranch_vccnz Lvf_22
    v_readfirstlane_b32 s94, v44
    s_nop 1
    v_cmp_ne_u32 vcc, s94, v44
    s_cbranch_vccnz main_kernel_census
Lvf_23:
    v_and_b32 v5, 0x37, v0
    v_lshlrev_b32 v5, 2, v5
    v_add_u32 v5, 20000, v5
    v_lshlrev_b32 v10, 2, v0
    v_mov_b32 v44, 0
    v_mov_b32 v45, 0
    v_mov_b32 v46, 0
    v_mov_b32 v47, 0
    v_mov_b32 v48, 0
    v_mov_b32 v49, 0
    v_mov_b32 v50, 0
    v_mov_b32 v51, 0
    v_mov_b32 v52, 0
    v_mov_b32 v53, 0
    v_mov_b32 v54, 0
    v_mov_b32 v55, 0
    v_mov_b32 v56, 0
    v_mov_b32 v57, 0
    v_mov_b32 v58, 0
    v_mov_b32 v59, 0
    v_mov_b32 v60, 0
    v_mov_b32 v61, 0
    v_mov_b32 v62, 0
    v_mov_b32 v63, 0
    v_mov_b32 v64, 0
    v_mov_b32 v65, 0
    v_mov_b32 v66, 0
    v_mov_b32 v67, 0
    v_mov_b32 v68, 0
    v_mov_b32 v69, 0
    v_mov_b32 v70, 0
    v_mov_b32 v71, 0
    s_waitcnt vmcnt(0) lgkmcnt(0)
    buffer_load_dwordx4 v[16:19], v1, s[4:7], s20 offen sc1
    buffer_load_dwordx4 v[20:23], v1, s[4:7], s21 offen sc1
    buffer_load_dwordx4 v[16:19], v1, s[4:7], s20 offen sc1
    buffer_load_dwordx4 v[20:23], v1, s[4:7], s21 offen sc1
LA_24:
    s_branch Lok_26
Lpm_25:
    buffer_load_dwordx4 v[16:19], v1, s[4:7], s20 offen sc1
    buffer_load_dwordx4 v[20:23], v1, s[4:7], s21 offen sc1
    s_sub_u32 s19, s19, 1
    s_cbranch_scc1 main_kernel_exit
    s_nop 2
    v_mov_b32 v44, 0
    v_mov_b32 v45, 0
    v_mov_b32 v46, 0
    v_mov_b32 v47, 0
    v_mov_b32 v48, 0
    v_mov_b32 v49, 0
    v_mov_b32 v50, 0
    v_mov_b32 v51, 0
Lok_26:
    s_waitcnt vmcnt(3)
    v_max3_u32 v13, v16, v17, v18
    s_waitcnt vmcnt(2)
    v_max3_u32 v15, v20, v21, v22
    v_max3_u32 v13, v19, v23, v13
    v_smfmac_f32_16x16x64_bf16 v[44:47], v[16:19], a[0:7], v2
    v_max_u32 v13, v13, v15
    v_cmp_eq_u32 vcc, -1, v13
    v_smfmac_f32_16x16x64_bf16 v[48:51], v[16:19], a[56:63], v2
    ds_write_b128 v1, v[16:19] offset:2048
    s_cbranch_vccnz Lpm_25
    v_smfmac_f32_16x16x64_bf16 v[52:55], v[16:19], a[112:119], v2
    v_smfmac_f32_16x16x64_bf16 v[56:59], v[16:19], a[168:175], v2
    v_smfmac_f32_16x16x64_bf16 v[60:63], v[16:19], a[224:231], v2
    ds_write_b128 v1, v[20:23] offset:3072
    v_smfmac_f32_16x16x64_bf16 v[64:67], v[16:19], v[144:151], v2
    buffer_load_dwordx4 v[72:75], v1, s[4:7], s27 offen offset:0
    v_smfmac_f32_16x16x64_bf16 v[68:71], v[16:19], v[200:207], v2
    buffer_load_dwordx4 v[76:79], v1, s[4:7], s27 offen offset:1024
    v_smfmac_f32_16x16x64_bf16 v[44:47], v[20:23], a[8:15], v2
    buffer_load_dwordx4 v[88:91], v1, s[4:7], s28 offen offset:0
    v_smfmac_f32_16x16x64_bf16 v[48:51], v[20:23], a[64:71], v2
    buffer_load_dwordx4 v[92:95], v1, s[4:7], s28 offen offset:1024
    v_smfmac_f32_16x16x64_bf16 v[52:55], v[20:23], a[120:127], v2
    s_waitcnt lgkmcnt(0)
    s_barrier
    ds_read_b128 v[24:27], v1 offset:4096
    v_smfmac_f32_16x16x64_bf16 v[56:59], v[20:23], a[176:183], v2
    ds_read_b128 v[28:31], v1 offset:5120
    v_smfmac_f32_16x16x64_bf16 v[60:63], v[20:23], a[232:239], v2
    ds_read_b128 v[32:35], v1 offset:6144
    v_smfmac_f32_16x16x64_bf16 v[64:67], v[20:23], v[152:159], v2
    ds_read_b128 v[36:39], v1 offset:0
    v_smfmac_f32_16x16x64_bf16 v[68:71], v[20:23], v[208:215], v2
    ds_read_b128 v[40:43], v1 offset:1024
    s_waitcnt lgkmcnt(4)
    v_smfmac_f32_16x16x64_bf16 v[44:47], v[24:27], a[16:23], v2
    s_waitcnt lgkmcnt(3)
    v_smfmac_f32_16x16x64_bf16 v[44:47], v[28:31], a[24:31], v2
    s_waitcnt lgkmcnt(1)
    v_smfmac_f32_16x16x64_bf16 v[44:47], v[32:35], a[32:39], v2
    buffer_load_dwordx4 v[80:83], v1, s[4:7], s27 offen offset:2048
    v_smfmac_f32_16x16x64_bf16 v[44:47], v[36:39], a[40:47], v2
    s_waitcnt lgkmcnt(0)
    v_smfmac_f32_16x16x64_bf16 v[44:47], v[40:43], a[48:55], v2
    ds_read_b128 v[104:107], v7 offset:1792
    v_smfmac_f32_16x16x64_bf16 v[48:51], v[24:27], a[72:79], v2
    buffer_load_dwordx4 v[84:87], v6, s[4:7], s27 offen offset:3072
    v_smfmac_f32_16x16x64_bf16 v[48:51], v[28:31], a[80:87], v2
    ds_read_b128 v[108:111], v7 offset:2304
    v_smfmac_f32_16x16x64_bf16 v[48:51], v[32:35], a[88:95], v2
    v_add_f32 v44, v44, v46
    v_smfmac_f32_16x16x64_bf16 v[48:51], v[36:39], a[96:103], v2
    v_add_f32 v45, v45, v47
    v_smfmac_f32_16x16x64_bf16 v[48:51], v[40:43], a[104:111], v2
    v_cvt_pk_bf16_f32 v44, v44, v45
    v_smfmac_f32_16x16x64_bf16 v[52:55], v[24:27], a[128:135], v2
    ds_write_b32 v3, v44 offset:0
    ds_read_b128 v[112:115], v7 offset:2816
    v_smfmac_f32_16x16x64_bf16 v[52:55], v[28:31], a[136:143], v2
    buffer_load_dwordx4 v[96:99], v1, s[4:7], s28 offen offset:2048
    v_smfmac_f32_16x16x64_bf16 v[52:55], v[32:35], a[144:151], v2
    v_add_f32 v48, v48, v50
    v_smfmac_f32_16x16x64_bf16 v[52:55], v[36:39], a[152:159], v2
    v_add_f32 v49, v49, v51
    v_smfmac_f32_16x16x64_bf16 v[52:55], v[40:43], a[160:167], v2
    v_cvt_pk_bf16_f32 v48, v48, v49
    v_smfmac_f32_16x16x64_bf16 v[56:59], v[24:27], a[184:191], v2
    ds_write_b32 v3, v48 offset:256
    ds_read_b128 v[116:119], v7 offset:3328
    v_smfmac_f32_16x16x64_bf16 v[56:59], v[28:31], a[192:199], v2
    buffer_load_dwordx4 v[100:103], v6, s[4:7], s28 offen offset:3072
    v_smfmac_f32_16x16x64_bf16 v[56:59], v[32:35], a[200:207], v2
    v_add_f32 v52, v52, v54
    v_smfmac_f32_16x16x64_bf16 v[56:59], v[36:39], a[208:215], v2
    v_add_f32 v53, v53, v55
    v_smfmac_f32_16x16x64_bf16 v[56:59], v[40:43], a[216:223], v2
    v_cvt_pk_bf16_f32 v52, v52, v53
    v_smfmac_f32_16x16x64_bf16 v[60:63], v[24:27], a[240:247], v2
    ds_write_b32 v3, v52 offset:512
    s_waitcnt vmcnt(8)
    v_smfmac_f32_16x16x64_bf16 v[60:63], v[28:31], a[248:255], v2
    ds_read_b128 v[16:19], v1 offset:24064
    v_smfmac_f32_16x16x64_bf16 v[60:63], v[32:35], v[120:127], v2
    v_add_f32 v56, v56, v58
    v_smfmac_f32_16x16x64_bf16 v[60:63], v[36:39], v[128:135], v2
    v_add_f32 v57, v57, v59
    v_smfmac_f32_16x16x64_bf16 v[60:63], v[40:43], v[136:143], v2
    v_cvt_pk_bf16_f32 v56, v56, v57
    v_smfmac_f32_16x16x64_bf16 v[64:67], v[24:27], v[160:167], v2
    ds_write_b32 v3, v56 offset:768
    ds_read_b128 v[20:23], v1 offset:24064
    v_smfmac_f32_16x16x64_bf16 v[64:67], v[28:31], v[168:175], v2
    ds_read_b64_tr_b16 v[48:49], v4
    v_smfmac_f32_16x16x64_bf16 v[64:67], v[32:35], v[176:183], v2
    v_add_f32 v60, v60, v62
    v_smfmac_f32_16x16x64_bf16 v[64:67], v[36:39], v[184:191], v2
    v_add_f32 v61, v61, v63
    v_smfmac_f32_16x16x64_bf16 v[64:67], v[40:43], v[192:199], v2
    v_cvt_pk_bf16_f32 v60, v60, v61
    v_smfmac_f32_16x16x64_bf16 v[68:71], v[24:27], v[216:223], v2
    ds_write_b32 v3, v60 offset:1024
    ds_read_b128 v[44:47], v1 offset:24064
    v_smfmac_f32_16x16x64_bf16 v[68:71], v[28:31], v[224:231], v2
    ds_read_b64_tr_b16 v[50:51], v4 offset:128
    v_smfmac_f32_16x16x64_bf16 v[68:71], v[32:35], v[232:239], v2
    v_add_f32 v64, v64, v66
    v_smfmac_f32_16x16x64_bf16 v[68:71], v[36:39], v[240:247], v2
    v_add_f32 v65, v65, v67
    v_smfmac_f32_16x16x64_bf16 v[68:71], v[40:43], v[248:255], v2
    v_cvt_pk_bf16_f32 v64, v64, v65
    ds_write_b32 v3, v64 offset:1280
    s_waitcnt vmcnt(4) lgkmcnt(1)
    v_smfmac_f32_16x16x64_bf16 v[16:19], v[48:51], v[72:79], v2
    v_smfmac_f32_16x16x64_bf16 v[20:23], v[48:51], v[88:95], v2
    v_add_f32 v68, v68, v70
    v_add_f32 v69, v69, v71
    v_cvt_pk_bf16_f32 v68, v68, v69
    ds_write_b32 v3, v68 offset:1536
    ds_read_b64_tr_b16 v[52:53], v4 offset:1024
    ds_read_b64_tr_b16 v[54:55], v4 offset:1152
    v_smfmac_f32_16x16x64_bf16 v[44:47], v[48:51], v[104:111], v2
    s_nop 1
    v_mov_b32 v64, 0
    s_nop 1
    v_mov_b32 v65, 0
    s_nop 1
    v_mov_b32 v66, 0
    s_waitcnt vmcnt(0) lgkmcnt(0)
    v_smfmac_f32_16x16x64_bf16 v[16:19], v[52:55], v[80:87], v2
    v_smfmac_f32_16x16x64_bf16 v[20:23], v[52:55], v[96:103], v2
    v_smfmac_f32_16x16x64_bf16 v[44:47], v[52:55], v[112:119], v2
    s_cmp_eq_u32 s37, 1
    v_add_f32 v56, v16, v18
    v_add_f32 v60, v17, v19
    s_nop 1
    v_add_f32 v57, v20, v22
    ds_write_b64 v9, v[56:57] offset:16384
    v_add_f32 v61, v21, v23
    v_add_f32_dpp v58, v44, v46 quad_perm:[0,1,2,3] row_mask:0xf bank_mask:3
    v_add_f32_dpp v58, v45, v47 quad_perm:[0,1,2,3] row_mask:0xf bank_mask:12
    ds_write_b32 v10, v58 offset:20224
    s_nop 2
    v_mov_b32 v68, 0
    s_nop 2
    v_mov_b32 v69, 0
    s_nop 2
    v_mov_b32 v70, 0
    s_waitcnt lgkmcnt(0)
    s_barrier
    ds_read2st64_b64 v[24:27], v9 offset0:37 offset1:38
    ds_read_b64 v[28:29], v9 offset:17920
    ds_read2st64_b32 v[30:31], v5 offset0:0 offset1:1
    ds_read2st64_b32 v[32:33], v5 offset0:2 offset1:3
    s_waitcnt lgkmcnt(3)
    v_pk_add_f32 v[60:61], v[60:61], v[24:25]
    v_pk_add_f32 v[60:61], v[60:61], v[26:27]
    s_waitcnt lgkmcnt(2)
    v_pk_add_f32 v[60:61], v[60:61], v[28:29]
    v_exp_f32 v36, v60
    s_waitcnt lgkmcnt(0)
    v_pk_add_f32 v[30:31], v[30:31], v[32:33]
    v_exp_f32 v37, v61
    v_add_f32 v62, v30, v31
    v_exp_f32 v38, v62
    v_add_f32 v39, v36, v37
    v_fma_f32 v39, v38, 0.5, v39
    v_max3_f32 v13, |v60|, |v61|, |v62|
    v_cmp_nge_f32 vcc, 0x42800000, v13
    v_add_f32_dpp v39, v39, v39 row_ror:8 row_mask:0xf bank_mask:0xf
    s_nop 1
    v_add_f32_dpp v39, v39, v39 row_ror:4 row_mask:0xf bank_mask:0xf
    s_nop 1
    v_add_f32_dpp v39, v39, v39 row_ror:2 row_mask:0xf bank_mask:0xf
    s_nop 1
    v_add_f32_dpp v39, v39, v39 row_ror:1 row_mask:0xf bank_mask:0xf
    v_rcp_f32 v39, v39
    s_cbranch_vccnz Lslow_29
Lback_30:
    v_mul_f32 v36, v36, v39
    v_mul_f32 v37, v37, v39
    v_mul_f32 v38, v38, v39
    v_cvt_pk_bf16_f32 v36, |v36|, |v37|
    v_cvt_pk_bf16_f32 v38, |v38|, |v38|
    s_cbranch_scc1 Ls_27
    buffer_store_dword v36, v11, s[4:7], s26 offen
    buffer_store_short v38, v12, s[4:7], s26 offen offset:2048
Ls_28:
    s_add_u32 s26, s26, 47104
    s_barrier
    s_add_u32 s27, s27, 47104
    s_add_u32 s28, s28, 47104
    s_add_u32 s38, s38, 458752
    s_add_u32 s30, s30, 47104
    s_add_u32 s20, s20, 47104
    s_add_u32 s21, s21, 47104
    s_add_u32 s18, s18, 1
    s_cmp_ge_u32 s18, 63
    s_cbranch_scc1 main_kernel_exit
    s_sleep 11
    s_nop 3
    v_mov_b32 v44, 0
    s_nop 1
    v_mov_b32 v45, 0
    s_nop 1
    v_mov_b32 v46, 0
    s_nop 1
    v_mov_b32 v47, 0
    s_nop 1
    v_mov_b32 v48, 0
    s_nop 1
    v_mov_b32 v49, 0
    s_nop 1
    v_mov_b32 v50, 0
    s_nop 1
    v_mov_b32 v51, 0
    s_nop 1
    v_mov_b32 v52, 0
    s_nop 1
    v_mov_b32 v53, 0
    s_nop 1
    v_mov_b32 v54, 0
    s_nop 1
    v_mov_b32 v55, 0
    s_nop 1
    v_mov_b32 v56, 0
    s_nop 1
    v_mov_b32 v57, 0
    s_nop 1
    v_mov_b32 v58, 0
    s_nop 1
    buffer_load_dwordx4 v[16:19], v1, s[4:7], s20 offen sc1
    buffer_load_dwordx4 v[20:23], v1, s[4:7], s21 offen sc1
    v_mov_b32 v59, 0
    s_nop 1
    v_mov_b32 v60, 0
    s_nop 1
    v_mov_b32 v61, 0
    s_nop 1
    v_mov_b32 v62, 0
    s_nop 1
    v_mov_b32 v63, 0
    s_nop 1
    v_mov_b32 v64, 0
    s_nop 1
    buffer_load_dwordx4 v[16:19], v1, s[4:7], s20 offen sc1
    buffer_load_dwordx4 v[20:23], v1, s[4:7], s21 offen sc1
    v_mov_b32 v65, 0
    s_nop 1
    v_mov_b32 v66, 0
    s_nop 1
    v_mov_b32 v67, 0
    s_nop 1
    v_mov_b32 v68, 0
    s_nop 1
    v_mov_b32 v69, 0
    s_nop 1
    v_mov_b32 v70, 0
    s_nop 1
    v_mov_b32 v71, 0
    s_nop 1
    s_branch LA_24
Ls_27:
    buffer_store_dword v36, v11, s[4:7], s26 offen sc1
    buffer_store_short v38, v12, s[4:7], s26 offen offset:2048 sc1
    s_branch Ls_28
Lslow_29:
    v_max3_f32 v13, v60, v61, v62
    s_nop 1
    v_max_f32_dpp v13, v13, v13 row_ror:8 row_mask:0xf bank_mask:0xf
    s_nop 1
    v_max_f32_dpp v13, v13, v13 row_ror:4 row_mask:0xf bank_mask:0xf
    s_nop 1
    v_max_f32_dpp v13, v13, v13 row_ror:2 row_mask:0xf bank_mask:0xf
    s_nop 1
    v_max_f32_dpp v13, v13, v13 row_ror:1 row_mask:0xf bank_mask:0xf
    v_sub_f32 v60, v60, v13
    v_exp_f32 v36, v60
    v_sub_f32 v61, v61, v13
    v_exp_f32 v37, v61
    v_sub_f32 v62, v62, v13
    v_exp_f32 v38, v62
    s_nop 0
    v_add_f32 v39, v36, v37
    v_fma_f32 v39, v38, 0.5, v39
    s_nop 1
    v_add_f32_dpp v39, v39, v39 row_ror:8 row_mask:0xf bank_mask:0xf
    s_nop 1
    v_add_f32_dpp v39, v39, v39 row_ror:4 row_mask:0xf bank_mask:0xf
    s_nop 1
    v_add_f32_dpp v39, v39, v39 row_ror:2 row_mask:0xf bank_mask:0xf
    s_nop 1
    v_add_f32_dpp v39, v39, v39 row_ror:1 row_mask:0xf bank_mask:0xf
    v_rcp_f32 v39, v39
    s_branch Lback_30
.p2align 6
LteamA2_5:
    v_lshlrev_b32 v1, 4, v0
    v_mov_b32 v2, 0x44444444
    v_mov_b32 v13, 0xeeeeeeee
    v_and_b32 v14, 2, v0
    v_cmp_ne_u32 vcc, 0, v14
    s_nop 1
    v_cndmask_b32 v2, v2, v13, vcc
    v_mov_b32 v13, 0
    v_lshlrev_b32 v14, 2, v0
    ds_write_b32 v14, v13 offset:24576
    s_mov_b32 s18, 0
    s_mov_b32 s34, 42222592
    s_mov_b64 s[82:83], 0
    s_and_b32 s84, s17, 15
    s_lshl_b32 s84, s84, 8
    s_add_u32 s84, s84, 54767616
    s_mov_b32 s20, 42209280
    s_mov_b32 s21, 42210304
    v_and_b32 v13, 15, v0
    v_lshrrev_b32 v14, 4, v0
    v_and_b32 v15, 1, v14
    v_and_b32 v6, 0x1f0, v1
    v_lshrrev_b32 v3, 2, v13
    v_lshlrev_b32 v3, 6, v3
    v_and_b32 v5, 1, v0
    v_lshl_add_u32 v3, v5, 5, v3
    v_lshl_add_u32 v3, v14, 3, v3
    v_bfe_u32 v5, v0, 1, 1
    v_lshl_add_u32 v3, v5, 2, v3
    v_add_u32 v3, 11520, v3
    v_lshlrev_b32 v4, 8, v14
    v_lshl_add_u32 v4, v13, 3, v4
    v_add_u32 v4, 11520, v4
    v_bfe_u32 v7, v0, 1, 1
    v_lshlrev_b32 v7, 7, v7
    v_bfe_u32 v5, v0, 2, 1
    v_lshl_add_u32 v7, v5, 6, v7
    v_lshl_add_u32 v7, v15, 5, v7
    v_and_b32 v5, 1, v0
    v_lshl_add_u32 v7, v5, 4, v7
    v_lshrrev_b32 v5, 5, v0
    v_lshl_add_u32 v7, v5, 8, v7
    v_lshlrev_b32 v5, 6, v14
    v_bfe_u32 v8, v0, 2, 1
    v_lshl_add_u32 v5, v8, 5, v5
    v_add_u32 v5, 0, v5
    v_lshrrev_b32 v8, 3, v13
    v_lshl_add_u32 v11, v8, 8, v5
    v_and_b32 v8, 3, v0
    v_lshl_add_u32 v11, v8, 2, v11
    v_lshl_add_u32 v12, v8, 1, v5
    s_and_b32 s24, s17, 3
    s_lshl_b32 s25, s24, 9
    v_add_u32 v11, s25, v11
    s_lshr_b32 s25, s24, 1
    s_lshl_b32 s25, s25, 8
    s_and_b32 s24, s24, 1
    s_lshl_b32 s24, s24, 3
    s_add_u32 s25, s25, s24
    v_add_u32 v12, s25, v12
    s_lshr_b32 s26, s17, 2
    s_mul_i32 s26, s26, 2560
    s_add_u32 s26, s26, 42212352
    v_lshlrev_b32 v9, 3, v0
    v_mov_b32 v10, 0
    v_mov_b32 v13, 0
    v_lshlrev_b32 v14, 2, v0
    ds_write_b32 v14, v13 offset:13312
    ds_write_b32 v14, v13 offset:7168
    s_mul_i32 s22, s17, 401408
    s_add_u32 s22, s22, 0
    v_lshlrev_b32 v8, 7, v0
    v_min_u32 v5, 2816, v8
    s_mul_i32 s30, s17, 2944
    s_add_u32 s30, s30, 42252288
    s_mul_i32 s38, s17, 28672
    s_add_u32 s38, s38, 12845312
    v_min_u32 v8, 7040, v8
    v_lshlrev_b32 v8, 2, v8
    s_mov_b32 s27, 42230784
    s_mov_b32 s28, 42245120
    s_add_u32 s23, s22, 208896
    buffer_load_dwordx4 a[0:3], v1, s[4:7], s23 offen offset:0
    buffer_load_dwordx4 a[4:7], v1, s[4:7], s23 offen offset:1024
    s_add_u32 s23, s22, 210944
    buffer_load_dwordx4 a[8:11], v1, s[4:7], s23 offen offset:0
    buffer_load_dwordx4 a[12:15], v1, s[4:7], s23 offen offset:1024
    s_add_u32 s23, s22, 212992
    buffer_load_dwordx4 a[16:19], v1, s[4:7], s23 offen offset:0
    buffer_load_dwordx4 a[20:23], v1, s[4:7], s23 offen offset:1024
    s_add_u32 s23, s22, 200704
    buffer_load_dwordx4 a[24:27], v1, s[4:7], s23 offen offset:0
    buffer_load_dwordx4 a[28:31], v1, s[4:7], s23 offen offset:1024
    s_add_u32 s23, s22, 202752
    buffer_load_dwordx4 a[32:35], v1, s[4:7], s23 offen offset:0
    buffer_load_dwordx4 a[36:39], v1, s[4:7], s23 offen offset:1024
    s_add_u32 s23, s22, 204800
    buffer_load_dwordx4 a[40:43], v1, s[4:7], s23 offen offset:0
    buffer_load_dwordx4 a[44:47], v1, s[4:7], s23 offen offset:1024
    s_add_u32 s23, s22, 206848
    buffer_load_dwordx4 a[48:51], v1, s[4:7], s23 offen offset:0
    buffer_load_dwordx4 a[52:55], v1, s[4:7], s23 offen offset:1024
    s_add_u32 s23, s22, 223232
    buffer_load_dwordx4 a[56:59], v1, s[4:7], s23 offen offset:0
    buffer_load_dwordx4 a[60:63], v1, s[4:7], s23 offen offset:1024
    s_add_u32 s23, s22, 225280
    buffer_load_dwordx4 a[64:67], v1, s[4:7], s23 offen offset:0
    buffer_load_dwordx4 a[68:71], v1, s[4:7], s23 offen offset:1024
    s_add_u32 s23, s22, 227328
    buffer_load_dwordx4 a[72:75], v1, s[4:7], s23 offen offset:0
    buffer_load_dwordx4 a[76:79], v1, s[4:7], s23 offen offset:1024
    s_add_u32 s23, s22, 215040
    buffer_load_dwordx4 a[80:83], v1, s[4:7], s23 offen offset:0
    buffer_load_dwordx4 a[84:87], v1, s[4:7], s23 offen offset:1024
    s_add_u32 s23, s22, 217088
    buffer_load_dwordx4 a[88:91], v1, s[4:7], s23 offen offset:0
    buffer_load_dwordx4 a[92:95], v1, s[4:7], s23 offen offset:1024
    s_add_u32 s23, s22, 219136
    buffer_load_dwordx4 a[96:99], v1, s[4:7], s23 offen offset:0
    buffer_load_dwordx4 a[100:103], v1, s[4:7], s23 offen offset:1024
    s_add_u32 s23, s22, 221184
    buffer_load_dwordx4 a[104:107], v1, s[4:7], s23 offen offset:0
    buffer_load_dwordx4 a[108:111], v1, s[4:7], s23 offen offset:1024
    s_add_u32 s23, s22, 237568
    buffer_load_dwordx4 a[112:115], v1, s[4:7], s23 offen offset:0
    buffer_load_dwordx4 a[116:119], v1, s[4:7], s23 offen offset:1024
    s_add_u32 s23, s22, 239616
    buffer_load_dwordx4 a[120:123], v1, s[4:7], s23 offen offset:0
    buffer_load_dwordx4 a[124:127], v1, s[4:7], s23 offen offset:1024
    s_add_u32 s23, s22, 241664
    buffer_load_dwordx4 a[128:131], v1, s[4:7], s23 offen offset:0
    buffer_load_dwordx4 a[132:135], v1, s[4:7], s23 offen offset:1024
    s_add_u32 s23, s22, 229376
    buffer_load_dwordx4 a[136:139], v1, s[4:7], s23 offen offset:0
    buffer_load_dwordx4 a[140:143], v1, s[4:7], s23 offen offset:1024
    s_add_u32 s23, s22, 231424
    buffer_load_dwordx4 a[144:147], v1, s[4:7], s23 offen offset:0
    buffer_load_dwordx4 a[148:151], v1, s[4:7], s23 offen offset:1024
    s_add_u32 s23, s22, 233472
    buffer_load_dwordx4 a[152:155], v1, s[4:7], s23 offen offset:0
    buffer_load_dwordx4 a[156:159], v1, s[4:7], s23 offen offset:1024
    s_add_u32 s23, s22, 235520
    buffer_load_dwordx4 a[160:163], v1, s[4:7], s23 offen offset:0
    buffer_load_dwordx4 a[164:167], v1, s[4:7], s23 offen offset:1024
    s_waitcnt vmcnt(40)
    s_add_u32 s23, s22, 251904
    buffer_load_dwordx4 a[168:171], v1, s[4:7], s23 offen offset:0
    buffer_load_dwordx4 a[172:175], v1, s[4:7], s23 offen offset:1024
    s_add_u32 s23, s22, 253952
    buffer_load_dwordx4 a[176:179], v1, s[4:7], s23 offen offset:0
    buffer_load_dwordx4 a[180:183], v1, s[4:7], s23 offen offset:1024
    s_add_u32 s23, s22, 256000
    buffer_load_dwordx4 a[184:187], v1, s[4:7], s23 offen offset:0
    buffer_load_dwordx4 a[188:191], v1, s[4:7], s23 offen offset:1024
    s_add_u32 s23, s22, 243712
    buffer_load_dwordx4 a[192:195], v1, s[4:7], s23 offen offset:0
    buffer_load_dwordx4 a[196:199], v1, s[4:7], s23 offen offset:1024
    s_add_u32 s23, s22, 245760
    buffer_load_dwordx4 a[200:203], v1, s[4:7], s23 offen offset:0
    buffer_load_dwordx4 a[204:207], v1, s[4:7], s23 offen offset:1024
    s_add_u32 s23, s22, 247808
    buffer_load_dwordx4 a[208:211], v1, s[4:7], s23 offen offset:0
    buffer_load_dwordx4 a[212:215], v1, s[4:7], s23 offen offset:1024
    s_add_u32 s23, s22, 249856
    buffer_load_dwordx4 a[216:219], v1, s[4:7], s23 offen offset:0
    buffer_load_dwordx4 a[220:223], v1, s[4:7], s23 offen offset:1024
    s_waitcnt vmcnt(40)
    s_add_u32 s23, s22, 266240
    buffer_load_dwordx4 a[224:227], v1, s[4:7], s23 offen offset:0
    buffer_load_dwordx4 a[228:231], v1, s[4:7], s23 offen offset:1024
    s_add_u32 s23, s22, 268288
    buffer_load_dwordx4 a[232:235], v1, s[4:7], s23 offen offset:0
    buffer_load_dwordx4 a[236:239], v1, s[4:7], s23 offen offset:1024
    s_add_u32 s23, s22, 270336
    buffer_load_dwordx4 a[240:243], v1, s[4:7], s23 offen offset:0
    buffer_load_dwordx4 a[244:247], v1, s[4:7], s23 offen offset:1024
    s_add_u32 s23, s22, 258048
    buffer_load_dwordx4 a[248:251], v1, s[4:7], s23 offen offset:0
    buffer_load_dwordx4 a[252:255], v1, s[4:7], s23 offen offset:1024
    s_add_u32 s23, s22, 260096
    buffer_load_dwordx4 v[120:123], v1, s[4:7], s23 offen offset:0
    buffer_load_dwordx4 v[124:127], v1, s[4:7], s23 offen offset:1024
    s_add_u32 s23, s22, 262144
    buffer_load_dwordx4 v[128:131], v1, s[4:7], s23 offen offset:0
    buffer_load_dwordx4 v[132:135], v1, s[4:7], s23 offen offset:1024
    s_add_u32 s23, s22, 264192
    buffer_load_dwordx4 v[136:139], v1, s[4:7], s23 offen offset:0
    buffer_load_dwordx4 v[140:143], v1, s[4:7], s23 offen offset:1024
    s_waitcnt vmcnt(40)
    s_add_u32 s23, s22, 280576
    buffer_load_dwordx4 v[144:147], v1, s[4:7], s23 offen offset:0
    buffer_load_dwordx4 v[148:151], v1, s[4:7], s23 offen offset:1024
    s_add_u32 s23, s22, 282624
    buffer_load_dwordx4 v[152:155], v1, s[4:7], s23 offen offset:0
    buffer_load_dwordx4 v[156:159], v1, s[4:7], s23 offen offset:1024
    s_add_u32 s23, s22, 284672
    buffer_load_dwordx4 v[160:163], v1, s[4:7], s23 offen offset:0
    buffer_load_dwordx4 v[164:167], v1, s[4:7], s23 offen offset:1024
    s_add_u32 s23, s22, 272384
    buffer_load_dwordx4 v[168:171], v1, s[4:7], s23 offen offset:0
    buffer_load_dwordx4 v[172:175], v1, s[4:7], s23 offen offset:1024
    s_add_u32 s23, s22, 274432
    buffer_load_dwordx4 v[176:179], v1, s[4:7], s23 offen offset:0
    buffer_load_dwordx4 v[180:183], v1, s[4:7], s23 offen offset:1024
    s_add_u32 s23, s22, 276480
    buffer_load_dwordx4 v[184:187], v1, s[4:7], s23 offen offset:0
    buffer_load_dwordx4 v[188:191], v1, s[4:7], s23 offen offset:1024
    s_add_u32 s23, s22, 278528
    buffer_load_dwordx4 v[192:195], v1, s[4:7], s23 offen offset:0
    buffer_load_dwordx4 v[196:199], v1, s[4:7], s23 offen offset:1024
    s_waitcnt vmcnt(40)
    s_add_u32 s23, s22, 294912
    buffer_load_dwordx4 v[200:203], v1, s[4:7], s23 offen offset:0
    buffer_load_dwordx4 v[204:207], v1, s[4:7], s23 offen offset:1024
    s_add_u32 s23, s22, 296960
    buffer_load_dwordx4 v[208:211], v1, s[4:7], s23 offen offset:0
    buffer_load_dwordx4 v[212:215], v1, s[4:7], s23 offen offset:1024
    s_add_u32 s23, s22, 299008
    buffer_load_dwordx4 v[216:219], v1, s[4:7], s23 offen offset:0
    buffer_load_dwordx4 v[220:223], v1, s[4:7], s23 offen offset:1024
    s_add_u32 s23, s22, 286720
    buffer_load_dwordx4 v[224:227], v1, s[4:7], s23 offen offset:0
    buffer_load_dwordx4 v[228:231], v1, s[4:7], s23 offen offset:1024
    s_add_u32 s23, s22, 288768
    buffer_load_dwordx4 v[232:235], v1, s[4:7], s23 offen offset:0
    buffer_load_dwordx4 v[236:239], v1, s[4:7], s23 offen offset:1024
    s_add_u32 s23, s22, 290816
    buffer_load_dwordx4 v[240:243], v1, s[4:7], s23 offen offset:0
    buffer_load_dwordx4 v[244:247], v1, s[4:7], s23 offen offset:1024
    s_add_u32 s23, s22, 292864
    buffer_load_dwordx4 v[248:251], v1, s[4:7], s23 offen offset:0
    buffer_load_dwordx4 v[252:255], v1, s[4:7], s23 offen offset:1024
    s_waitcnt vmcnt(40)
    s_cmp_lg_u32 s94, 0
    s_cbranch_scc1 Lvf_32
    v_and_b32 v45, 31, v0
    v_lshlrev_b32 v45, 2, v45
Lvf_31:
    buffer_load_dword v44, v45, s[12:15], 0 offen offset:128 sc1
    s_sub_u32 s19, s19, 1
    s_cbranch_scc1 main_kernel_exit
    s_waitcnt vmcnt(0)
    v_cmp_eq_u32 vcc, 0, v44
    s_cbranch_vccnz Lvf_31
    v_readfirstlane_b32 s94, v44
    s_nop 1
    v_cmp_ne_u32 vcc, s94, v44
    s_cbranch_vccnz main_kernel_census
Lvf_32:
    v_lshlrev_b32 v10, 2, v0
    v_mov_b32 v44, 0
    v_mov_b32 v45, 0
    v_mov_b32 v46, 0
    v_mov_b32 v47, 0
    v_mov_b32 v48, 0
    v_mov_b32 v49, 0
    v_mov_b32 v50, 0
    v_mov_b32 v51, 0
    v_mov_b32 v52, 0
    v_mov_b32 v53, 0
    v_mov_b32 v54, 0
    v_mov_b32 v55, 0
    v_mov_b32 v56, 0
    v_mov_b32 v57, 0
    v_mov_b32 v58, 0
    v_mov_b32 v59, 0
    v_mov_b32 v60, 0
    v_mov_b32 v61, 0
    v_mov_b32 v62, 0
    v_mov_b32 v63, 0
    v_mov_b32 v64, 0
    v_mov_b32 v65, 0
    v_mov_b32 v66, 0
    v_mov_b32 v67, 0
    v_mov_b32 v68, 0
    v_mov_b32 v69, 0
    v_mov_b32 v70, 0
    v_mov_b32 v71, 0
    s_waitcnt vmcnt(0) lgkmcnt(0)
    buffer_load_dwordx4 v[16:19], v1, s[4:7], s20 offen sc1
    buffer_load_dwordx4 v[20:23], v1, s[4:7], s21 offen sc1
    buffer_load_dwordx4 v[16:19], v1, s[4:7], s20 offen sc1
    buffer_load_dwordx4 v[20:23], v1, s[4:7], s21 offen sc1
LA_33:
    s_branch Lok_35
Lpm_34:
    buffer_load_dwordx4 v[16:19], v1, s[4:7], s20 offen sc1
    buffer_load_dwordx4 v[20:23], v1, s[4:7], s21 offen sc1
    s_sub_u32 s19, s19, 1
    s_cbranch_scc1 main_kernel_exit
    s_nop 2
    v_mov_b32 v44, 0
    v_mov_b32 v45, 0
    v_mov_b32 v46, 0
    v_mov_b32 v47, 0
    v_mov_b32 v48, 0
    v_mov_b32 v49, 0
    v_mov_b32 v50, 0
    v_mov_b32 v51, 0
Lok_35:
    s_waitcnt vmcnt(3)
    v_max3_u32 v13, v16, v17, v18
    s_waitcnt vmcnt(2)
    v_max3_u32 v15, v20, v21, v22
    v_max3_u32 v13, v19, v23, v13
    v_smfmac_f32_16x16x64_bf16 v[44:47], v[16:19], a[0:7], v2
    v_max_u32 v13, v13, v15
    v_cmp_eq_u32 vcc, -1, v13
    v_smfmac_f32_16x16x64_bf16 v[48:51], v[16:19], a[56:63], v2
    ds_write_b128 v1, v[16:19] offset:4096
    s_cbranch_vccnz Lpm_34
    v_smfmac_f32_16x16x64_bf16 v[52:55], v[16:19], a[112:119], v2
    v_smfmac_f32_16x16x64_bf16 v[56:59], v[16:19], a[168:175], v2
    v_smfmac_f32_16x16x64_bf16 v[60:63], v[16:19], a[224:231], v2
    ds_write_b128 v1, v[20:23] offset:5120
    v_smfmac_f32_16x16x64_bf16 v[64:67], v[16:19], v[144:151], v2
    buffer_load_dwordx4 v[72:75], v1, s[4:7], s27 offen offset:0
    v_smfmac_f32_16x16x64_bf16 v[68:71], v[16:19], v[200:207], v2
    buffer_load_dwordx4 v[76:79], v1, s[4:7], s27 offen offset:1024
    v_smfmac_f32_16x16x64_bf16 v[44:47], v[20:23], a[8:15], v2
    buffer_load_dwordx4 v[88:91], v1, s[4:7], s28 offen offset:0
    v_smfmac_f32_16x16x64_bf16 v[48:51], v[20:23], a[64:71], v2
    buffer_load_dwordx4 v[92:95], v1, s[4:7], s28 offen offset:1024
    v_smfmac_f32_16x16x64_bf16 v[52:55], v[20:23], a[120:127], v2
    s_waitcnt lgkmcnt(0)
    s_barrier
    ds_read_b128 v[24:27], v1 offset:6144
    v_smfmac_f32_16x16x64_bf16 v[56:59], v[20:23], a[176:183], v2
    ds_read_b128 v[28:31], v1 offset:0
    v_smfmac_f32_16x16x64_bf16 v[60:63], v[20:23], a[232:239], v2
    ds_read_b128 v[32:35], v1 offset:1024
    v_smfmac_f32_16x16x64_bf16 v[64:67], v[20:23], v[152:159], v2
    ds_read_b128 v[36:39], v1 offset:2048
    v_smfmac_f32_16x16x64_bf16 v[68:71], v[20:23], v[208:215], v2
    ds_read_b128 v[40:43], v1 offset:3072
    s_waitcnt lgkmcnt(4)
    v_smfmac_f32_16x16x64_bf16 v[44:47], v[24:27], a[16:23], v2
    s_waitcnt lgkmcnt(3)
    v_smfmac_f32_16x16x64_bf16 v[44:47], v[28:31], a[24:31], v2
    s_waitcnt lgkmcnt(1)
    v_smfmac_f32_16x16x64_bf16 v[44:47], v[32:35], a[32:39], v2
    buffer_load_dwordx4 v[80:83], v1, s[4:7], s27 offen offset:2048
    v_smfmac_f32_16x16x64_bf16 v[44:47], v[36:39], a[40:47], v2
    s_waitcnt lgkmcnt(0)
    v_smfmac_f32_16x16x64_bf16 v[44:47], v[40:43], a[48:55], v2
    ds_read_b128 v[104:107], v7 offset:3584
    v_smfmac_f32_16x16x64_bf16 v[48:51], v[24:27], a[72:79], v2
    buffer_load_dwordx4 v[84:87], v6, s[4:7], s27 offen offset:3072
    v_smfmac_f32_16x16x64_bf16 v[48:51], v[28:31], a[80:87], v2
    ds_read_b128 v[108:111], v7 offset:4096
    v_smfmac_f32_16x16x64_bf16 v[48:51], v[32:35], a[88:95], v2
    v_add_f32 v44, v44, v46
    v_smfmac_f32_16x16x64_bf16 v[48:51], v[36:39], a[96:103], v2
    v_add_f32 v45, v45, v47
    v_smfmac_f32_16x16x64_bf16 v[48:51], v[40:43], a[104:111], v2
    v_cvt_pk_bf16_f32 v44, v44, v45
    v_smfmac_f32_16x16x64_bf16 v[52:55], v[24:27], a[128:135], v2
    ds_write_b32 v3, v44 offset:0
    ds_read_b128 v[112:115], v7 offset:4608
    v_smfmac_f32_16x16x64_bf16 v[52:55], v[28:31], a[136:143], v2
    buffer_load_dwordx4 v[96:99], v1, s[4:7], s28 offen offset:2048
    v_smfmac_f32_16x16x64_bf16 v[52:55], v[32:35], a[144:151], v2
    v_add_f32 v48, v48, v50
    v_smfmac_f32_16x16x64_bf16 v[52:55], v[36:39], a[152:159], v2
    v_add_f32 v49, v49, v51
    v_smfmac_f32_16x16x64_bf16 v[52:55], v[40:43], a[160:167], v2
    v_cvt_pk_bf16_f32 v48, v48, v49
    v_smfmac_f32_16x16x64_bf16 v[56:59], v[24:27], a[184:191], v2
    ds_write_b32 v3, v48 offset:256
    ds_read_b128 v[116:119], v7 offset:5120
    v_smfmac_f32_16x16x64_bf16 v[56:59], v[28:31], a[192:199], v2
    buffer_load_dwordx4 v[100:103], v6, s[4:7], s28 offen offset:3072
    v_smfmac_f32_16x16x64_bf16 v[56:59], v[32:35], a[200:207], v2
    v_add_f32 v52, v52, v54
    v_smfmac_f32_16x16x64_bf16 v[56:59], v[36:39], a[208:215], v2
    v_add_f32 v53, v53, v55
    v_smfmac_f32_16x16x64_bf16 v[56:59], v[40:43], a[216:223], v2
    v_cvt_pk_bf16_f32 v52, v52, v53
    v_smfmac_f32_16x16x64_bf16 v[60:63], v[24:27], a[240:247], v2
    ds_write_b32 v3, v52 offset:512
    s_waitcnt vmcnt(8)
    v_smfmac_f32_16x16x64_bf16 v[60:63], v[28:31], a[248:255], v2
    ds_read_b128 v[16:19], v1 offset:24064
    v_smfmac_f32_16x16x64_bf16 v[60:63], v[32:35], v[120:127], v2
    v_add_f32 v56, v56, v58
    v_smfmac_f32_16x16x64_bf16 v[60:63], v[36:39], v[128:135], v2
    v_add_f32 v57, v57, v59
    v_smfmac_f32_16x16x64_bf16 v[60:63], v[40:43], v[136:143], v2
    v_cvt_pk_bf16_f32 v56, v56, v57
    v_smfmac_f32_16x16x64_bf16 v[64:67], v[24:27], v[160:167], v2
    ds_write_b32 v3, v56 offset:768
    ds_read_b128 v[20:23], v1 offset:24064
    v_smfmac_f32_16x16x64_bf16 v[64:67], v[28:31], v[168:175], v2
    ds_read_b64_tr_b16 v[48:49], v4
    v_smfmac_f32_16x16x64_bf16 v[64:67], v[32:35], v[176:183], v2
    v_add_f32 v60, v60, v62
    v_smfmac_f32_16x16x64_bf16 v[64:67], v[36:39], v[184:191], v2
    v_add_f32 v61, v61, v63
    v_smfmac_f32_16x16x64_bf16 v[64:67], v[40:43], v[192:199], v2
    v_cvt_pk_bf16_f32 v60, v60, v61
    v_smfmac_f32_16x16x64_bf16 v[68:71], v[24:27], v[216:223], v2
    ds_write_b32 v3, v60 offset:1024
    ds_read_b128 v[44:47], v1 offset:24064
    v_smfmac_f32_16x16x64_bf16 v[68:71], v[28:31], v[224:231], v2
    ds_read_b64_tr_b16 v[50:51], v4 offset:128
    v_smfmac_f32_16x16x64_bf16 v[68:71], v[32:35], v[232:239], v2
    v_add_f32 v64, v64, v66
    v_smfmac_f32_16x16x64_bf16 v[68:71], v[36:39], v[240:247], v2
    v_add_f32 v65, v65, v67
    v_smfmac_f32_16x16x64_bf16 v[68:71], v[40:43], v[248:255], v2
    v_cvt_pk_bf16_f32 v64, v64, v65
    ds_write_b32 v3, v64 offset:1280
    s_waitcnt vmcnt(4) lgkmcnt(1)
    v_smfmac_f32_16x16x64_bf16 v[16:19], v[48:51], v[72:79], v2
    v_smfmac_f32_16x16x64_bf16 v[20:23], v[48:51], v[88:95], v2
    v_add_f32 v68, v68, v70
    v_add_f32 v69, v69, v71
    v_cvt_pk_bf16_f32 v68, v68, v69
    ds_write_b32 v3, v68 offset:1536
    ds_read_b64_tr_b16 v[52:53], v4 offset:1024
    ds_read_b64_tr_b16 v[54:55], v4 offset:1152
    v_smfmac_f32_16x16x64_bf16 v[44:47], v[48:51], v[104:111], v2
    s_nop 1
    v_mov_b32 v64, 0
    s_nop 1
    v_mov_b32 v65, 0
    s_nop 1
    v_mov_b32 v66, 0
    s_waitcnt vmcnt(0) lgkmcnt(0)
    v_smfmac_f32_16x16x64_bf16 v[16:19], v[52:55], v[80:87], v2
    v_smfmac_f32_16x16x64_bf16 v[20:23], v[52:55], v[96:103], v2
    v_smfmac_f32_16x16x64_bf16 v[44:47], v[52:55], v[112:119], v2
    s_cmp_eq_u32 s37, 1
    v_add_f32 v60, v17, v19
    v_add_f32 v56, v16, v18
    s_nop 1
    v_add_f32 v61, v21, v23
    ds_write_b64 v9, v[60:61] offset:18944
    v_add_f32 v57, v20, v22
    ds_write_b64 v9, v[56:57] offset:16896
    v_add_f32_dpp v58, v44, v46 quad_perm:[0,1,2,3] row_mask:0xf bank_mask:3
    v_add_f32_dpp v58, v45, v47 quad_perm:[0,1,2,3] row_mask:0xf bank_mask:12
    ds_write_b32 v10, v58 offset:20480
    s_nop 2
    v_mov_b32 v68, 0
    s_nop 2
    v_mov_b32 v69, 0
    s_nop 2
    v_mov_b32 v70, 0
    s_waitcnt lgkmcnt(0)
    s_barrier
    v_mov_b32 v44, 0
    s_nop 3
    v_mov_b32 v45, 0
    s_nop 3
    v_mov_b32 v46, 0
    s_nop 3
    v_mov_b32 v47, 0
    s_nop 3
    v_mov_b32 v48, 0
    s_nop 3
    v_mov_b32 v49, 0
    s_nop 3
    v_mov_b32 v50, 0
    s_nop 3
    v_mov_b32 v51, 0
    s_nop 3
    s_barrier
    s_add_u32 s27, s27, 47104
    s_add_u32 s28, s28, 47104
    s_add_u32 s38, s38, 458752
    s_add_u32 s30, s30, 47104
    s_add_u32 s20, s20, 47104
    s_add_u32 s21, s21, 47104
    s_add_u32 s18, s18, 1
    s_cmp_ge_u32 s18, 63
    s_cbranch_scc1 main_kernel_exit
    s_sleep 11
    s_nop 3
    v_mov_b32 v44, 0
    s_nop 1
    v_mov_b32 v45, 0
    s_nop 1
    v_mov_b32 v46, 0
    s_nop 1
    v_mov_b32 v47, 0
    s_nop 1
    v_mov_b32 v48, 0
    s_nop 1
    v_mov_b32 v49, 0
    s_nop 1
    v_mov_b32 v50, 0
    s_nop 1
    v_mov_b32 v51, 0
    s_nop 1
    v_mov_b32 v52, 0
    s_nop 1
    v_mov_b32 v53, 0
    s_nop 1
    v_mov_b32 v54, 0
    s_nop 1
    v_mov_b32 v55, 0
    s_nop 1
    v_mov_b32 v56, 0
    s_nop 1
    v_mov_b32 v57, 0
    s_nop 1
    v_mov_b32 v58, 0
    s_nop 1
    buffer_load_dwordx4 v[16:19], v1, s[4:7], s20 offen sc1
    buffer_load_dwordx4 v[20:23], v1, s[4:7], s21 offen sc1
    v_mov_b32 v59, 0
    s_nop 1
    v_mov_b32 v60, 0
    s_nop 1
    v_mov_b32 v61, 0
    s_nop 1
    v_mov_b32 v62, 0
    s_nop 1
    v_mov_b32 v63, 0
    s_nop 1
    v_mov_b32 v64, 0
    s_nop 1
    buffer_load_dwordx4 v[16:19], v1, s[4:7], s20 offen sc1
    buffer_load_dwordx4 v[20:23], v1, s[4:7], s21 offen sc1
    v_mov_b32 v65, 0
    s_nop 1
    v_mov_b32 v66, 0
    s_nop 1
    v_mov_b32 v67, 0
    s_nop 1
    v_mov_b32 v68, 0
    s_nop 1
    v_mov_b32 v69, 0
    s_nop 1
    v_mov_b32 v70, 0
    s_nop 1
    v_mov_b32 v71, 0
    s_nop 1
    s_branch LA_33
.p2align 6
LteamA3_6:
    v_lshlrev_b32 v1, 4, v0
    v_mov_b32 v2, 0x44444444
    v_mov_b32 v13, 0xeeeeeeee
    v_and_b32 v14, 2, v0
    v_cmp_ne_u32 vcc, 0, v14
    s_nop 1
    v_cndmask_b32 v2, v2, v13, vcc
    v_mov_b32 v13, 0
    v_lshlrev_b32 v14, 2, v0
    ds_write_b32 v14, v13 offset:24832
    s_mov_b32 s18, 0
    s_mov_b32 s34, 42222592
    s_mov_b64 s[82:83], 0
    s_and_b32 s84, s17, 15
    s_lshl_b32 s84, s84, 8
    s_add_u32 s84, s84, 54767616
    s_mov_b32 s20, 42211328
    s_mov_b32 s21, 42205184
    v_and_b32 v13, 15, v0
    v_lshrrev_b32 v14, 4, v0
    v_and_b32 v15, 1, v14
    v_and_b32 v6, 0x1f0, v1
    v_lshrrev_b32 v3, 2, v13
    v_lshlrev_b32 v3, 6, v3
    v_and_b32 v5, 1, v0
    v_lshl_add_u32 v3, v5, 5, v3
    v_lshl_add_u32 v3, v14, 3, v3
    v_bfe_u32 v5, v0, 1, 1
    v_lshl_add_u32 v3, v5, 2, v3
    v_add_u32 v3, 13568, v3
    v_lshlrev_b32 v4, 8, v14
    v_lshl_add_u32 v4, v13, 3, v4
    v_add_u32 v4, 13568, v4
    v_bfe_u32 v7, v0, 1, 1
    v_lshlrev_b32 v7, 7, v7
    v_bfe_u32 v5, v0, 2, 1
    v_lshl_add_u32 v7, v5, 6, v7
    v_lshl_add_u32 v7, v15, 5, v7
    v_and_b32 v5, 1, v0
    v_lshl_add_u32 v7, v5, 4, v7
    v_lshrrev_b32 v5, 5, v0
    v_lshl_add_u32 v7, v5, 8, v7
    v_lshlrev_b32 v5, 6, v14
    v_bfe_u32 v8, v0, 2, 1
    v_lshl_add_u32 v5, v8, 5, v5
    v_add_u32 v5, 16, v5
    v_lshrrev_b32 v8, 3, v13
    v_lshl_add_u32 v11, v8, 8, v5
    v_and_b32 v8, 3, v0
    v_lshl_add_u32 v11, v8, 2, v11
    v_lshl_add_u32 v12, v8, 1, v5
    s_and_b32 s24, s17, 3
    s_lshl_b32 s25, s24, 9
    v_add_u32 v11, s25, v11
    s_lshr_b32 s25, s24, 1
    s_lshl_b32 s25, s25, 8
    s_and_b32 s24, s24, 1
    s_lshl_b32 s24, s24, 3
    s_add_u32 s25, s25, s24
    v_add_u32 v12, s25, v12
    s_lshr_b32 s26, s17, 2
    s_mul_i32 s26, s26, 2560
    s_add_u32 s26, s26, 42212352
    v_lshlrev_b32 v9, 3, v0
    v_mov_b32 v10, 0
    v_mov_b32 v13, 0
    v_lshlrev_b32 v14, 2, v0
    ds_write_b32 v14, v13 offset:15360
    ds_write_b32 v14, v13 offset:7168
    s_mul_i32 s22, s17, 401408
    s_add_u32 s22, s22, 0
    v_lshlrev_b32 v8, 7, v0
    v_min_u32 v5, 2816, v8
    s_mul_i32 s30, s17, 2944
    s_add_u32 s30, s30, 42252288
    s_mul_i32 s38, s17, 28672
    s_add_u32 s38, s38, 12845440
    v_min_u32 v8, 7040, v8
    v_lshlrev_b32 v8, 2, v8
    s_mov_b32 s27, 42234368
    s_mov_b32 s28, 42248704
    s_add_u32 s23, s22, 313344
    buffer_load_dwordx4 a[0:3], v1, s[4:7], s23 offen offset:0
    buffer_load_dwordx4 a[4:7], v1, s[4:7], s23 offen offset:1024
    s_add_u32 s23, s22, 301056
    buffer_load_dwordx4 a[8:11], v1, s[4:7], s23 offen offset:0
    buffer_load_dwordx4 a[12:15], v1, s[4:7], s23 offen offset:1024
    s_add_u32 s23, s22, 303104
    buffer_load_dwordx4 a[16:19], v1, s[4:7], s23 offen offset:0
    buffer_load_dwordx4 a[20:23], v1, s[4:7], s23 offen offset:1024
    s_add_u32 s23, s22, 305152
    buffer_load_dwordx4 a[24:27], v1, s[4:7], s23 offen offset:0
    buffer_load_dwordx4 a[28:31], v1, s[4:7], s23 offen offset:1024
    s_add_u32 s23, s22, 307200
    buffer_load_dwordx4 a[32:35], v1, s[4:7], s23 offen offset:0
    buffer_load_dwordx4 a[36:39], v1, s[4:7], s23 offen offset:1024
    s_add_u32 s23, s22, 309248
    buffer_load_dwordx4 a[40:43], v1, s[4:7], s23 offen offset:0
    buffer_load_dwordx4 a[44:47], v1, s[4:7], s23 offen offset:1024
    s_add_u32 s23, s22, 311296
    buffer_load_dwordx4 a[48:51], v1, s[4:7], s23 offen offset:0
    buffer_load_dwordx4 a[52:55], v1, s[4:7], s23 offen offset:1024
    s_add_u32 s23, s22, 327680
    buffer_load_dwordx4 a[56:59], v1, s[4:7], s23 offen offset:0
    buffer_load_dwordx4 a[60:63], v1, s[4:7], s23 offen offset:1024
    s_add_u32 s23, s22, 315392
    buffer_load_dwordx4 a[64:67], v1, s[4:7], s23 offen offset:0
    buffer_load_dwordx4 a[68:71], v1, s[4:7], s23 offen offset:1024
    s_add_u32 s23, s22, 317440
    buffer_load_dwordx4 a[72:75], v1, s[4:7], s23 offen offset:0
    buffer_load_dwordx4 a[76:79], v1, s[4:7], s23 offen offset:1024
    s_add_u32 s23, s22, 319488
    buffer_load_dwordx4 a[80:83], v1, s[4:7], s23 offen offset:0
    buffer_load_dwordx4 a[84:87], v1, s[4:7], s23 offen offset:1024
    s_add_u32 s23, s22, 321536
    buffer_load_dwordx4 a[88:91], v1, s[4:7], s23 offen offset:0
    buffer_load_dwordx4 a[92:95], v1, s[4:7], s23 offen offset:1024
    s_add_u32 s23, s22, 323584
    buffer_load_dwordx4 a[96:99], v1, s[4:7], s23 offen offset:0
    buffer_load_dwordx4 a[100:103], v1, s[4:7], s23 offen offset:1024
    s_add_u32 s23, s22, 325632
    buffer_load_dwordx4 a[104:107], v1, s[4:7], s23 offen offset:0
    buffer_load_dwordx4 a[108:111], v1, s[4:7], s23 offen offset:1024
    s_add_u32 s23, s22, 342016
    buffer_load_dwordx4 a[112:115], v1, s[4:7], s23 offen offset:0
    buffer_load_dwordx4 a[116:119], v1, s[4:7], s23 offen offset:1024
    s_add_u32 s23, s22, 329728
    buffer_load_dwordx4 a[120:123], v1, s[4:7], s23 offen offset:0
    buffer_load_dwordx4 a[124:127], v1, s[4:7], s23 offen offset:1024
    s_add_u32 s23, s22, 331776
    buffer_load_dwordx4 a[128:131], v1, s[4:7], s23 offen offset:0
    buffer_load_dwordx4 a[132:135], v1, s[4:7], s23 offen offset:1024
    s_add_u32 s23, s22, 333824
    buffer_load_dwordx4 a[136:139], v1, s[4:7], s23 offen offset:0
    buffer_load_dwordx4 a[140:143], v1, s[4:7], s23 offen offset:1024
    s_add_u32 s23, s22, 335872
    buffer_load_dwordx4 a[144:147], v1, s[4:7], s23 offen offset:0
    buffer_load_dwordx4 a[148:151], v1, s[4:7], s23 offen offset:1024
    s_add_u32 s23, s22, 337920
    buffer_load_dwordx4 a[152:155], v1, s[4:7], s23 offen offset:0
    buffer_load_dwordx4 a[156:159], v1, s[4:7], s23 offen offset:1024
    s_add_u32 s23, s22, 339968
    buffer_load_dwordx4 a[160:163], v1, s[4:7], s23 offen offset:0
    buffer_load_dwordx4 a[164:167], v1, s[4:7], s23 offen offset:1024
    s_waitcnt vmcnt(40)
    s_add_u32 s23, s22, 356352
    buffer_load_dwordx4 a[168:171], v1, s[4:7], s23 offen offset:0
    buffer_load_dwordx4 a[172:175], v1, s[4:7], s23 offen offset:1024
    s_add_u32 s23, s22, 344064
    buffer_load_dwordx4 a[176:179], v1, s[4:7], s23 offen offset:0
    buffer_load_dwordx4 a[180:183], v1, s[4:7], s23 offen offset:1024
    s_add_u32 s23, s22, 346112
    buffer_load_dwordx4 a[184:187], v1, s[4:7], s23 offen offset:0
    buffer_load_dwordx4 a[188:191], v1, s[4:7], s23 offen offset:1024
    s_add_u32 s23, s22, 348160
    buffer_load_dwordx4 a[192:195], v1, s[4:7], s23 offen offset:0
    buffer_load_dwordx4 a[196:199], v1, s[4:7], s23 offen offset:1024
    s_add_u32 s23, s22, 350208
    buffer_load_dwordx4 a[200:203], v1, s[4:7], s23 offen offset:0
    buffer_load_dwordx4 a[204:207], v1, s[4:7], s23 offen offset:1024
    s_add_u32 s23, s22, 352256
    buffer_load_dwordx4 a[208:211], v1, s[4:7], s23 offen offset:0
    buffer_load_dwordx4 a[212:215], v1, s[4:7], s23 offen offset:1024
    s_add_u32 s23, s22, 354304
    buffer_load_dwordx4 a[216:219], v1, s[4:7], s23 offen offset:0
    buffer_load_dwordx4 a[220:223], v1, s[4:7], s23 offen offset:1024
    s_waitcnt vmcnt(40)
    s_add_u32 s23, s22, 370688
    buffer_load_dwordx4 a[224:227], v1, s[4:7], s23 offen offset:0
    buffer_load_dwordx4 a[228:231], v1, s[4:7], s23 offen offset:1024
    s_add_u32 s23, s22, 358400
    buffer_load_dwordx4 a[232:235], v1, s[4:7], s23 offen offset:0
    buffer_load_dwordx4 a[236:239], v1, s[4:7], s23 offen offset:1024
    s_add_u32 s23, s22, 360448
    buffer_load_dwordx4 a[240:243], v1, s[4:7], s23 offen offset:0
    buffer_load_dwordx4 a[244:247], v1, s[4:7], s23 offen offset:1024
    s_add_u32 s23, s22, 362496
    buffer_load_dwordx4 a[248:251], v1, s[4:7], s23 offen offset:0
    buffer_load_dwordx4 a[252:255], v1, s[4:7], s23 offen offset:1024
    s_add_u32 s23, s22, 364544
    buffer_load_dwordx4 v[120:123], v1, s[4:7], s23 offen offset:0
    buffer_load_dwordx4 v[124:127], v1, s[4:7], s23 offen offset:1024
    s_add_u32 s23, s22, 366592
    buffer_load_dwordx4 v[128:131], v1, s[4:7], s23 offen offset:0
    buffer_load_dwordx4 v[132:135], v1, s[4:7], s23 offen offset:1024
    s_add_u32 s23, s22, 368640
    buffer_load_dwordx4 v[136:139], v1, s[4:7], s23 offen offset:0
    buffer_load_dwordx4 v[140:143], v1, s[4:7], s23 offen offset:1024
    s_waitcnt vmcnt(40)
    s_add_u32 s23, s22, 385024
    buffer_load_dwordx4 v[144:147], v1, s[4:7], s23 offen offset:0
    buffer_load_dwordx4 v[148:151], v1, s[4:7], s23 offen offset:1024
    s_add_u32 s23, s22, 372736
    buffer_load_dwordx4 v[152:155], v1, s[4:7], s23 offen offset:0
    buffer_load_dwordx4 v[156:159], v1, s[4:7], s23 offen offset:1024
    s_add_u32 s23, s22, 374784
    buffer_load_dwordx4 v[160:163], v1, s[4:7], s23 offen offset:0
    buffer_load_dwordx4 v[164:167], v1, s[4:7], s23 offen offset:1024
    s_add_u32 s23, s22, 376832
    buffer_load_dwordx4 v[168:171], v1, s[4:7], s23 offen offset:0
    buffer_load_dwordx4 v[172:175], v1, s[4:7], s23 offen offset:1024
    s_add_u32 s23, s22, 378880
    buffer_load_dwordx4 v[176:179], v1, s[4:7], s23 offen offset:0
    buffer_load_dwordx4 v[180:183], v1, s[4:7], s23 offen offset:1024
    s_add_u32 s23, s22, 380928
    buffer_load_dwordx4 v[184:187], v1, s[4:7], s23 offen offset:0
    buffer_load_dwordx4 v[188:191], v1, s[4:7], s23 offen offset:1024
    s_add_u32 s23, s22, 382976
    buffer_load_dwordx4 v[192:195], v1, s[4:7], s23 offen offset:0
    buffer_load_dwordx4 v[196:199], v1, s[4:7], s23 offen offset:1024
    s_waitcnt vmcnt(40)
    s_add_u32 s23, s22, 399360
    buffer_load_dwordx4 v[200:203], v1, s[4:7], s23 offen offset:0
    buffer_load_dwordx4 v[204:207], v1, s[4:7], s23 offen offset:1024
    s_add_u32 s23, s22, 387072
    buffer_load_dwordx4 v[208:211], v1, s[4:7], s23 offen offset:0
    buffer_load_dwordx4 v[212:215], v1, s[4:7], s23 offen offset:1024
    s_add_u32 s23, s22, 389120
    buffer_load_dwordx4 v[216:219], v1, s[4:7], s23 offen offset:0
    buffer_load_dwordx4 v[220:223], v1, s[4:7], s23 offen offset:1024
    s_add_u32 s23, s22, 391168
    buffer_load_dwordx4 v[224:227], v1, s[4:7], s23 offen offset:0
    buffer_load_dwordx4 v[228:231], v1, s[4:7], s23 offen offset:1024
    s_add_u32 s23, s22, 393216
    buffer_load_dwordx4 v[232:235], v1, s[4:7], s23 offen offset:0
    buffer_load_dwordx4 v[236:239], v1, s[4:7], s23 offen offset:1024
    s_add_u32 s23, s22, 395264
    buffer_load_dwordx4 v[240:243], v1, s[4:7], s23 offen offset:0
    buffer_load_dwordx4 v[244:247], v1, s[4:7], s23 offen offset:1024
    s_add_u32 s23, s22, 397312
    buffer_load_dwordx4 v[248:251], v1, s[4:7], s23 offen offset:0
    buffer_load_dwordx4 v[252:255], v1, s[4:7], s23 offen offset:1024
    s_waitcnt vmcnt(40)
    s_cmp_lg_u32 s94, 0
    s_cbranch_scc1 Lvf_41
    v_and_b32 v45, 31, v0
    v_lshlrev_b32 v45, 2, v45
Lvf_40:
    buffer_load_dword v44, v45, s[12:15], 0 offen offset:128 sc1
    s_sub_u32 s19, s19, 1
    s_cbranch_scc1 main_kernel_exit
    s_waitcnt vmcnt(0)
    v_cmp_eq_u32 vcc, 0, v44
    s_cbranch_vccnz Lvf_40
    v_readfirstlane_b32 s94, v44
    s_nop 1
    v_cmp_ne_u32 vcc, s94, v44
    s_cbranch_vccnz main_kernel_census
Lvf_41:
    v_lshlrev_b32 v10, 2, v0
    v_mov_b32 v44, 0
    v_mov_b32 v45, 0
    v_mov_b32 v46, 0
    v_mov_b32 v47, 0
    v_mov_b32 v48, 0
    v_mov_b32 v49, 0
    v_mov_b32 v50, 0
    v_mov_b32 v51, 0
    v_mov_b32 v52, 0
    v_mov_b32 v53, 0
    v_mov_b32 v54, 0
    v_mov_b32 v55, 0
    v_mov_b32 v56, 0
    v_mov_b32 v57, 0
    v_mov_b32 v58, 0
    v_mov_b32 v59, 0
    v_mov_b32 v60, 0
    v_mov_b32 v61, 0
    v_mov_b32 v62, 0
    v_mov_b32 v63, 0
    v_mov_b32 v64, 0
    v_mov_b32 v65, 0
    v_mov_b32 v66, 0
    v_mov_b32 v67, 0
    v_mov_b32 v68, 0
    v_mov_b32 v69, 0
    v_mov_b32 v70, 0
    v_mov_b32 v71, 0
    s_waitcnt vmcnt(0) lgkmcnt(0)
    buffer_load_dwordx4 v[16:19], v1, s[4:7], s20 offen sc1
    buffer_load_dwordx4 v[20:23], v1, s[4:7], s21 offen sc1
    buffer_load_dwordx4 v[16:19], v1, s[4:7], s20 offen sc1
    buffer_load_dwordx4 v[20:23], v1, s[4:7], s21 offen sc1
LA_42:
    s_branch Lok_44
Lpm_43:
    buffer_load_dwordx4 v[16:19], v1, s[4:7], s20 offen sc1
    buffer_load_dwordx4 v[20:23], v1, s[4:7], s21 offen sc1
    s_sub_u32 s19, s19, 1
    s_cbranch_scc1 main_kernel_exit
    s_nop 2
    v_mov_b32 v44, 0
    v_mov_b32 v45, 0
    v_mov_b32 v46, 0
    v_mov_b32 v47, 0
    v_mov_b32 v48, 0
    v_mov_b32 v49, 0
    v_mov_b32 v50, 0
    v_mov_b32 v51, 0
Lok_44:
    s_waitcnt vmcnt(3)
    v_max3_u32 v13, v16, v17, v18
    s_waitcnt vmcnt(2)
    v_max3_u32 v15, v20, v21, v22
    v_max3_u32 v13, v19, v23, v13
    v_smfmac_f32_16x16x64_bf16 v[44:47], v[16:19], a[0:7], v2
    v_max_u32 v13, v13, v15
    v_cmp_eq_u32 vcc, -1, v13
    v_smfmac_f32_16x16x64_bf16 v[48:51], v[16:19], a[56:63], v2
    ds_write_b128 v1, v[16:19] offset:6144
    s_cbranch_vccnz Lpm_43
    v_smfmac_f32_16x16x64_bf16 v[52:55], v[16:19], a[112:119], v2
    v_smfmac_f32_16x16x64_bf16 v[56:59], v[16:19], a[168:175], v2
    v_smfmac_f32_16x16x64_bf16 v[60:63], v[16:19], a[224:231], v2
    v_smfmac_f32_16x16x64_bf16 v[64:67], v[16:19], v[144:151], v2
    buffer_load_dwordx4 v[72:75], v1, s[4:7], s27 offen offset:0
    v_smfmac_f32_16x16x64_bf16 v[68:71], v[16:19], v[200:207], v2
    buffer_load_dwordx4 v[76:79], v1, s[4:7], s27 offen offset:1024
    v_smfmac_f32_16x16x64_bf16 v[44:47], v[20:23], a[8:15], v2
    buffer_load_dwordx4 v[88:91], v1, s[4:7], s28 offen offset:0
    v_smfmac_f32_16x16x64_bf16 v[48:51], v[20:23], a[64:71], v2
    buffer_load_dwordx4 v[92:95], v1, s[4:7], s28 offen offset:1024
    v_smfmac_f32_16x16x64_bf16 v[52:55], v[20:23], a[120:127], v2
    s_waitcnt lgkmcnt(0)
    s_barrier
    ds_read_b128 v[24:27], v1 offset:1024
    v_smfmac_f32_16x16x64_bf16 v[56:59], v[20:23], a[176:183], v2
    ds_read_b128 v[28:31], v1 offset:2048
    v_smfmac_f32_16x16x64_bf16 v[60:63], v[20:23], a[232:239], v2
    ds_read_b128 v[32:35], v1 offset:3072
    v_smfmac_f32_16x16x64_bf16 v[64:67], v[20:23], v[152:159], v2
    ds_read_b128 v[36:39], v1 offset:4096
    v_smfmac_f32_16x16x64_bf16 v[68:71], v[20:23], v[208:215], v2
    ds_read_b128 v[40:43], v1 offset:5120
    s_waitcnt lgkmcnt(4)
    v_smfmac_f32_16x16x64_bf16 v[44:47], v[24:27], a[16:23], v2
    s_waitcnt lgkmcnt(3)
    v_smfmac_f32_16x16x64_bf16 v[44:47], v[28:31], a[24:31], v2
    s_waitcnt lgkmcnt(1)
    v_smfmac_f32_16x16x64_bf16 v[44:47], v[32:35], a[32:39], v2
    buffer_load_dwordx4 v[80:83], v1, s[4:7], s27 offen offset:2048
    v_smfmac_f32_16x16x64_bf16 v[44:47], v[36:39], a[40:47], v2
    s_waitcnt lgkmcnt(0)
    v_smfmac_f32_16x16x64_bf16 v[44:47], v[40:43], a[48:55], v2
    ds_read_b128 v[104:107], v7 offset:5376
    v_smfmac_f32_16x16x64_bf16 v[48:51], v[24:27], a[72:79], v2
    buffer_load_dwordx4 v[84:87], v6, s[4:7], s27 offen offset:3072
    v_smfmac_f32_16x16x64_bf16 v[48:51], v[28:31], a[80:87], v2
    ds_read_b128 v[108:111], v7 offset:5888
    v_smfmac_f32_16x16x64_bf16 v[48:51], v[32:35], a[88:95], v2
    v_add_f32 v44, v44, v46
    v_smfmac_f32_16x16x64_bf16 v[48:51], v[36:39], a[96:103], v2
    v_add_f32 v45, v45, v47
    v_smfmac_f32_16x16x64_bf16 v[48:51], v[40:43], a[104:111], v2
    v_cvt_pk_bf16_f32 v44, v44, v45
    v_smfmac_f32_16x16x64_bf16 v[52:55], v[24:27], a[128:135], v2
    ds_write_b32 v3, v44 offset:0
    ds_read_b128 v[112:115], v7 offset:6400
    v_smfmac_f32_16x16x64_bf16 v[52:55], v[28:31], a[136:143], v2
    buffer_load_dwordx4 v[96:99], v1, s[4:7], s28 offen offset:2048
    v_smfmac_f32_16x16x64_bf16 v[52:55], v[32:35], a[144:151], v2
    v_add_f32 v48, v48, v50
    v_smfmac_f32_16x16x64_bf16 v[52:55], v[36:39], a[152:159], v2
    v_add_f32 v49, v49, v51
    v_smfmac_f32_16x16x64_bf16 v[52:55], v[40:43], a[160:167], v2
    v_cvt_pk_bf16_f32 v48, v48, v49
    v_smfmac_f32_16x16x64_bf16 v[56:59], v[24:27], a[184:191], v2
    ds_write_b32 v3, v48 offset:256
    ds_read_b128 v[116:119], v7 offset:6912
    v_smfmac_f32_16x16x64_bf16 v[56:59], v[28:31], a[192:199], v2
    buffer_load_dwordx4 v[100:103], v6, s[4:7], s28 offen offset:3072
    v_smfmac_f32_16x16x64_bf16 v[56:59], v[32:35], a[200:207], v2
    v_add_f32 v52, v52, v54
    v_smfmac_f32_16x16x64_bf16 v[56:59], v[36:39], a[208:215], v2
    v_add_f32 v53, v53, v55
    v_smfmac_f32_16x16x64_bf16 v[56:59], v[40:43], a[216:223], v2
    v_cvt_pk_bf16_f32 v52, v52, v53
    v_smfmac_f32_16x16x64_bf16 v[60:63], v[24:27], a[240:247], v2
    ds_write_b32 v3, v52 offset:512
    s_waitcnt vmcnt(8)
    v_smfmac_f32_16x16x64_bf16 v[60:63], v[28:31], a[248:255], v2
    ds_read_b128 v[16:19], v1 offset:24064
    v_smfmac_f32_16x16x64_bf16 v[60:63], v[32:35], v[120:127], v2
    v_add_f32 v56, v56, v58
    v_smfmac_f32_16x16x64_bf16 v[60:63], v[36:39], v[128:135], v2
    v_add_f32 v57, v57, v59
    v_smfmac_f32_16x16x64_bf16 v[60:63], v[40:43], v[136:143], v2
    v_cvt_pk_bf16_f32 v56, v56, v57
    v_smfmac_f32_16x16x64_bf16 v[64:67], v[24:27], v[160:167], v2
    ds_write_b32 v3, v56 offset:768
    ds_read_b128 v[20:23], v1 offset:24064
    v_smfmac_f32_16x16x64_bf16 v[64:67], v[28:31], v[168:175], v2
    ds_read_b64_tr_b16 v[48:49], v4
    v_smfmac_f32_16x16x64_bf16 v[64:67], v[32:35], v[176:183], v2
    v_add_f32 v60, v60, v62
    v_smfmac_f32_16x16x64_bf16 v[64:67], v[36:39], v[184:191], v2
    v_add_f32 v61, v61, v63
    v_smfmac_f32_16x16x64_bf16 v[64:67], v[40:43], v[192:199], v2
    v_cvt_pk_bf16_f32 v60, v60, v61
    v_smfmac_f32_16x16x64_bf16 v[68:71], v[24:27], v[216:223], v2
    ds_write_b32 v3, v60 offset:1024
    ds_read_b128 v[44:47], v1 offset:24064
    v_smfmac_f32_16x16x64_bf16 v[68:71], v[28:31], v[224:231], v2
    ds_read_b64_tr_b16 v[50:51], v4 offset:128
    v_smfmac_f32_16x16x64_bf16 v[68:71], v[32:35], v[232:239], v2
    v_add_f32 v64, v64, v66
    v_smfmac_f32_16x16x64_bf16 v[68:71], v[36:39], v[240:247], v2
    v_add_f32 v65, v65, v67
    v_smfmac_f32_16x16x64_bf16 v[68:71], v[40:43], v[248:255], v2
    v_cvt_pk_bf16_f32 v64, v64, v65
    ds_write_b32 v3, v64 offset:1280
    s_waitcnt vmcnt(4) lgkmcnt(1)
    v_smfmac_f32_16x16x64_bf16 v[16:19], v[48:51], v[72:79], v2
    v_smfmac_f32_16x16x64_bf16 v[20:23], v[48:51], v[88:95], v2
    v_add_f32 v68, v68, v70
    v_add_f32 v69, v69, v71
    v_cvt_pk_bf16_f32 v68, v68, v69
    ds_write_b32 v3, v68 offset:1536
    ds_read_b64_tr_b16 v[52:53], v4 offset:1024
    ds_read_b64_tr_b16 v[54:55], v4 offset:1152
    v_smfmac_f32_16x16x64_bf16 v[44:47], v[48:51], v[104:111], v2
    s_nop 1
    v_mov_b32 v64, 0
    s_nop 1
    v_mov_b32 v65, 0
    s_nop 1
    v_mov_b32 v66, 0
    s_waitcnt vmcnt(0) lgkmcnt(0)
    v_smfmac_f32_16x16x64_bf16 v[16:19], v[52:55], v[80:87], v2
    v_smfmac_f32_16x16x64_bf16 v[20:23], v[52:55], v[96:103], v2
    v_smfmac_f32_16x16x64_bf16 v[44:47], v[52:55], v[112:119], v2
    s_cmp_eq_u32 s37, 1
    v_add_f32 v56, v16, v18
    v_add_f32 v60, v17, v19
    s_nop 1
    v_add_f32 v57, v20, v22
    ds_write_b64 v9, v[56:57] offset:17408
    v_add_f32 v61, v21, v23
    ds_write_b64 v9, v[60:61] offset:19456
    v_add_f32_dpp v58, v44, v46 quad_perm:[0,1,2,3] row_mask:0xf bank_mask:3
    v_add_f32_dpp v58, v45, v47 quad_perm:[0,1,2,3] row_mask:0xf bank_mask:12
    ds_write_b32 v10, v58 offset:20736
    s_nop 2
    v_mov_b32 v68, 0
    s_nop 2
    v_mov_b32 v69, 0
    s_nop 2
    v_mov_b32 v70, 0
    s_waitcnt lgkmcnt(0)
    s_barrier
    s_barrier
    s_add_u32 s27, s27, 47104
    s_add_u32 s28, s28, 47104
    s_add_u32 s38, s38, 458752
    s_add_u32 s30, s30, 47104
    s_add_u32 s20, s20, 47104
    s_add_u32 s21, s21, 47104
    s_add_u32 s18, s18, 1
    s_cmp_ge_u32 s18, 63
    s_cbranch_scc1 main_kernel_exit
    buffer_load_dword v15, v5, s[4:7], s30 offen
    s_sleep 11
    v_mov_b32 v44, 0
    s_nop 1
    v_mov_b32 v45, 0
    s_nop 1
    v_mov_b32 v46, 0
    s_nop 1
    v_mov_b32 v47, 0
    s_nop 1
    v_mov_b32 v48, 0
    s_nop 1
    v_mov_b32 v49, 0
    s_nop 1
    v_mov_b32 v50, 0
    s_nop 1
    v_mov_b32 v51, 0
    s_nop 1
    v_mov_b32 v52, 0
    s_nop 1
    v_mov_b32 v53, 0
    s_nop 1
    v_mov_b32 v54, 0
    s_nop 1
    v_mov_b32 v55, 0
    s_nop 1
    v_mov_b32 v56, 0
    s_nop 1
    v_mov_b32 v57, 0
    s_nop 1
    v_mov_b32 v58, 0
    s_nop 1
    buffer_load_dwordx4 v[16:19], v1, s[4:7], s20 offen sc1
    buffer_load_dwordx4 v[20:23], v1, s[4:7], s21 offen sc1
    v_mov_b32 v59, 0
    s_nop 1
    v_mov_b32 v60, 0
    s_nop 1
    v_mov_b32 v61, 0
    s_nop 1
    v_mov_b32 v62, 0
    s_nop 1
    v_mov_b32 v63, 0
    s_nop 1
    v_mov_b32 v64, 0
    s_nop 1
    buffer_load_dwordx4 v[16:19], v1, s[4:7], s20 offen sc1
    buffer_load_dwordx4 v[20:23], v1, s[4:7], s21 offen sc1
    v_mov_b32 v65, 0
    s_nop 1
    v_mov_b32 v66, 0
    s_nop 1
    v_mov_b32 v67, 0
    s_nop 1
    v_mov_b32 v68, 0
    s_nop 1
    v_mov_b32 v69, 0
    s_nop 1
    v_mov_b32 v70, 0
    s_nop 1
    v_mov_b32 v71, 0
    s_nop 1
    s_branch LA_42
.p2align 6
LteamB0_7:
    v_lshlrev_b32 v1, 4, v0
    v_mov_b32 v2, 0x44444444
    v_mov_b32 v13, 0xeeeeeeee
    v_and_b32 v14, 2, v0
    v_cmp_ne_u32 vcc, 0, v14
    s_nop 1
    v_cndmask_b32 v2, v2, v13, vcc
    v_mov_b32 v13, 0
    v_lshlrev_b32 v14, 2, v0
    ds_write_b32 v14, v13 offset:24064
    s_mov_b32 s18, 0
    s_mov_b32 s34, 42222592
    s_mov_b64 s[82:83], 0
    s_and_b32 s84, s17, 15
    s_lshl_b32 s84, s84, 8
    s_add_u32 s84, s84, 54767616
    s_mov_b32 s20, 42205184
    s_mov_b32 s21, 42206208
    s_sub_u32 s24, s17, 16
    s_mul_i32 s25, s24, 28
    v_and_b32 v13, 15, v0
    v_lshrrev_b32 v14, 4, v0
    s_mul_i32 s22, s24, 401408
    s_add_u32 s22, s22, 6422528
    s_add_u32 s23, s22, 0
    buffer_load_dwordx4 a[0:3], v1, s[4:7], s23 offen offset:0
    buffer_load_dwordx4 a[4:7], v1, s[4:7], s23 offen offset:1024
    s_add_u32 s23, s22, 2048
    buffer_load_dwordx4 a[8:11], v1, s[4:7], s23 offen offset:0
    buffer_load_dwordx4 a[12:15], v1, s[4:7], s23 offen offset:1024
    s_add_u32 s23, s22, 4096
    buffer_load_dwordx4 a[16:19], v1, s[4:7], s23 offen offset:0
    buffer_load_dwordx4 a[20:23], v1, s[4:7], s23 offen offset:1024
    s_add_u32 s23, s22, 6144
    buffer_load_dwordx4 a[24:27], v1, s[4:7], s23 offen offset:0
    buffer_load_dwordx4 a[28:31], v1, s[4:7], s23 offen offset:1024
    s_add_u32 s23, s22, 8192
    buffer_load_dwordx4 a[32:35], v1, s[4:7], s23 offen offset:0
    buffer_load_dwordx4 a[36:39], v1, s[4:7], s23 offen offset:1024
    s_add_u32 s23, s22, 10240
    buffer_load_dwordx4 a[40:43], v1, s[4:7], s23 offen offset:0
    buffer_load_dwordx4 a[44:47], v1, s[4:7], s23 offen offset:1024
    s_add_u32 s23, s22, 12288
    buffer_load_dwordx4 a[48:51], v1, s[4:7], s23 offen offset:0
    buffer_load_dwordx4 a[52:55], v1, s[4:7], s23 offen offset:1024
    s_add_u32 s23, s22, 14336
    buffer_load_dwordx4 a[56:59], v1, s[4:7], s23 offen offset:0
    buffer_load_dwordx4 a[60:63], v1, s[4:7], s23 offen offset:1024
    s_add_u32 s23, s22, 16384
    buffer_load_dwordx4 a[64:67], v1, s[4:7], s23 offen offset:0
    buffer_load_dwordx4 a[68:71], v1, s[4:7], s23 offen offset:1024
    s_add_u32 s23, s22, 18432
    buffer_load_dwordx4 a[72:75], v1, s[4:7], s23 offen offset:0
    buffer_load_dwordx4 a[76:79], v1, s[4:7], s23 offen offset:1024
    s_add_u32 s23, s22, 20480
    buffer_load_dwordx4 a[80:83], v1, s[4:7], s23 offen offset:0
    buffer_load_dwordx4 a[84:87], v1, s[4:7], s23 offen offset:1024
    s_add_u32 s23, s22, 22528
    buffer_load_dwordx4 a[88:91], v1, s[4:7], s23 offen offset:0
    buffer_load_dwordx4 a[92:95], v1, s[4:7], s23 offen offset:1024
    s_add_u32 s23, s22, 24576
    buffer_load_dwordx4 a[96:99], v1, s[4:7], s23 offen offset:0
    buffer_load_dwordx4 a[100:103], v1, s[4:7], s23 offen offset:1024
    s_add_u32 s23, s22, 26624
    buffer_load_dwordx4 a[104:107], v1, s[4:7], s23 offen offset:0
    buffer_load_dwordx4 a[108:111], v1, s[4:7], s23 offen offset:1024
    s_add_u32 s23, s22, 28672
    buffer_load_dwordx4 a[112:115], v1, s[4:7], s23 offen offset:0
    buffer_load_dwordx4 a[116:119], v1, s[4:7], s23 offen offset:1024
    s_add_u32 s23, s22, 30720
    buffer_load_dwordx4 a[120:123], v1, s[4:7], s23 offen offset:0
    buffer_load_dwordx4 a[124:127], v1, s[4:7], s23 offen offset:1024
    s_add_u32 s23, s22, 32768
    buffer_load_dwordx4 a[128:131], v1, s[4:7], s23 offen offset:0
    buffer_load_dwordx4 a[132:135], v1, s[4:7], s23 offen offset:1024
    s_add_u32 s23, s22, 34816
    buffer_load_dwordx4 a[136:139], v1, s[4:7], s23 offen offset:0
    buffer_load_dwordx4 a[140:143], v1, s[4:7], s23 offen offset:1024
    s_add_u32 s23, s22, 36864
    buffer_load_dwordx4 a[144:147], v1, s[4:7], s23 offen offset:0
    buffer_load_dwordx4 a[148:151], v1, s[4:7], s23 offen offset:1024
    s_add_u32 s23, s22, 38912
    buffer_load_dwordx4 a[152:155], v1, s[4:7], s23 offen offset:0
    buffer_load_dwordx4 a[156:159], v1, s[4:7], s23 offen offset:1024
    s_add_u32 s23, s22, 40960
    buffer_load_dwordx4 a[160:163], v1, s[4:7], s23 offen offset:0
    buffer_load_dwordx4 a[164:167], v1, s[4:7], s23 offen offset:1024
    s_waitcnt vmcnt(40)
    s_add_u32 s23, s22, 43008
    buffer_load_dwordx4 a[168:171], v1, s[4:7], s23 offen offset:0
    buffer_load_dwordx4 a[172:175], v1, s[4:7], s23 offen offset:1024
    s_add_u32 s23, s22, 45056
    buffer_load_dwordx4 a[176:179], v1, s[4:7], s23 offen offset:0
    buffer_load_dwordx4 a[180:183], v1, s[4:7], s23 offen offset:1024
    s_add_u32 s23, s22, 47104
    buffer_load_dwordx4 a[184:187], v1, s[4:7], s23 offen offset:0
    buffer_load_dwordx4 a[188:191], v1, s[4:7], s23 offen offset:1024
    s_add_u32 s23, s22, 49152
    buffer_load_dwordx4 a[192:195], v1, s[4:7], s23 offen offset:0
    buffer_load_dwordx4 a[196:199], v1, s[4:7], s23 offen offset:1024
    s_add_u32 s23, s22, 51200
    buffer_load_dwordx4 a[200:203], v1, s[4:7], s23 offen offset:0
    buffer_load_dwordx4 a[204:207], v1, s[4:7], s23 offen offset:1024
    s_add_u32 s23, s22, 53248
    buffer_load_dwordx4 a[208:211], v1, s[4:7], s23 offen offset:0
    buffer_load_dwordx4 a[212:215], v1, s[4:7], s23 offen offset:1024
    s_add_u32 s23, s22, 55296
    buffer_load_dwordx4 a[216:219], v1, s[4:7], s23 offen offset:0
    buffer_load_dwordx4 a[220:223], v1, s[4:7], s23 offen offset:1024
    s_waitcnt vmcnt(40)
    s_add_u32 s23, s22, 57344
    buffer_load_dwordx4 a[224:227], v1, s[4:7], s23 offen offset:0
    buffer_load_dwordx4 a[228:231], v1, s[4:7], s23 offen offset:1024
    s_add_u32 s23, s22, 59392
    buffer_load_dwordx4 a[232:235], v1, s[4:7], s23 offen offset:0
    buffer_load_dwordx4 a[236:239], v1, s[4:7], s23 offen offset:1024
    s_add_u32 s23, s22, 61440
    buffer_load_dwordx4 a[240:243], v1, s[4:7], s23 offen offset:0
    buffer_load_dwordx4 a[244:247], v1, s[4:7], s23 offen offset:1024
    s_add_u32 s23, s22, 63488
    buffer_load_dwordx4 a[248:251], v1, s[4:7], s23 offen offset:0
    buffer_load_dwordx4 a[252:255], v1, s[4:7], s23 offen offset:1024
    s_add_u32 s23, s22, 65536
    buffer_load_dwordx4 v[120:123], v1, s[4:7], s23 offen offset:0
    buffer_load_dwordx4 v[124:127], v1, s[4:7], s23 offen offset:1024
    s_add_u32 s23, s22, 67584
    buffer_load_dwordx4 v[128:131], v1, s[4:7], s23 offen offset:0
    buffer_load_dwordx4 v[132:135], v1, s[4:7], s23 offen offset:1024
    s_add_u32 s23, s22, 69632
    buffer_load_dwordx4 v[136:139], v1, s[4:7], s23 offen offset:0
    buffer_load_dwordx4 v[140:143], v1, s[4:7], s23 offen offset:1024
    s_waitcnt vmcnt(40)
    s_add_u32 s23, s22, 71680
    buffer_load_dwordx4 v[144:147], v1, s[4:7], s23 offen offset:0
    buffer_load_dwordx4 v[148:151], v1, s[4:7], s23 offen offset:1024
    s_add_u32 s23, s22, 73728
    buffer_load_dwordx4 v[152:155], v1, s[4:7], s23 offen offset:0
    buffer_load_dwordx4 v[156:159], v1, s[4:7], s23 offen offset:1024
    s_add_u32 s23, s22, 75776
    buffer_load_dwordx4 v[160:163], v1, s[4:7], s23 offen offset:0
    buffer_load_dwordx4 v[164:167], v1, s[4:7], s23 offen offset:1024
    s_add_u32 s23, s22, 77824
    buffer_load_dwordx4 v[168:171], v1, s[4:7], s23 offen offset:0
    buffer_load_dwordx4 v[172:175], v1, s[4:7], s23 offen offset:1024
    s_add_u32 s23, s22, 79872
    buffer_load_dwordx4 v[176:179], v1, s[4:7], s23 offen offset:0
    buffer_load_dwordx4 v[180:183], v1, s[4:7], s23 offen offset:1024
    s_add_u32 s23, s22, 81920
    buffer_load_dwordx4 v[184:187], v1, s[4:7], s23 offen offset:0
    buffer_load_dwordx4 v[188:191], v1, s[4:7], s23 offen offset:1024
    s_add_u32 s23, s22, 83968
    buffer_load_dwordx4 v[192:195], v1, s[4:7], s23 offen offset:0
    buffer_load_dwordx4 v[196:199], v1, s[4:7], s23 offen offset:1024
    s_waitcnt vmcnt(40)
    s_add_u32 s23, s22, 86016
    buffer_load_dwordx4 v[200:203], v1, s[4:7], s23 offen offset:0
    buffer_load_dwordx4 v[204:207], v1, s[4:7], s23 offen offset:1024
    s_add_u32 s23, s22, 88064
    buffer_load_dwordx4 v[208:211], v1, s[4:7], s23 offen offset:0
    buffer_load_dwordx4 v[212:215], v1, s[4:7], s23 offen offset:1024
    s_add_u32 s23, s22, 90112
    buffer_load_dwordx4 v[216:219], v1, s[4:7], s23 offen offset:0
    buffer_load_dwordx4 v[220:223], v1, s[4:7], s23 offen offset:1024
    s_add_u32 s23, s22, 92160
    buffer_load_dwordx4 v[224:227], v1, s[4:7], s23 offen offset:0
    buffer_load_dwordx4 v[228:231], v1, s[4:7], s23 offen offset:1024
    s_add_u32 s23, s22, 94208
    buffer_load_dwordx4 v[232:235], v1, s[4:7], s23 offen offset:0
    buffer_load_dwordx4 v[236:239], v1, s[4:7], s23 offen offset:1024
    s_add_u32 s23, s22, 96256
    buffer_load_dwordx4 v[240:243], v1, s[4:7], s23 offen offset:0
    buffer_load_dwordx4 v[244:247], v1, s[4:7], s23 offen offset:1024
    s_add_u32 s23, s22, 98304
    buffer_load_dwordx4 v[248:251], v1, s[4:7], s23 offen offset:0
    buffer_load_dwordx4 v[252:255], v1, s[4:7], s23 offen offset:1024
    s_waitcnt vmcnt(40)
    s_cmp_lg_u32 s94, 0
    s_cbranch_scc1 Lvf_50
    v_and_b32 v45, 31, v0
    v_lshlrev_b32 v45, 2, v45
Lvf_49:
    buffer_load_dword v44, v45, s[12:15], 0 offen offset:128 sc1
    s_sub_u32 s19, s19, 1
    s_cbranch_scc1 main_kernel_exit
    s_waitcnt vmcnt(0)
    v_cmp_eq_u32 vcc, 0, v44
    s_cbranch_vccnz Lvf_49
    v_readfirstlane_b32 s94, v44
    s_nop 1
    v_cmp_ne_u32 vcc, s94, v44
    s_cbranch_vccnz main_kernel_census
Lvf_50:
    v_lshlrev_b32 v3, 4, v13
    v_lshl_add_u32 v3, v14, 2, v3
    v_add_u32 v3, 7424, v3
    v_mul_u32_u24 v4, 28, v14
    v_add_u32 v4, v4, v13
    v_lshlrev_b32 v4, 4, v4
    v_add_u32 v4, 7424, v4
    v_lshlrev_b32 v12, 1, v13
    v_add_u32 v12, s25, v12
    v_lshrrev_b32 v10, 4, v12
    v_lshlrev_b32 v10, 8, v10
    v_lshl_add_u32 v10, v14, 6, v10
    v_bfe_u32 v11, v12, 3, 1
    v_lshl_add_u32 v10, v11, 5, v10
    v_bfe_u32 v11, v12, 1, 2
    v_lshl_add_u32 v10, v11, 2, v10
    v_add_u32 v10, 0, v10
    v_mov_b32 v12, 0x80000000
    v_cmp_gt_u32 vcc, 14, v13
    s_nop 1
    v_cndmask_b32 v10, v12, v10, vcc
    v_cmp_gt_u32 vcc, 32, v0
    s_nop 1
    v_cndmask_b32 v7, v12, v1, vcc
    v_lshlrev_b32 v8, 3, v0
    v_mov_b32 v9, 0x80008000
    v_min_u32 v5, 13, v13
    v_mul_u32_u24 v6, 14, v14
    v_add_lshl_u32 v5, v5, v6, 4
    s_mul_i32 s25, s24, 28672
    s_add_u32 s30, s25, 12845056
    s_add_u32 s31, s30, 3584
    s_mov_b32 s26, 42212352
    s_mov_b32 s35, 42252288
    s_mov_b32 s39, 48346112
    s_mov_b32 s36, 45314048
    s_cmp_eq_u32 s24, 0
    s_cselect_b32 s22, 0, 0x80000000
    s_cmp_eq_u32 s24, 1
    s_cselect_b32 s23, 0, 0x80000000
    v_or_b32 v6, s22, v1
    v_or_b32 v12, s23, v1
    s_waitcnt vmcnt(0)
    v_mov_b32 v44, 0
    v_mov_b32 v45, 0
    v_mov_b32 v46, 0
    v_mov_b32 v47, 0
    v_mov_b32 v48, 0
    v_mov_b32 v49, 0
    v_mov_b32 v50, 0
    v_mov_b32 v51, 0
    v_mov_b32 v52, 0
    v_mov_b32 v53, 0
    v_mov_b32 v54, 0
    v_mov_b32 v55, 0
    v_mov_b32 v56, 0
    v_mov_b32 v57, 0
    v_mov_b32 v58, 0
    v_mov_b32 v59, 0
    v_mov_b32 v60, 0
    v_mov_b32 v61, 0
    v_mov_b32 v62, 0
    v_mov_b32 v63, 0
    v_mov_b32 v64, 0
    v_mov_b32 v65, 0
    v_mov_b32 v66, 0
    v_mov_b32 v67, 0
    v_mov_b32 v68, 0
    v_mov_b32 v69, 0
    v_mov_b32 v70, 0
    v_mov_b32 v71, 0
    v_mov_b32 v16, -1
    v_mov_b32 v17, -1
    v_mov_b32 v18, 0
    ds_write_b64 v8, v[16:17] offset:15872
    ds_write_b64 v8, v[16:17] offset:17920
    v_lshrrev_b32 v13, 1, v8
    ds_write_b32 v13, v18 offset:9216
    s_waitcnt lgkmcnt(0)
    v_mov_b32 v108, 0
    v_mov_b32 v109, 0
    v_mov_b32 v110, 0
    v_mov_b32 v111, 0
    v_mov_b32 v116, 0
    v_mov_b32 v117, 0
    v_mov_b32 v118, 0
    v_mov_b32 v119, 0
    buffer_load_dwordx4 v[16:19], v1, s[4:7], s20 offen sc1
    buffer_load_dwordx4 v[20:23], v1, s[4:7], s21 offen sc1
LB_51:
    s_branch Lok_55
Lpm_54:
    buffer_load_dwordx4 v[16:19], v1, s[4:7], s20 offen sc1
    buffer_load_dwordx4 v[20:23], v1, s[4:7], s21 offen sc1
    s_sub_u32 s19, s19, 1
    s_cbranch_scc1 main_kernel_exit
    s_nop 2
    v_mov_b32 v44, 0
    v_mov_b32 v45, 0
    v_mov_b32 v46, 0
    v_mov_b32 v47, 0
    v_mov_b32 v48, 0
    v_mov_b32 v49, 0
    v_mov_b32 v50, 0
    v_mov_b32 v51, 0
Lok_55:
    s_waitcnt vmcnt(1)
    v_max3_u32 v13, v16, v17, v18
    s_waitcnt vmcnt(0)
    v_max3_u32 v15, v20, v21, v22
    v_max3_u32 v13, v19, v23, v13
    v_smfmac_f32_16x16x64_bf16 v[44:47], v[16:19], a[0:7], v2
    v_max_u32 v13, v13, v15
    v_cmp_eq_u32 vcc, -1, v13
    v_smfmac_f32_16x16x64_bf16 v[48:51], v[16:19], a[56:63], v2
    ds_write_b128 v1, v[16:19] offset:0
    s_cbranch_vccnz Lpm_54
    v_smfmac_f32_16x16x64_bf16 v[52:55], v[16:19], a[112:119], v2
    v_smfmac_f32_16x16x64_bf16 v[56:59], v[16:19], a[168:175], v2
    v_smfmac_f32_16x16x64_bf16 v[60:63], v[16:19], a[224:231], v2
    ds_write_b128 v1, v[20:23] offset:1024
    v_smfmac_f32_16x16x64_bf16 v[64:67], v[16:19], v[144:151], v2
    v_smfmac_f32_16x16x64_bf16 v[68:71], v[16:19], v[200:207], v2
    v_smfmac_f32_16x16x64_bf16 v[44:47], v[20:23], a[8:15], v2
    v_smfmac_f32_16x16x64_bf16 v[48:51], v[20:23], a[64:71], v2
    s_waitcnt lgkmcnt(0)
    s_barrier
    ds_read_b128 v[24:27], v1 offset:2048
    s_bitcmp1_b64 s[82:83], s18
    s_cbranch_scc0 Lfw_52
Lfb_53:
    v_smfmac_f32_16x16x64_bf16 v[52:55], v[20:23], a[120:127], v2
    ds_read_b128 v[28:31], v1 offset:3072
    buffer_load_dwordx4 v[72:75], v5, s[4:7], s30 offen offset:0 sc1
    v_smfmac_f32_16x16x64_bf16 v[56:59], v[20:23], a[176:183], v2
    ds_read_b128 v[32:35], v1 offset:4096
    v_smfmac_f32_16x16x64_bf16 v[60:63], v[20:23], a[232:239], v2
    ds_read_b128 v[36:39], v1 offset:5120
    buffer_load_dwordx4 v[80:83], v5, s[4:7], s30 offen offset:896 sc1
    v_smfmac_f32_16x16x64_bf16 v[64:67], v[20:23], v[152:159], v2
    ds_read_b128 v[40:43], v1 offset:6144
    v_smfmac_f32_16x16x64_bf16 v[68:71], v[20:23], v[208:215], v2
    buffer_load_dwordx4 v[76:79], v5, s[4:7], s30 offen offset:1792 sc1
    s_waitcnt lgkmcnt(0)
    v_smfmac_f32_16x16x64_bf16 v[44:47], v[24:27], a[16:23], v2
    s_add_u32 s20, s20, 47104
    v_smfmac_f32_16x16x64_bf16 v[44:47], v[28:31], a[24:31], v2
    buffer_load_dwordx4 v[84:87], v5, s[4:7], s30 offen offset:2688 sc1
    s_add_u32 s21, s21, 47104
    v_smfmac_f32_16x16x64_bf16 v[44:47], v[32:35], a[32:39], v2
    s_cmp_gt_u32 s24, 1
    s_cbranch_scc1 Lpub_56
    buffer_store_dwordx4 v[16:19], v6, s[4:7], s36 offen sc1
    buffer_store_dwordx4 v[20:23], v12, s[4:7], s36 offen offset:1024 sc1
Lpub_56:
    s_add_u32 s18, s18, 1
    v_smfmac_f32_16x16x64_bf16 v[44:47], v[36:39], a[40:47], v2
    buffer_load_dwordx4 v[88:91], v5, s[4:7], s31 offen offset:0 sc1
    s_add_u32 s36, s36, 48128
    v_smfmac_f32_16x16x64_bf16 v[44:47], v[40:43], a[48:55], v2
    s_add_u32 s38, s38, 47104
    v_smfmac_f32_16x16x64_bf16 v[48:51], v[24:27], a[72:79], v2
    ds_read_b128 v[16:19], v1 offset:24064
    buffer_load_dwordx4 v[96:99], v5, s[4:7], s31 offen offset:896 sc1
    v_smfmac_f32_16x16x64_bf16 v[48:51], v[28:31], a[80:87], v2
    ds_read_b128 v[20:23], v1 offset:24064
    v_smfmac_f32_16x16x64_bf16 v[48:51], v[32:35], a[88:95], v2
    v_add_f32 v44, v44, v46
    buffer_load_dwordx4 v[92:95], v5, s[4:7], s31 offen offset:1792 sc1
    v_smfmac_f32_16x16x64_bf16 v[48:51], v[36:39], a[96:103], v2
    v_add_f32 v45, v45, v47
    v_smfmac_f32_16x16x64_bf16 v[48:51], v[40:43], a[104:111], v2
    v_cvt_pk_bf16_f32 v44, v44, v45
    buffer_load_dwordx4 v[100:103], v5, s[4:7], s31 offen offset:2688 sc1
    v_smfmac_f32_16x16x64_bf16 v[52:55], v[24:27], a[128:135], v2
    ds_write_b32 v3, v44 offset:0
    v_smfmac_f32_16x16x64_bf16 v[52:55], v[28:31], a[136:143], v2
    v_smfmac_f32_16x16x64_bf16 v[52:55], v[32:35], a[144:151], v2
    v_add_f32 v48, v48, v50
    v_smfmac_f32_16x16x64_bf16 v[52:55], v[36:39], a[152:159], v2
    v_add_f32 v49, v49, v51
    v_smfmac_f32_16x16x64_bf16 v[52:55], v[40:43], a[160:167], v2
    v_cvt_pk_bf16_f32 v48, v48, v49
    v_smfmac_f32_16x16x64_bf16 v[56:59], v[24:27], a[184:191], v2
    ds_write_b32 v3, v48 offset:256
    v_smfmac_f32_16x16x64_bf16 v[56:59], v[28:31], a[192:199], v2
    v_smfmac_f32_16x16x64_bf16 v[56:59], v[32:35], a[200:207], v2
    v_add_f32 v52, v52, v54
    v_smfmac_f32_16x16x64_bf16 v[56:59], v[36:39], a[208:215], v2
    v_add_f32 v53, v53, v55
    v_smfmac_f32_16x16x64_bf16 v[56:59], v[40:43], a[216:223], v2
    v_cvt_pk_bf16_f32 v52, v52, v53
    v_smfmac_f32_16x16x64_bf16 v[60:63], v[24:27], a[240:247], v2
    ds_write_b32 v3, v52 offset:512
    v_smfmac_f32_16x16x64_bf16 v[60:63], v[28:31], a[248:255], v2
    v_smfmac_f32_16x16x64_bf16 v[60:63], v[32:35], v[120:127], v2
    v_add_f32 v56, v56, v58
    v_smfmac_f32_16x16x64_bf16 v[60:63], v[36:39], v[128:135], v2
    v_add_f32 v57, v57, v59
    v_smfmac_f32_16x16x64_bf16 v[60:63], v[40:43], v[136:143], v2
    v_cvt_pk_bf16_f32 v56, v56, v57
    v_smfmac_f32_16x16x64_bf16 v[64:67], v[24:27], v[160:167], v2
    ds_write_b32 v3, v56 offset:768
    v_smfmac_f32_16x16x64_bf16 v[64:67], v[28:31], v[168:175], v2
    v_smfmac_f32_16x16x64_bf16 v[64:67], v[32:35], v[176:183], v2
    v_add_f32 v60, v60, v62
    v_smfmac_f32_16x16x64_bf16 v[64:67], v[36:39], v[184:191], v2
    v_add_f32 v61, v61, v63
    v_smfmac_f32_16x16x64_bf16 v[64:67], v[40:43], v[192:199], v2
    v_cvt_pk_bf16_f32 v60, v60, v61
    v_smfmac_f32_16x16x64_bf16 v[68:71], v[24:27], v[216:223], v2
    ds_write_b32 v3, v60 offset:1024
    v_smfmac_f32_16x16x64_bf16 v[68:71], v[28:31], v[224:231], v2
    v_lshrrev_b32 v14, 2, v1
    buffer_load_dword v15, v14, s[4:7], s84 offen sc1
    v_smfmac_f32_16x16x64_bf16 v[68:71], v[32:35], v[232:239], v2
    v_add_f32 v64, v64, v66
    v_smfmac_f32_16x16x64_bf16 v[68:71], v[36:39], v[240:247], v2
    v_add_f32 v65, v65, v67
    v_smfmac_f32_16x16x64_bf16 v[68:71], v[40:43], v[248:255], v2
    v_cvt_pk_bf16_f32 v64, v64, v65
    ds_write_b32 v3, v64 offset:1280
    s_nop 7
    v_add_f32 v68, v68, v70
    v_add_f32 v69, v69, v71
    v_cvt_pk_bf16_f32 v68, v68, v69
    ds_write_b32 v3, v68 offset:1536
    ds_read_b128 v[104:107], v4
    ds_read_b128 v[112:115], v4 offset:224
    v_mov_b32 v40, -1
    v_mov_b32 v41, -1
    s_add_u32 s30, s30, 458752
    s_add_u32 s31, s31, 458752
    s_waitcnt lgkmcnt(0)
    s_nop 11
    v_mov_b32 v44, 0
    s_nop 1
    v_mov_b32 v45, 0
    s_nop 1
    v_mov_b32 v46, 0
    s_nop 1
    v_mov_b32 v47, 0
    s_nop 1
    v_mov_b32 v48, 0
    s_nop 1
    v_mov_b32 v49, 0
    s_nop 1
    v_mov_b32 v50, 0
    s_nop 1
    v_mov_b32 v51, 0
    s_nop 1
    v_mov_b32 v52, 0
    s_nop 1
    v_mov_b32 v53, 0
    s_nop 1
    v_mov_b32 v54, 0
    s_nop 1
    v_mov_b32 v55, 0
    s_nop 1
    v_mov_b32 v56, 0
    s_nop 1
    v_mov_b32 v57, 0
    s_nop 1
    buffer_load_dwordx4 v[24:27], v1, s[4:7], s26 offen sc1
    buffer_load_dwordx4 v[28:31], v1, s[4:7], s26 offen offset:1024 sc1
    buffer_load_dwordx4 v[32:35], v7, s[4:7], s26 offen offset:2048 sc1
    v_mov_b32 v58, 0
    s_nop 1
    v_mov_b32 v59, 0
    s_nop 1
    v_mov_b32 v60, 0
    s_nop 1
    v_mov_b32 v61, 0
    s_nop 1
    v_mov_b32 v62, 0
    s_nop 1
    v_mov_b32 v63, 0
    s_nop 1
    v_mov_b32 v64, 0
    s_nop 1
    v_mov_b32 v65, 0
    s_nop 1
    v_mov_b32 v66, 0
    s_nop 1
    v_mov_b32 v67, 0
    s_nop 1
    buffer_load_dwordx4 v[24:27], v1, s[4:7], s26 offen sc1
    buffer_load_dwordx4 v[28:31], v1, s[4:7], s26 offen offset:1024 sc1
    buffer_load_dwordx4 v[32:35], v7, s[4:7], s26 offen offset:2048 sc1
    v_mov_b32 v68, 0
    s_nop 1
    v_mov_b32 v69, 0
    s_nop 1
    v_mov_b32 v70, 0
    s_nop 1
    v_mov_b32 v71, 0
    s_nop 1
    s_branch Lok_58
Lpp_57:
    buffer_load_dwordx4 v[24:27], v1, s[4:7], s26 offen sc1
    buffer_load_dwordx4 v[28:31], v1, s[4:7], s26 offen offset:1024 sc1
    buffer_load_dwordx4 v[32:35], v7, s[4:7], s26 offen offset:2048 sc1
    s_sub_u32 s19, s19, 1
    s_cbranch_scc1 main_kernel_exit
    s_nop 2
    v_mov_b32 v16, 0
    v_mov_b32 v17, 0
    v_mov_b32 v18, 0
    v_mov_b32 v19, 0
Lok_58:
    s_waitcnt vmcnt(5)
    v_or3_b32 v13, v24, v25, v26
    s_waitcnt vmcnt(4)
    v_or3_b32 v14, v28, v29, v30
    v_or3_b32 v13, v13, v27, v31
    v_smfmac_f32_16x16x64_bf16 v[16:19], v[24:27], v[72:79], v2
    s_waitcnt vmcnt(3)
    v_or3_b32 v14, v14, v32, v33
    v_or3_b32 v13, v13, v34, v35
    v_smfmac_f32_16x16x64_bf16 v[16:19], v[28:31], v[88:95], v2
    v_bitop3_b32 v13, v13, v14, v9 bitop3:0xa8
    v_cmp_ne_u32 vcc, 0, v13
    v_smfmac_f32_16x16x64_bf16 v[16:19], v[32:35], v[104:111], v2
    s_cbranch_vccnz Lpp_57
    v_smfmac_f32_16x16x64_bf16 v[20:23], v[24:27], v[80:87], v2
    v_smfmac_f32_16x16x64_bf16 v[20:23], v[28:31], v[96:103], v2
    v_smfmac_f32_16x16x64_bf16 v[20:23], v[32:35], v[112:119], v2
    v_add_f32 v72, v16, v18
    v_add_f32 v74, v17, v19
    s_cmp_eq_u32 s37, 1
    s_nop 4
    v_add_f32 v73, v20, v22
    v_add_f32 v75, v21, v23
    ds_write_b64 v8, v[74:75] offset:17920
    s_barrier
    ds_read_b64 v[76:77], v8 offset:16384
    ds_read_b64 v[78:79], v8 offset:16896
    ds_read_b64 v[80:81], v8 offset:17408
    s_waitcnt lgkmcnt(2)
    v_pk_add_f32 v[82:83], v[72:73], v[76:77]
    s_waitcnt lgkmcnt(1)
    v_pk_add_f32 v[82:83], v[82:83], v[78:79]
    s_waitcnt lgkmcnt(0)
    v_pk_add_f32 v[82:83], v[82:83], v[80:81]
    v_cmp_u_f32 vcc, v82, v83
    v_cvt_pk_bf16_f32 v11, v82, v83
    s_cbranch_scc1 Ls_59
    v_cndmask_b32 v11, v11, v40, vcc
    buffer_store_dword v11, v10, s[4:7], s35 offen
Ls_60:
    s_cbranch_vccnz Lrs_61
Lrb_62:
    ds_write_b64 v8, v[40:41] offset:16384
    ds_write_b64 v8, v[40:41] offset:16896
    ds_write_b64 v8, v[40:41] offset:17408
    v_cmp_ne_u32 s[82:83], 0, v15
    s_cmp_ge_u32 s18, 63
    s_cbranch_scc1 Llast_63
    s_add_u32 s35, s35, 47104
    s_add_u32 s26, s26, 47104
    s_sleep 3
    s_nop 3
    buffer_load_dwordx4 v[16:19], v1, s[4:7], s20 offen sc1
    buffer_load_dwordx4 v[20:23], v1, s[4:7], s21 offen sc1
    s_branch LB_51
Ls_59:
    v_cndmask_b32 v11, v11, v40, vcc
    buffer_store_dword v11, v10, s[4:7], s35 offen sc1
    s_branch Ls_60
Lrs_61:
    ds_read_b64 v[76:77], v8 offset:16384
    ds_read_b64 v[78:79], v8 offset:16896
    ds_read_b64 v[80:81], v8 offset:17408
    s_sub_u32 s19, s19, 1
    s_cbranch_scc1 main_kernel_exit
    s_waitcnt vmcnt(0) lgkmcnt(0)
    v_max3_u32 v13, v76, v77, v78
    v_max3_u32 v13, v13, v79, v80
    v_max_u32 v13, v13, v81
    v_cmp_eq_u32 vcc, -1, v13
    s_cbranch_vccnz Lrs_61
    v_pk_add_f32 v[82:83], v[72:73], v[76:77]
    v_pk_add_f32 v[82:83], v[82:83], v[78:79]
    v_pk_add_f32 v[82:83], v[82:83], v[80:81]
    v_cvt_pk_bf16_f32 v11, v82, v83
    v_min_u32 v11, 0xfffffffe, v11
    s_cmp_eq_u32 s37, 1
    s_cbranch_scc1 Lr2_64
    buffer_store_dword v11, v10, s[4:7], s35 offen
    s_branch Lrb_62
Lr2_64:
    buffer_store_dword v11, v10, s[4:7], s35 offen sc1
    s_branch Lrb_62
Lfw_52:
    v_lshrrev_b32 v14, 2, v1
    buffer_load_dword v13, v14, s[4:7], s84 offen sc1
    s_waitcnt vmcnt(0)
    v_cmp_ne_u32 s[82:83], 0, v13
    s_nop 0
    s_bitcmp1_b64 s[82:83], s18
    s_cbranch_scc1 Lfb_53
    s_sub_u32 s19, s19, 1
    s_cbranch_scc1 main_kernel_exit
    s_sleep 2
    s_branch Lfw_52
Llast_63:
    buffer_store_dword v11, v10, s[4:7], s39 offen sc1
    s_branch main_kernel_exit
.p2align 6
LteamB1_8:
    v_lshlrev_b32 v1, 4, v0
    v_mov_b32 v2, 0x44444444
    v_mov_b32 v13, 0xeeeeeeee
    v_and_b32 v14, 2, v0
    v_cmp_ne_u32 vcc, 0, v14
    s_nop 1
    v_cndmask_b32 v2, v2, v13, vcc
    v_mov_b32 v13, 0
    v_lshlrev_b32 v14, 2, v0
    ds_write_b32 v14, v13 offset:24320
    s_mov_b32 s18, 0
    s_mov_b32 s34, 42222592
    s_mov_b64 s[82:83], 0
    s_and_b32 s84, s17, 15
    s_lshl_b32 s84, s84, 8
    s_add_u32 s84, s84, 54767616
    s_mov_b32 s20, 42207232
    s_mov_b32 s21, 42208256
    s_sub_u32 s24, s17, 16
    s_mul_i32 s25, s24, 28
    v_and_b32 v13, 15, v0
    v_lshrrev_b32 v14, 4, v0
    s_mul_i32 s22, s24, 401408
    s_add_u32 s22, s22, 6422528
    s_add_u32 s23, s22, 104448
    buffer_load_dwordx4 a[0:3], v1, s[4:7], s23 offen offset:0
    buffer_load_dwordx4 a[4:7], v1, s[4:7], s23 offen offset:1024
    s_add_u32 s23, s22, 106496
    buffer_load_dwordx4 a[8:11], v1, s[4:7], s23 offen offset:0
    buffer_load_dwordx4 a[12:15], v1, s[4:7], s23 offen offset:1024
    s_add_u32 s23, s22, 108544
    buffer_load_dwordx4 a[16:19], v1, s[4:7], s23 offen offset:0
    buffer_load_dwordx4 a[20:23], v1, s[4:7], s23 offen offset:1024
    s_add_u32 s23, s22, 110592
    buffer_load_dwordx4 a[24:27], v1, s[4:7], s23 offen offset:0
    buffer_load_dwordx4 a[28:31], v1, s[4:7], s23 offen offset:1024
    s_add_u32 s23, s22, 112640
    buffer_load_dwordx4 a[32:35], v1, s[4:7], s23 offen offset:0
    buffer_load_dwordx4 a[36:39], v1, s[4:7], s23 offen offset:1024
    s_add_u32 s23, s22, 100352
    buffer_load_dwordx4 a[40:43], v1, s[4:7], s23 offen offset:0
    buffer_load_dwordx4 a[44:47], v1, s[4:7], s23 offen offset:1024
    s_add_u32 s23, s22, 102400
    buffer_load_dwordx4 a[48:51], v1, s[4:7], s23 offen offset:0
    buffer_load_dwordx4 a[52:55], v1, s[4:7], s23 offen offset:1024
    s_add_u32 s23, s22, 118784
    buffer_load_dwordx4 a[56:59], v1, s[4:7], s23 offen offset:0
    buffer_load_dwordx4 a[60:63], v1, s[4:7], s23 offen offset:1024
    s_add_u32 s23, s22, 120832
    buffer_load_dwordx4 a[64:67], v1, s[4:7], s23 offen offset:0
    buffer_load_dwordx4 a[68:71], v1, s[4:7], s23 offen offset:1024
    s_add_u32 s23, s22, 122880
    buffer_load_dwordx4 a[72:75], v1, s[4:7], s23 offen offset:0
    buffer_load_dwordx4 a[76:79], v1, s[4:7], s23 offen offset:1024
    s_add_u32 s23, s22, 124928
    buffer_load_dwordx4 a[80:83], v1, s[4:7], s23 offen offset:0
    buffer_load_dwordx4 a[84:87], v1, s[4:7], s23 offen offset:1024
    s_add_u32 s23, s22, 126976
    buffer_load_dwordx4 a[88:91], v1, s[4:7], s23 offen offset:0
    buffer_load_dwordx4 a[92:95], v1, s[4:7], s23 offen offset:1024
    s_add_u32 s23, s22, 114688
    buffer_load_dwordx4 a[96:99], v1, s[4:7], s23 offen offset:0
    buffer_load_dwordx4 a[100:103], v1, s[4:7], s23 offen offset:1024
    s_add_u32 s23, s22, 116736
    buffer_load_dwordx4 a[104:107], v1, s[4:7], s23 offen offset:0
    buffer_load_dwordx4 a[108:111], v1, s[4:7], s23 offen offset:1024
    s_add_u32 s23, s22, 133120
    buffer_load_dwordx4 a[112:115], v1, s[4:7], s23 offen offset:0
    buffer_load_dwordx4 a[116:119], v1, s[4:7], s23 offen offset:1024
    s_add_u32 s23, s22, 135168
    buffer_load_dwordx4 a[120:123], v1, s[4:7], s23 offen offset:0
    buffer_load_dwordx4 a[124:127], v1, s[4:7], s23 offen offset:1024
    s_add_u32 s23, s22, 137216
    buffer_load_dwordx4 a[128:131], v1, s[4:7], s23 offen offset:0
    buffer_load_dwordx4 a[132:135], v1, s[4:7], s23 offen offset:1024
    s_add_u32 s23, s22, 139264
    buffer_load_dwordx4 a[136:139], v1, s[4:7], s23 offen offset:0
    buffer_load_dwordx4 a[140:143], v1, s[4:7], s23 offen offset:1024
    s_add_u32 s23, s22, 141312
    buffer_load_dwordx4 a[144:147], v1, s[4:7], s23 offen offset:0
    buffer_load_dwordx4 a[148:151], v1, s[4:7], s23 offen offset:1024
    s_add_u32 s23, s22, 129024
    buffer_load_dwordx4 a[152:155], v1, s[4:7], s23 offen offset:0
    buffer_load_dwordx4 a[156:159], v1, s[4:7], s23 offen offset:1024
    s_add_u32 s23, s22, 131072
    buffer_load_dwordx4 a[160:163], v1, s[4:7], s23 offen offset:0
    buffer_load_dwordx4 a[164:167], v1, s[4:7], s23 offen offset:1024
    s_waitcnt vmcnt(40)
    s_add_u32 s23, s22, 147456
    buffer_load_dwordx4 a[168:171], v1, s[4:7], s23 offen offset:0
    buffer_load_dwordx4 a[172:175], v1, s[4:7], s23 offen offset:1024
    s_add_u32 s23, s22, 149504
    buffer_load_dwordx4 a[176:179], v1, s[4:7], s23 offen offset:0
    buffer_load_dwordx4 a[180:183], v1, s[4:7], s23 offen offset:1024
    s_add_u32 s23, s22, 151552
    buffer_load_dwordx4 a[184:187], v1, s[4:7], s23 offen offset:0
    buffer_load_dwordx4 a[188:191], v1, s[4:7], s23 offen offset:1024
    s_add_u32 s23, s22, 153600
    buffer_load_dwordx4 a[192:195], v1, s[4:7], s23 offen offset:0
    buffer_load_dwordx4 a[196:199], v1, s[4:7], s23 offen offset:1024
    s_add_u32 s23, s22, 155648
    buffer_load_dwordx4 a[200:203], v1, s[4:7], s23 offen offset:0
    buffer_load_dwordx4 a[204:207], v1, s[4:7], s23 offen offset:1024
    s_add_u32 s23, s22, 143360
    buffer_load_dwordx4 a[208:211], v1, s[4:7], s23 offen offset:0
    buffer_load_dwordx4 a[212:215], v1, s[4:7], s23 offen offset:1024
    s_add_u32 s23, s22, 145408
    buffer_load_dwordx4 a[216:219], v1, s[4:7], s23 offen offset:0
    buffer_load_dwordx4 a[220:223], v1, s[4:7], s23 offen offset:1024
    s_waitcnt vmcnt(40)
    s_add_u32 s23, s22, 161792
    buffer_load_dwordx4 a[224:227], v1, s[4:7], s23 offen offset:0
    buffer_load_dwordx4 a[228:231], v1, s[4:7], s23 offen offset:1024
    s_add_u32 s23, s22, 163840
    buffer_load_dwordx4 a[232:235], v1, s[4:7], s23 offen offset:0
    buffer_load_dwordx4 a[236:239], v1, s[4:7], s23 offen offset:1024
    s_add_u32 s23, s22, 165888
    buffer_load_dwordx4 a[240:243], v1, s[4:7], s23 offen offset:0
    buffer_load_dwordx4 a[244:247], v1, s[4:7], s23 offen offset:1024
    s_add_u32 s23, s22, 167936
    buffer_load_dwordx4 a[248:251], v1, s[4:7], s23 offen offset:0
    buffer_load_dwordx4 a[252:255], v1, s[4:7], s23 offen offset:1024
    s_add_u32 s23, s22, 169984
    buffer_load_dwordx4 v[120:123], v1, s[4:7], s23 offen offset:0
    buffer_load_dwordx4 v[124:127], v1, s[4:7], s23 offen offset:1024
    s_add_u32 s23, s22, 157696
    buffer_load_dwordx4 v[128:131], v1, s[4:7], s23 offen offset:0
    buffer_load_dwordx4 v[132:135], v1, s[4:7], s23 offen offset:1024
    s_add_u32 s23, s22, 159744
    buffer_load_dwordx4 v[136:139], v1, s[4:7], s23 offen offset:0
    buffer_load_dwordx4 v[140:143], v1, s[4:7], s23 offen offset:1024
    s_waitcnt vmcnt(40)
    s_add_u32 s23, s22, 176128
    buffer_load_dwordx4 v[144:147], v1, s[4:7], s23 offen offset:0
    buffer_load_dwordx4 v[148:151], v1, s[4:7], s23 offen offset:1024
    s_add_u32 s23, s22, 178176
    buffer_load_dwordx4 v[152:155], v1, s[4:7], s23 offen offset:0
    buffer_load_dwordx4 v[156:159], v1, s[4:7], s23 offen offset:1024
    s_add_u32 s23, s22, 180224
    buffer_load_dwordx4 v[160:163], v1, s[4:7], s23 offen offset:0
    buffer_load_dwordx4 v[164:167], v1, s[4:7], s23 offen offset:1024
    s_add_u32 s23, s22, 182272
    buffer_load_dwordx4 v[168:171], v1, s[4:7], s23 offen offset:0
    buffer_load_dwordx4 v[172:175], v1, s[4:7], s23 offen offset:1024
    s_add_u32 s23, s22, 184320
    buffer_load_dwordx4 v[176:179], v1, s[4:7], s23 offen offset:0
    buffer_load_dwordx4 v[180:183], v1, s[4:7], s23 offen offset:1024
    s_add_u32 s23, s22, 172032
    buffer_load_dwordx4 v[184:187], v1, s[4:7], s23 offen offset:0
    buffer_load_dwordx4 v[188:191], v1, s[4:7], s23 offen offset:1024
    s_add_u32 s23, s22, 174080
    buffer_load_dwordx4 v[192:195], v1, s[4:7], s23 offen offset:0
    buffer_load_dwordx4 v[196:199], v1, s[4:7], s23 offen offset:1024
    s_waitcnt vmcnt(40)
    s_add_u32 s23, s22, 190464
    buffer_load_dwordx4 v[200:203], v1, s[4:7], s23 offen offset:0
    buffer_load_dwordx4 v[204:207], v1, s[4:7], s23 offen offset:1024
    s_add_u32 s23, s22, 192512
    buffer_load_dwordx4 v[208:211], v1, s[4:7], s23 offen offset:0
    buffer_load_dwordx4 v[212:215], v1, s[4:7], s23 offen offset:1024
    s_add_u32 s23, s22, 194560
    buffer_load_dwordx4 v[216:219], v1, s[4:7], s23 offen offset:0
    buffer_load_dwordx4 v[220:223], v1, s[4:7], s23 offen offset:1024
    s_add_u32 s23, s22, 196608
    buffer_load_dwordx4 v[224:227], v1, s[4:7], s23 offen offset:0
    buffer_load_dwordx4 v[228:231], v1, s[4:7], s23 offen offset:1024
    s_add_u32 s23, s22, 198656
    buffer_load_dwordx4 v[232:235], v1, s[4:7], s23 offen offset:0
    buffer_load_dwordx4 v[236:239], v1, s[4:7], s23 offen offset:1024
    s_add_u32 s23, s22, 186368
    buffer_load_dwordx4 v[240:243], v1, s[4:7], s23 offen offset:0
    buffer_load_dwordx4 v[244:247], v1, s[4:7], s23 offen offset:1024
    s_add_u32 s23, s22, 188416
    buffer_load_dwordx4 v[248:251], v1, s[4:7], s23 offen offset:0
    buffer_load_dwordx4 v[252:255], v1, s[4:7], s23 offen offset:1024
    s_waitcnt vmcnt(40)
    s_cmp_lg_u32 s94, 0
    s_cbranch_scc1 Lvf_66
    v_and_b32 v45, 31, v0
    v_lshlrev_b32 v45, 2, v45
Lvf_65:
    buffer_load_dword v44, v45, s[12:15], 0 offen offset:128 sc1
    s_sub_u32 s19, s19, 1
    s_cbranch_scc1 main_kernel_exit
    s_waitcnt vmcnt(0)
    v_cmp_eq_u32 vcc, 0, v44
    s_cbranch_vccnz Lvf_65
    v_readfirstlane_b32 s94, v44
    s_nop 1
    v_cmp_ne_u32 vcc, s94, v44
    s_cbranch_vccnz main_kernel_census
Lvf_66:
    v_lshlrev_b32 v3, 4, v13
    v_lshl_add_u32 v3, v14, 2, v3
    v_add_u32 v3, 9472, v3
    v_mul_u32_u24 v4, 28, v14
    v_add_u32 v4, v4, v13
    v_lshlrev_b32 v4, 4, v4
    v_add_u32 v4, 9472, v4
    v_lshlrev_b32 v12, 1, v13
    v_add_u32 v12, s25, v12
    v_lshrrev_b32 v10, 4, v12
    v_lshlrev_b32 v10, 8, v10
    v_lshl_add_u32 v10, v14, 6, v10
    v_bfe_u32 v11, v12, 3, 1
    v_lshl_add_u32 v10, v11, 5, v10
    v_bfe_u32 v11, v12, 1, 2
    v_lshl_add_u32 v10, v11, 2, v10
    v_add_u32 v10, 16, v10
    v_mov_b32 v12, 0x80000000
    v_cmp_gt_u32 vcc, 14, v13
    s_nop 1
    v_cndmask_b32 v10, v12, v10, vcc
    v_cmp_gt_u32 vcc, 32, v0
    s_nop 1
    v_cndmask_b32 v7, v12, v1, vcc
    v_lshlrev_b32 v8, 3, v0
    v_mov_b32 v9, 0x80008000
    v_min_u32 v5, 13, v13
    v_mul_u32_u24 v6, 14, v14
    v_add_lshl_u32 v5, v5, v6, 4
    s_mul_i32 s25, s24, 28672
    s_add_u32 s30, s25, 12852224
    s_add_u32 s31, s30, 3584
    s_mov_b32 s26, 42214912
    s_mov_b32 s35, 42252288
    s_mov_b32 s39, 48346112
    s_mov_b32 s36, 45316096
    s_cmp_eq_u32 s24, 0
    s_cselect_b32 s22, 0, 0x80000000
    s_cmp_eq_u32 s24, 1
    s_cselect_b32 s23, 0, 0x80000000
    v_or_b32 v6, s22, v1
    v_or_b32 v12, s23, v1
    s_waitcnt vmcnt(0)
    v_mov_b32 v44, 0
    v_mov_b32 v45, 0
    v_mov_b32 v46, 0
    v_mov_b32 v47, 0
    v_mov_b32 v48, 0
    v_mov_b32 v49, 0
    v_mov_b32 v50, 0
    v_mov_b32 v51, 0
    v_mov_b32 v52, 0
    v_mov_b32 v53, 0
    v_mov_b32 v54, 0
    v_mov_b32 v55, 0
    v_mov_b32 v56, 0
    v_mov_b32 v57, 0
    v_mov_b32 v58, 0
    v_mov_b32 v59, 0
    v_mov_b32 v60, 0
    v_mov_b32 v61, 0
    v_mov_b32 v62, 0
    v_mov_b32 v63, 0
    v_mov_b32 v64, 0
    v_mov_b32 v65, 0
    v_mov_b32 v66, 0
    v_mov_b32 v67, 0
    v_mov_b32 v68, 0
    v_mov_b32 v69, 0
    v_mov_b32 v70, 0
    v_mov_b32 v71, 0
    v_mov_b32 v16, -1
    v_mov_b32 v17, -1
    v_mov_b32 v18, 0
    ds_write_b64 v8, v[16:17] offset:16384
    ds_write_b64 v8, v[16:17] offset:18432
    v_lshrrev_b32 v13, 1, v8
    ds_write_b32 v13, v18 offset:11264
    s_waitcnt lgkmcnt(0)
    v_mov_b32 v108, 0
    v_mov_b32 v109, 0
    v_mov_b32 v110, 0
    v_mov_b32 v111, 0
    v_mov_b32 v116, 0
    v_mov_b32 v117, 0
    v_mov_b32 v118, 0
    v_mov_b32 v119, 0
    buffer_load_dwordx4 v[16:19], v1, s[4:7], s20 offen sc1
    buffer_load_dwordx4 v[20:23], v1, s[4:7], s21 offen sc1
LB_67:
    s_branch Lok_71
Lpm_70:
    buffer_load_dwordx4 v[16:19], v1, s[4:7], s20 offen sc1
    buffer_load_dwordx4 v[20:23], v1, s[4:7], s21 offen sc1
    s_sub_u32 s19, s19, 1
    s_cbranch_scc1 main_kernel_exit
    s_nop 2
    v_mov_b32 v44, 0
    v_mov_b32 v45, 0
    v_mov_b32 v46, 0
    v_mov_b32 v47, 0
    v_mov_b32 v48, 0
    v_mov_b32 v49, 0
    v_mov_b32 v50, 0
    v_mov_b32 v51, 0
Lok_71:
    s_waitcnt vmcnt(1)
    v_max3_u32 v13, v16, v17, v18
    s_waitcnt vmcnt(0)
    v_max3_u32 v15, v20, v21, v22
    v_max3_u32 v13, v19, v23, v13
    v_smfmac_f32_16x16x64_bf16 v[44:47], v[16:19], a[0:7], v2
    v_max_u32 v13, v13, v15
    v_cmp_eq_u32 vcc, -1, v13
    v_smfmac_f32_16x16x64_bf16 v[48:51], v[16:19], a[56:63], v2
    ds_write_b128 v1, v[16:19] offset:2048
    s_cbranch_vccnz Lpm_70
    v_smfmac_f32_16x16x64_bf16 v[52:55], v[16:19], a[112:119], v2
    v_smfmac_f32_16x16x64_bf16 v[56:59], v[16:19], a[168:175], v2
    v_smfmac_f32_16x16x64_bf16 v[60:63], v[16:19], a[224:231], v2
    ds_write_b128 v1, v[20:23] offset:3072
    v_smfmac_f32_16x16x64_bf16 v[64:67], v[16:19], v[144:151], v2
    v_smfmac_f32_16x16x64_bf16 v[68:71], v[16:19], v[200:207], v2
    v_smfmac_f32_16x16x64_bf16 v[44:47], v[20:23], a[8:15], v2
    v_smfmac_f32_16x16x64_bf16 v[48:51], v[20:23], a[64:71], v2
    s_waitcnt lgkmcnt(0)
    s_barrier
    ds_read_b128 v[24:27], v1 offset:4096
    s_bitcmp1_b64 s[82:83], s18
    s_cbranch_scc0 Lfw_68
Lfb_69:
    v_smfmac_f32_16x16x64_bf16 v[52:55], v[20:23], a[120:127], v2
    ds_read_b128 v[28:31], v1 offset:5120
    buffer_load_dwordx4 v[72:75], v5, s[4:7], s30 offen offset:0 sc1
    v_smfmac_f32_16x16x64_bf16 v[56:59], v[20:23], a[176:183], v2
    ds_read_b128 v[32:35], v1 offset:6144
    v_smfmac_f32_16x16x64_bf16 v[60:63], v[20:23], a[232:239], v2
    ds_read_b128 v[36:39], v1 offset:0
    buffer_load_dwordx4 v[80:83], v5, s[4:7], s30 offen offset:896 sc1
    v_smfmac_f32_16x16x64_bf16 v[64:67], v[20:23], v[152:159], v2
    ds_read_b128 v[40:43], v1 offset:1024
    v_smfmac_f32_16x16x64_bf16 v[68:71], v[20:23], v[208:215], v2
    buffer_load_dwordx4 v[76:79], v5, s[4:7], s30 offen offset:1792 sc1
    s_waitcnt lgkmcnt(0)
    v_smfmac_f32_16x16x64_bf16 v[44:47], v[24:27], a[16:23], v2
    s_add_u32 s20, s20, 47104
    v_smfmac_f32_16x16x64_bf16 v[44:47], v[28:31], a[24:31], v2
    buffer_load_dwordx4 v[84:87], v5, s[4:7], s30 offen offset:2688 sc1
    s_add_u32 s21, s21, 47104
    v_smfmac_f32_16x16x64_bf16 v[44:47], v[32:35], a[32:39], v2
    s_cmp_gt_u32 s24, 1
    s_cbranch_scc1 Lpub_72
    buffer_store_dwordx4 v[16:19], v6, s[4:7], s36 offen sc1
    buffer_store_dwordx4 v[20:23], v12, s[4:7], s36 offen offset:1024 sc1
Lpub_72:
    s_add_u32 s18, s18, 1
    v_smfmac_f32_16x16x64_bf16 v[44:47], v[36:39], a[40:47], v2
    buffer_load_dwordx4 v[88:91], v5, s[4:7], s31 offen offset:0 sc1
    s_add_u32 s36, s36, 48128
    v_smfmac_f32_16x16x64_bf16 v[44:47], v[40:43], a[48:55], v2
    s_add_u32 s38, s38, 47104
    v_smfmac_f32_16x16x64_bf16 v[48:51], v[24:27], a[72:79], v2
    ds_read_b128 v[16:19], v1 offset:24064
    buffer_load_dwordx4 v[96:99], v5, s[4:7], s31 offen offset:896 sc1
    v_smfmac_f32_16x16x64_bf16 v[48:51], v[28:31], a[80:87], v2
    ds_read_b128 v[20:23], v1 offset:24064
    v_smfmac_f32_16x16x64_bf16 v[48:51], v[32:35], a[88:95], v2
    v_add_f32 v44, v44, v46
    buffer_load_dwordx4 v[92:95], v5, s[4:7], s31 offen offset:1792 sc1
    v_smfmac_f32_16x16x64_bf16 v[48:51], v[36:39], a[96:103], v2
    v_add_f32 v45, v45, v47
    v_smfmac_f32_16x16x64_bf16 v[48:51], v[40:43], a[104:111], v2
    v_cvt_pk_bf16_f32 v44, v44, v45
    buffer_load_dwordx4 v[100:103], v5, s[4:7], s31 offen offset:2688 sc1
    v_smfmac_f32_16x16x64_bf16 v[52:55], v[24:27], a[128:135], v2
    ds_write_b32 v3, v44 offset:0
    v_smfmac_f32_16x16x64_bf16 v[52:55], v[28:31], a[136:143], v2
    v_smfmac_f32_16x16x64_bf16 v[52:55], v[32:35], a[144:151], v2
    v_add_f32 v48, v48, v50
    v_smfmac_f32_16x16x64_bf16 v[52:55], v[36:39], a[152:159], v2
    v_add_f32 v49, v49, v51
    v_smfmac_f32_16x16x64_bf16 v[52:55], v[40:43], a[160:167], v2
    v_cvt_pk_bf16_f32 v48, v48, v49
    v_smfmac_f32_16x16x64_bf16 v[56:59], v[24:27], a[184:191], v2
    ds_write_b32 v3, v48 offset:256
    v_smfmac_f32_16x16x64_bf16 v[56:59], v[28:31], a[192:199], v2
    v_smfmac_f32_16x16x64_bf16 v[56:59], v[32:35], a[200:207], v2
    v_add_f32 v52, v52, v54
    v_smfmac_f32_16x16x64_bf16 v[56:59], v[36:39], a[208:215], v2
    v_add_f32 v53, v53, v55
    v_smfmac_f32_16x16x64_bf16 v[56:59], v[40:43], a[216:223], v2
    v_cvt_pk_bf16_f32 v52, v52, v53
    v_smfmac_f32_16x16x64_bf16 v[60:63], v[24:27], a[240:247], v2
    ds_write_b32 v3, v52 offset:512
    v_smfmac_f32_16x16x64_bf16 v[60:63], v[28:31], a[248:255], v2
    v_smfmac_f32_16x16x64_bf16 v[60:63], v[32:35], v[120:127], v2
    v_add_f32 v56, v56, v58
    v_smfmac_f32_16x16x64_bf16 v[60:63], v[36:39], v[128:135], v2
    v_add_f32 v57, v57, v59
    v_smfmac_f32_16x16x64_bf16 v[60:63], v[40:43], v[136:143], v2
    v_cvt_pk_bf16_f32 v56, v56, v57
    v_smfmac_f32_16x16x64_bf16 v[64:67], v[24:27], v[160:167], v2
    ds_write_b32 v3, v56 offset:768
    v_smfmac_f32_16x16x64_bf16 v[64:67], v[28:31], v[168:175], v2
    v_smfmac_f32_16x16x64_bf16 v[64:67], v[32:35], v[176:183], v2
    v_add_f32 v60, v60, v62
    v_smfmac_f32_16x16x64_bf16 v[64:67], v[36:39], v[184:191], v2
    v_add_f32 v61, v61, v63
    v_smfmac_f32_16x16x64_bf16 v[64:67], v[40:43], v[192:199], v2
    v_cvt_pk_bf16_f32 v60, v60, v61
    v_smfmac_f32_16x16x64_bf16 v[68:71], v[24:27], v[216:223], v2
    ds_write_b32 v3, v60 offset:1024
    v_smfmac_f32_16x16x64_bf16 v[68:71], v[28:31], v[224:231], v2
    v_lshrrev_b32 v14, 2, v1
    buffer_load_dword v15, v14, s[4:7], s84 offen sc1
    v_smfmac_f32_16x16x64_bf16 v[68:71], v[32:35], v[232:239], v2
    v_add_f32 v64, v64, v66
    v_smfmac_f32_16x16x64_bf16 v[68:71], v[36:39], v[240:247], v2
    v_add_f32 v65, v65, v67
    v_smfmac_f32_16x16x64_bf16 v[68:71], v[40:43], v[248:255], v2
    v_cvt_pk_bf16_f32 v64, v64, v65
    ds_write_b32 v3, v64 offset:1280
    s_nop 7
    v_add_f32 v68, v68, v70
    v_add_f32 v69, v69, v71
    v_cvt_pk_bf16_f32 v68, v68, v69
    ds_write_b32 v3, v68 offset:1536
    ds_read_b128 v[104:107], v4
    ds_read_b128 v[112:115], v4 offset:224
    v_mov_b32 v40, -1
    v_mov_b32 v41, -1
    s_add_u32 s30, s30, 458752
    s_add_u32 s31, s31, 458752
    s_waitcnt lgkmcnt(0)
    s_nop 11
    v_mov_b32 v44, 0
    s_nop 1
    v_mov_b32 v45, 0
    s_nop 1
    v_mov_b32 v46, 0
    s_nop 1
    v_mov_b32 v47, 0
    s_nop 1
    v_mov_b32 v48, 0
    s_nop 1
    v_mov_b32 v49, 0
    s_nop 1
    v_mov_b32 v50, 0
    s_nop 1
    v_mov_b32 v51, 0
    s_nop 1
    v_mov_b32 v52, 0
    s_nop 1
    v_mov_b32 v53, 0
    s_nop 1
    v_mov_b32 v54, 0
    s_nop 1
    v_mov_b32 v55, 0
    s_nop 1
    v_mov_b32 v56, 0
    s_nop 1
    v_mov_b32 v57, 0
    s_nop 1
    buffer_load_dwordx4 v[24:27], v1, s[4:7], s26 offen sc1
    buffer_load_dwordx4 v[28:31], v1, s[4:7], s26 offen offset:1024 sc1
    buffer_load_dwordx4 v[32:35], v7, s[4:7], s26 offen offset:2048 sc1
    v_mov_b32 v58, 0
    s_nop 1
    v_mov_b32 v59, 0
    s_nop 1
    v_mov_b32 v60, 0
    s_nop 1
    v_mov_b32 v61, 0
    s_nop 1
    v_mov_b32 v62, 0
    s_nop 1
    v_mov_b32 v63, 0
    s_nop 1
    v_mov_b32 v64, 0
    s_nop 1
    v_mov_b32 v65, 0
    s_nop 1
    v_mov_b32 v66, 0
    s_nop 1
    v_mov_b32 v67, 0
    s_nop 1
    buffer_load_dwordx4 v[24:27], v1, s[4:7], s26 offen sc1
    buffer_load_dwordx4 v[28:31], v1, s[4:7], s26 offen offset:1024 sc1
    buffer_load_dwordx4 v[32:35], v7, s[4:7], s26 offen offset:2048 sc1
    v_mov_b32 v68, 0
    s_nop 1
    v_mov_b32 v69, 0
    s_nop 1
    v_mov_b32 v70, 0
    s_nop 1
    v_mov_b32 v71, 0
    s_nop 1
    s_branch Lok_74
Lpp_73:
    buffer_load_dwordx4 v[24:27], v1, s[4:7], s26 offen sc1
    buffer_load_dwordx4 v[28:31], v1, s[4:7], s26 offen offset:1024 sc1
    buffer_load_dwordx4 v[32:35], v7, s[4:7], s26 offen offset:2048 sc1
    s_sub_u32 s19, s19, 1
    s_cbranch_scc1 main_kernel_exit
    s_nop 2
    v_mov_b32 v16, 0
    v_mov_b32 v17, 0
    v_mov_b32 v18, 0
    v_mov_b32 v19, 0
Lok_74:
    s_waitcnt vmcnt(5)
    v_or3_b32 v13, v24, v25, v26
    s_waitcnt vmcnt(4)
    v_or3_b32 v14, v28, v29, v30
    v_or3_b32 v13, v13, v27, v31
    v_smfmac_f32_16x16x64_bf16 v[16:19], v[24:27], v[72:79], v2
    s_waitcnt vmcnt(3)
    v_or3_b32 v14, v14, v32, v33
    v_or3_b32 v13, v13, v34, v35
    v_smfmac_f32_16x16x64_bf16 v[16:19], v[28:31], v[88:95], v2
    v_bitop3_b32 v13, v13, v14, v9 bitop3:0xa8
    v_cmp_ne_u32 vcc, 0, v13
    v_smfmac_f32_16x16x64_bf16 v[16:19], v[32:35], v[104:111], v2
    s_cbranch_vccnz Lpp_73
    v_smfmac_f32_16x16x64_bf16 v[20:23], v[24:27], v[80:87], v2
    v_smfmac_f32_16x16x64_bf16 v[20:23], v[28:31], v[96:103], v2
    v_smfmac_f32_16x16x64_bf16 v[20:23], v[32:35], v[112:119], v2
    v_add_f32 v72, v16, v18
    v_add_f32 v74, v17, v19
    s_cmp_eq_u32 s37, 1
    s_nop 4
    v_add_f32 v73, v20, v22
    v_add_f32 v75, v21, v23
    ds_write_b64 v8, v[72:73] offset:16384
    s_barrier
    ds_read_b64 v[76:77], v8 offset:17920
    ds_read_b64 v[78:79], v8 offset:18944
    ds_read_b64 v[80:81], v8 offset:19456
    s_waitcnt lgkmcnt(2)
    v_pk_add_f32 v[82:83], v[74:75], v[76:77]
    s_waitcnt lgkmcnt(1)
    v_pk_add_f32 v[82:83], v[82:83], v[78:79]
    s_waitcnt lgkmcnt(0)
    v_pk_add_f32 v[82:83], v[82:83], v[80:81]
    v_cmp_u_f32 vcc, v82, v83
    v_cvt_pk_bf16_f32 v11, v82, v83
    s_cbranch_scc1 Ls_75
    v_cndmask_b32 v11, v11, v40, vcc
    buffer_store_dword v11, v10, s[4:7], s35 offen
Ls_76:
    s_cbranch_vccnz Lrs_77
Lrb_78:
    ds_write_b64 v8, v[40:41] offset:17920
    ds_write_b64 v8, v[40:41] offset:18944
    ds_write_b64 v8, v[40:41] offset:19456
    v_cmp_ne_u32 s[82:83], 0, v15
    s_cmp_ge_u32 s18, 63
    s_cbranch_scc1 Llast_79
    s_add_u32 s35, s35, 47104
    s_add_u32 s26, s26, 47104
    s_sleep 3
    s_nop 3
    buffer_load_dwordx4 v[16:19], v1, s[4:7], s20 offen sc1
    buffer_load_dwordx4 v[20:23], v1, s[4:7], s21 offen sc1
    s_branch LB_67
Ls_75:
    v_cndmask_b32 v11, v11, v40, vcc
    buffer_store_dword v11, v10, s[4:7], s35 offen sc1
    s_branch Ls_76
Lrs_77:
    ds_read_b64 v[76:77], v8 offset:17920
    ds_read_b64 v[78:79], v8 offset:18944
    ds_read_b64 v[80:81], v8 offset:19456
    s_sub_u32 s19, s19, 1
    s_cbranch_scc1 main_kernel_exit
    s_waitcnt vmcnt(0) lgkmcnt(0)
    v_max3_u32 v13, v76, v77, v78
    v_max3_u32 v13, v13, v79, v80
    v_max_u32 v13, v13, v81
    v_cmp_eq_u32 vcc, -1, v13
    s_cbranch_vccnz Lrs_77
    v_pk_add_f32 v[82:83], v[74:75], v[76:77]
    v_pk_add_f32 v[82:83], v[82:83], v[78:79]
    v_pk_add_f32 v[82:83], v[82:83], v[80:81]
    v_cvt_pk_bf16_f32 v11, v82, v83
    v_min_u32 v11, 0xfffffffe, v11
    s_cmp_eq_u32 s37, 1
    s_cbranch_scc1 Lr2_80
    buffer_store_dword v11, v10, s[4:7], s35 offen
    s_branch Lrb_78
Lr2_80:
    buffer_store_dword v11, v10, s[4:7], s35 offen sc1
    s_branch Lrb_78
Lfw_68:
    v_lshrrev_b32 v14, 2, v1
    buffer_load_dword v13, v14, s[4:7], s84 offen sc1
    s_waitcnt vmcnt(0)
    v_cmp_ne_u32 s[82:83], 0, v13
    s_nop 0
    s_bitcmp1_b64 s[82:83], s18
    s_cbranch_scc1 Lfb_69
    s_sub_u32 s19, s19, 1
    s_cbranch_scc1 main_kernel_exit
    s_sleep 2
    s_branch Lfw_68
Llast_79:
    buffer_store_dword v11, v10, s[4:7], s39 offen sc1
    s_branch main_kernel_exit
.p2align 6
LteamB2_9:
    v_lshlrev_b32 v1, 4, v0
    v_mov_b32 v2, 0x44444444
    v_mov_b32 v13, 0xeeeeeeee
    v_and_b32 v14, 2, v0
    v_cmp_ne_u32 vcc, 0, v14
    s_nop 1
    v_cndmask_b32 v2, v2, v13, vcc
    v_mov_b32 v13, 0
    v_lshlrev_b32 v14, 2, v0
    ds_write_b32 v14, v13 offset:24576
    s_mov_b32 s18, 0
    s_mov_b32 s34, 42222592
    s_mov_b64 s[82:83], 0
    s_and_b32 s84, s17, 15
    s_lshl_b32 s84, s84, 8
    s_add_u32 s84, s84, 54767616
    s_mov_b32 s20, 42209280
    s_mov_b32 s21, 42210304
    s_sub_u32 s24, s17, 16
    s_mul_i32 s25, s24, 28
    v_and_b32 v13, 15, v0
    v_lshrrev_b32 v14, 4, v0
    s_mul_i32 s22, s24, 401408
    s_add_u32 s22, s22, 6422528
    s_add_u32 s23, s22, 208896
    buffer_load_dwordx4 a[0:3], v1, s[4:7], s23 offen offset:0
    buffer_load_dwordx4 a[4:7], v1, s[4:7], s23 offen offset:1024
    s_add_u32 s23, s22, 210944
    buffer_load_dwordx4 a[8:11], v1, s[4:7], s23 offen offset:0
    buffer_load_dwordx4 a[12:15], v1, s[4:7], s23 offen offset:1024
    s_add_u32 s23, s22, 212992
    buffer_load_dwordx4 a[16:19], v1, s[4:7], s23 offen offset:0
    buffer_load_dwordx4 a[20:23], v1, s[4:7], s23 offen offset:1024
    s_add_u32 s23, s22, 200704
    buffer_load_dwordx4 a[24:27], v1, s[4:7], s23 offen offset:0
    buffer_load_dwordx4 a[28:31], v1, s[4:7], s23 offen offset:1024
    s_add_u32 s23, s22, 202752
    buffer_load_dwordx4 a[32:35], v1, s[4:7], s23 offen offset:0
    buffer_load_dwordx4 a[36:39], v1, s[4:7], s23 offen offset:1024
    s_add_u32 s23, s22, 204800
    buffer_load_dwordx4 a[40:43], v1, s[4:7], s23 offen offset:0
    buffer_load_dwordx4 a[44:47], v1, s[4:7], s23 offen offset:1024
    s_add_u32 s23, s22, 206848
    buffer_load_dwordx4 a[48:51], v1, s[4:7], s23 offen offset:0
    buffer_load_dwordx4 a[52:55], v1, s[4:7], s23 offen offset:1024
    s_add_u32 s23, s22, 223232
    buffer_load_dwordx4 a[56:59], v1, s[4:7], s23 offen offset:0
    buffer_load_dwordx4 a[60:63], v1, s[4:7], s23 offen offset:1024
    s_add_u32 s23, s22, 225280
    buffer_load_dwordx4 a[64:67], v1, s[4:7], s23 offen offset:0
    buffer_load_dwordx4 a[68:71], v1, s[4:7], s23 offen offset:1024
    s_add_u32 s23, s22, 227328
    buffer_load_dwordx4 a[72:75], v1, s[4:7], s23 offen offset:0
    buffer_load_dwordx4 a[76:79], v1, s[4:7], s23 offen offset:1024
    s_add_u32 s23, s22, 215040
    buffer_load_dwordx4 a[80:83], v1, s[4:7], s23 offen offset:0
    buffer_load_dwordx4 a[84:87], v1, s[4:7], s23 offen offset:1024
    s_add_u32 s23, s22, 217088
    buffer_load_dwordx4 a[88:91], v1, s[4:7], s23 offen offset:0
    buffer_load_dwordx4 a[92:95], v1, s[4:7], s23 offen offset:1024
    s_add_u32 s23, s22, 219136
    buffer_load_dwordx4 a[96:99], v1, s[4:7], s23 offen offset:0
    buffer_load_dwordx4 a[100:103], v1, s[4:7], s23 offen offset:1024
    s_add_u32 s23, s22, 221184
    buffer_load_dwordx4 a[104:107], v1, s[4:7], s23 offen offset:0
    buffer_load_dwordx4 a[108:111], v1, s[4:7], s23 offen offset:1024
    s_add_u32 s23, s22, 237568
    buffer_load_dwordx4 a[112:115], v1, s[4:7], s23 offen offset:0
    buffer_load_dwordx4 a[116:119], v1, s[4:7], s23 offen offset:1024
    s_add_u32 s23, s22, 239616
    buffer_load_dwordx4 a[120:123], v1, s[4:7], s23 offen offset:0
    buffer_load_dwordx4 a[124:127], v1, s[4:7], s23 offen offset:1024
    s_add_u32 s23, s22, 241664
    buffer_load_dwordx4 a[128:131], v1, s[4:7], s23 offen offset:0
    buffer_load_dwordx4 a[132:135], v1, s[4:7], s23 offen offset:1024
    s_add_u32 s23, s22, 229376
    buffer_load_dwordx4 a[136:139], v1, s[4:7], s23 offen offset:0
    buffer_load_dwordx4 a[140:143], v1, s[4:7], s23 offen offset:1024
    s_add_u32 s23, s22, 231424
    buffer_load_dwordx4 a[144:147], v1, s[4:7], s23 offen offset:0
    buffer_load_dwordx4 a[148:151], v1, s[4:7], s23 offen offset:1024
    s_add_u32 s23, s22, 233472
    buffer_load_dwordx4 a[152:155], v1, s[4:7], s23 offen offset:0
    buffer_load_dwordx4 a[156:159], v1, s[4:7], s23 offen offset:1024
    s_add_u32 s23, s22, 235520
    buffer_load_dwordx4 a[160:163], v1, s[4:7], s23 offen offset:0
    buffer_load_dwordx4 a[164:167], v1, s[4:7], s23 offen offset:1024
    s_waitcnt vmcnt(40)
    s_add_u32 s23, s22, 251904
    buffer_load_dwordx4 a[168:171], v1, s[4:7], s23 offen offset:0
    buffer_load_dwordx4 a[172:175], v1, s[4:7], s23 offen offset:1024
    s_add_u32 s23, s22, 253952
    buffer_load_dwordx4 a[176:179], v1, s[4:7], s23 offen offset:0
    buffer_load_dwordx4 a[180:183], v1, s[4:7], s23 offen offset:1024
    s_add_u32 s23, s22, 256000
    buffer_load_dwordx4 a[184:187], v1, s[4:7], s23 offen offset:0
    buffer_load_dwordx4 a[188:191], v1, s[4:7], s23 offen offset:1024
    s_add_u32 s23, s22, 243712
    buffer_load_dwordx4 a[192:195], v1, s[4:7], s23 offen offset:0
    buffer_load_dwordx4 a[196:199], v1, s[4:7], s23 offen offset:1024
    s_add_u32 s23, s22, 245760
    buffer_load_dwordx4 a[200:203], v1, s[4:7], s23 offen offset:0
    buffer_load_dwordx4 a[204:207], v1, s[4:7], s23 offen offset:1024
    s_add_u32 s23, s22, 247808
    buffer_load_dwordx4 a[208:211], v1, s[4:7], s23 offen offset:0
    buffer_load_dwordx4 a[212:215], v1, s[4:7], s23 offen offset:1024
    s_add_u32 s23, s22, 249856
    buffer_load_dwordx4 a[216:219], v1, s[4:7], s23 offen offset:0
    buffer_load_dwordx4 a[220:223], v1, s[4:7], s23 offen offset:1024
    s_waitcnt vmcnt(40)
    s_add_u32 s23, s22, 266240
    buffer_load_dwordx4 a[224:227], v1, s[4:7], s23 offen offset:0
    buffer_load_dwordx4 a[228:231], v1, s[4:7], s23 offen offset:1024
    s_add_u32 s23, s22, 268288
    buffer_load_dwordx4 a[232:235], v1, s[4:7], s23 offen offset:0
    buffer_load_dwordx4 a[236:239], v1, s[4:7], s23 offen offset:1024
    s_add_u32 s23, s22, 270336
    buffer_load_dwordx4 a[240:243], v1, s[4:7], s23 offen offset:0
    buffer_load_dwordx4 a[244:247], v1, s[4:7], s23 offen offset:1024
    s_add_u32 s23, s22, 258048
    buffer_load_dwordx4 a[248:251], v1, s[4:7], s23 offen offset:0
    buffer_load_dwordx4 a[252:255], v1, s[4:7], s23 offen offset:1024
    s_add_u32 s23, s22, 260096
    buffer_load_dwordx4 v[120:123], v1, s[4:7], s23 offen offset:0
    buffer_load_dwordx4 v[124:127], v1, s[4:7], s23 offen offset:1024
    s_add_u32 s23, s22, 262144
    buffer_load_dwordx4 v[128:131], v1, s[4:7], s23 offen offset:0
    buffer_load_dwordx4 v[132:135], v1, s[4:7], s23 offen offset:1024
    s_add_u32 s23, s22, 264192
    buffer_load_dwordx4 v[136:139], v1, s[4:7], s23 offen offset:0
    buffer_load_dwordx4 v[140:143], v1, s[4:7], s23 offen offset:1024
    s_waitcnt vmcnt(40)
    s_add_u32 s23, s22, 280576
    buffer_load_dwordx4 v[144:147], v1, s[4:7], s23 offen offset:0
    buffer_load_dwordx4 v[148:151], v1, s[4:7], s23 offen offset:1024
    s_add_u32 s23, s22, 282624
    buffer_load_dwordx4 v[152:155], v1, s[4:7], s23 offen offset:0
    buffer_load_dwordx4 v[156:159], v1, s[4:7], s23 offen offset:1024
    s_add_u32 s23, s22, 284672
    buffer_load_dwordx4 v[160:163], v1, s[4:7], s23 offen offset:0
    buffer_load_dwordx4 v[164:167], v1, s[4:7], s23 offen offset:1024
    s_add_u32 s23, s22, 272384
    buffer_load_dwordx4 v[168:171], v1, s[4:7], s23 offen offset:0
    buffer_load_dwordx4 v[172:175], v1, s[4:7], s23 offen offset:1024
    s_add_u32 s23, s22, 274432
    buffer_load_dwordx4 v[176:179], v1, s[4:7], s23 offen offset:0
    buffer_load_dwordx4 v[180:183], v1, s[4:7], s23 offen offset:1024
    s_add_u32 s23, s22, 276480
    buffer_load_dwordx4 v[184:187], v1, s[4:7], s23 offen offset:0
    buffer_load_dwordx4 v[188:191], v1, s[4:7], s23 offen offset:1024
    s_add_u32 s23, s22, 278528
    buffer_load_dwordx4 v[192:195], v1, s[4:7], s23 offen offset:0
    buffer_load_dwordx4 v[196:199], v1, s[4:7], s23 offen offset:1024
    s_waitcnt vmcnt(40)
    s_add_u32 s23, s22, 294912
    buffer_load_dwordx4 v[200:203], v1, s[4:7], s23 offen offset:0
    buffer_load_dwordx4 v[204:207], v1, s[4:7], s23 offen offset:1024
    s_add_u32 s23, s22, 296960
    buffer_load_dwordx4 v[208:211], v1, s[4:7], s23 offen offset:0
    buffer_load_dwordx4 v[212:215], v1, s[4:7], s23 offen offset:1024
    s_add_u32 s23, s22, 299008
    buffer_load_dwordx4 v[216:219], v1, s[4:7], s23 offen offset:0
    buffer_load_dwordx4 v[220:223], v1, s[4:7], s23 offen offset:1024
    s_add_u32 s23, s22, 286720
    buffer_load_dwordx4 v[224:227], v1, s[4:7], s23 offen offset:0
    buffer_load_dwordx4 v[228:231], v1, s[4:7], s23 offen offset:1024
    s_add_u32 s23, s22, 288768
    buffer_load_dwordx4 v[232:235], v1, s[4:7], s23 offen offset:0
    buffer_load_dwordx4 v[236:239], v1, s[4:7], s23 offen offset:1024
    s_add_u32 s23, s22, 290816
    buffer_load_dwordx4 v[240:243], v1, s[4:7], s23 offen offset:0
    buffer_load_dwordx4 v[244:247], v1, s[4:7], s23 offen offset:1024
    s_add_u32 s23, s22, 292864
    buffer_load_dwordx4 v[248:251], v1, s[4:7], s23 offen offset:0
    buffer_load_dwordx4 v[252:255], v1, s[4:7], s23 offen offset:1024
    s_waitcnt vmcnt(40)
    s_cmp_lg_u32 s94, 0
    s_cbranch_scc1 Lvf_82
    v_and_b32 v45, 31, v0
    v_lshlrev_b32 v45, 2, v45
Lvf_81:
    buffer_load_dword v44, v45, s[12:15], 0 offen offset:128 sc1
    s_sub_u32 s19, s19, 1
    s_cbranch_scc1 main_kernel_exit
    s_waitcnt vmcnt(0)
    v_cmp_eq_u32 vcc, 0, v44
    s_cbranch_vccnz Lvf_81
    v_readfirstlane_b32 s94, v44
    s_nop 1
    v_cmp_ne_u32 vcc, s94, v44
    s_cbranch_vccnz main_kernel_census
Lvf_82:
    v_lshlrev_b32 v3, 4, v13
    v_lshl_add_u32 v3, v14, 2, v3
    v_add_u32 v3, 11520, v3
    v_mul_u32_u24 v4, 28, v14
    v_add_u32 v4, v4, v13
    v_lshlrev_b32 v4, 4, v4
    v_add_u32 v4, 11520, v4
    v_lshlrev_b32 v12, 1, v13
    v_add_u32 v12, s25, v12
    v_lshrrev_b32 v10, 4, v12
    v_lshlrev_b32 v10, 8, v10
    v_lshl_add_u32 v10, v14, 6, v10
    v_bfe_u32 v11, v12, 3, 1
    v_lshl_add_u32 v10, v11, 5, v10
    v_bfe_u32 v11, v12, 1, 2
    v_lshl_add_u32 v10, v11, 2, v10
    v_add_u32 v10, 0, v10
    v_mov_b32 v12, 0x80000000
    v_cmp_gt_u32 vcc, 14, v13
    s_nop 1
    v_cndmask_b32 v10, v12, v10, vcc
    v_cmp_gt_u32 vcc, 32, v0
    s_nop 1
    v_cndmask_b32 v7, v12, v1, vcc
    v_lshlrev_b32 v8, 3, v0
    v_mov_b32 v9, 0x80008000
    v_min_u32 v5, 13, v13
    v_mul_u32_u24 v6, 14, v14
    v_add_lshl_u32 v5, v5, v6, 4
    s_mul_i32 s25, s24, 28672
    s_add_u32 s30, s25, 12859392
    s_add_u32 s31, s30, 3584
    s_mov_b32 s26, 42217472
    s_mov_b32 s35, 42252288
    s_mov_b32 s39, 48346112
    s_mov_b32 s36, 45318144
    s_cmp_eq_u32 s24, 0
    s_cselect_b32 s22, 0, 0x80000000
    s_cmp_eq_u32 s24, 1
    s_cselect_b32 s23, 0, 0x80000000
    v_or_b32 v6, s22, v1
    v_or_b32 v12, s23, v1
    s_waitcnt vmcnt(0)
    v_mov_b32 v44, 0
    v_mov_b32 v45, 0
    v_mov_b32 v46, 0
    v_mov_b32 v47, 0
    v_mov_b32 v48, 0
    v_mov_b32 v49, 0
    v_mov_b32 v50, 0
    v_mov_b32 v51, 0
    v_mov_b32 v52, 0
    v_mov_b32 v53, 0
    v_mov_b32 v54, 0
    v_mov_b32 v55, 0
    v_mov_b32 v56, 0
    v_mov_b32 v57, 0
    v_mov_b32 v58, 0
    v_mov_b32 v59, 0
    v_mov_b32 v60, 0
    v_mov_b32 v61, 0
    v_mov_b32 v62, 0
    v_mov_b32 v63, 0
    v_mov_b32 v64, 0
    v_mov_b32 v65, 0
    v_mov_b32 v66, 0
    v_mov_b32 v67, 0
    v_mov_b32 v68, 0
    v_mov_b32 v69, 0
    v_mov_b32 v70, 0
    v_mov_b32 v71, 0
    v_mov_b32 v16, -1
    v_mov_b32 v17, -1
    v_mov_b32 v18, 0
    ds_write_b64 v8, v[16:17] offset:16896
    ds_write_b64 v8, v[16:17] offset:18944
    v_lshrrev_b32 v13, 1, v8
    ds_write_b32 v13, v18 offset:13312
    s_waitcnt lgkmcnt(0)
    v_mov_b32 v108, 0
    v_mov_b32 v109, 0
    v_mov_b32 v110, 0
    v_mov_b32 v111, 0
    v_mov_b32 v116, 0
    v_mov_b32 v117, 0
    v_mov_b32 v118, 0
    v_mov_b32 v119, 0
    buffer_load_dwordx4 v[16:19], v1, s[4:7], s20 offen sc1
    buffer_load_dwordx4 v[20:23], v1, s[4:7], s21 offen sc1
LB_83:
    s_branch Lok_87
Lpm_86:
    buffer_load_dwordx4 v[16:19], v1, s[4:7], s20 offen sc1
    buffer_load_dwordx4 v[20:23], v1, s[4:7], s21 offen sc1
    s_sub_u32 s19, s19, 1
    s_cbranch_scc1 main_kernel_exit
    s_nop 2
    v_mov_b32 v44, 0
    v_mov_b32 v45, 0
    v_mov_b32 v46, 0
    v_mov_b32 v47, 0
    v_mov_b32 v48, 0
    v_mov_b32 v49, 0
    v_mov_b32 v50, 0
    v_mov_b32 v51, 0
Lok_87:
    s_waitcnt vmcnt(1)
    v_max3_u32 v13, v16, v17, v18
    s_waitcnt vmcnt(0)
    v_max3_u32 v15, v20, v21, v22
    v_max3_u32 v13, v19, v23, v13
    v_smfmac_f32_16x16x64_bf16 v[44:47], v[16:19], a[0:7], v2
    v_max_u32 v13, v13, v15
    v_cmp_eq_u32 vcc, -1, v13
    v_smfmac_f32_16x16x64_bf16 v[48:51], v[16:19], a[56:63], v2
    ds_write_b128 v1, v[16:19] offset:4096
    s_cbranch_vccnz Lpm_86
    v_smfmac_f32_16x16x64_bf16 v[52:55], v[16:19], a[112:119], v2
    v_smfmac_f32_16x16x64_bf16 v[56:59], v[16:19], a[168:175], v2
    v_smfmac_f32_16x16x64_bf16 v[60:63], v[16:19], a[224:231], v2
    ds_write_b128 v1, v[20:23] offset:5120
    v_smfmac_f32_16x16x64_bf16 v[64:67], v[16:19], v[144:151], v2
    v_smfmac_f32_16x16x64_bf16 v[68:71], v[16:19], v[200:207], v2
    v_smfmac_f32_16x16x64_bf16 v[44:47], v[20:23], a[8:15], v2
    v_smfmac_f32_16x16x64_bf16 v[48:51], v[20:23], a[64:71], v2
    s_waitcnt lgkmcnt(0)
    s_barrier
    ds_read_b128 v[24:27], v1 offset:6144
    s_bitcmp1_b64 s[82:83], s18
    s_cbranch_scc0 Lfw_84
Lfb_85:
    v_smfmac_f32_16x16x64_bf16 v[52:55], v[20:23], a[120:127], v2
    ds_read_b128 v[28:31], v1 offset:0
    buffer_load_dwordx4 v[72:75], v5, s[4:7], s30 offen offset:0 sc1
    v_smfmac_f32_16x16x64_bf16 v[56:59], v[20:23], a[176:183], v2
    ds_read_b128 v[32:35], v1 offset:1024
    v_smfmac_f32_16x16x64_bf16 v[60:63], v[20:23], a[232:239], v2
    ds_read_b128 v[36:39], v1 offset:2048
    buffer_load_dwordx4 v[80:83], v5, s[4:7], s30 offen offset:896 sc1
    v_smfmac_f32_16x16x64_bf16 v[64:67], v[20:23], v[152:159], v2
    ds_read_b128 v[40:43], v1 offset:3072
    v_smfmac_f32_16x16x64_bf16 v[68:71], v[20:23], v[208:215], v2
    buffer_load_dwordx4 v[76:79], v5, s[4:7], s30 offen offset:1792 sc1
    s_waitcnt lgkmcnt(0)
    v_smfmac_f32_16x16x64_bf16 v[44:47], v[24:27], a[16:23], v2
    s_add_u32 s20, s20, 47104
    v_smfmac_f32_16x16x64_bf16 v[44:47], v[28:31], a[24:31], v2
    buffer_load_dwordx4 v[84:87], v5, s[4:7], s30 offen offset:2688 sc1
    s_add_u32 s21, s21, 47104
    v_smfmac_f32_16x16x64_bf16 v[44:47], v[32:35], a[32:39], v2
    s_cmp_gt_u32 s24, 1
    s_cbranch_scc1 Lpub_88
    buffer_store_dwordx4 v[16:19], v6, s[4:7], s36 offen sc1
    buffer_store_dwordx4 v[20:23], v12, s[4:7], s36 offen offset:1024 sc1
Lpub_88:
    s_add_u32 s18, s18, 1
    v_smfmac_f32_16x16x64_bf16 v[44:47], v[36:39], a[40:47], v2
    buffer_load_dwordx4 v[88:91], v5, s[4:7], s31 offen offset:0 sc1
    s_add_u32 s36, s36, 48128
    v_smfmac_f32_16x16x64_bf16 v[44:47], v[40:43], a[48:55], v2
    s_add_u32 s38, s38, 47104
    v_smfmac_f32_16x16x64_bf16 v[48:51], v[24:27], a[72:79], v2
    ds_read_b128 v[16:19], v1 offset:24064
    buffer_load_dwordx4 v[96:99], v5, s[4:7], s31 offen offset:896 sc1
    v_smfmac_f32_16x16x64_bf16 v[48:51], v[28:31], a[80:87], v2
    ds_read_b128 v[20:23], v1 offset:24064
    v_smfmac_f32_16x16x64_bf16 v[48:51], v[32:35], a[88:95], v2
    v_add_f32 v44, v44, v46
    buffer_load_dwordx4 v[92:95], v5, s[4:7], s31 offen offset:1792 sc1
    v_smfmac_f32_16x16x64_bf16 v[48:51], v[36:39], a[96:103], v2
    v_add_f32 v45, v45, v47
    v_smfmac_f32_16x16x64_bf16 v[48:51], v[40:43], a[104:111], v2
    v_cvt_pk_bf16_f32 v44, v44, v45
    buffer_load_dwordx4 v[100:103], v5, s[4:7], s31 offen offset:2688 sc1
    v_smfmac_f32_16x16x64_bf16 v[52:55], v[24:27], a[128:135], v2
    ds_write_b32 v3, v44 offset:0
    v_smfmac_f32_16x16x64_bf16 v[52:55], v[28:31], a[136:143], v2
    v_smfmac_f32_16x16x64_bf16 v[52:55], v[32:35], a[144:151], v2
    v_add_f32 v48, v48, v50
    v_smfmac_f32_16x16x64_bf16 v[52:55], v[36:39], a[152:159], v2
    v_add_f32 v49, v49, v51
    v_smfmac_f32_16x16x64_bf16 v[52:55], v[40:43], a[160:167], v2
    v_cvt_pk_bf16_f32 v48, v48, v49
    v_smfmac_f32_16x16x64_bf16 v[56:59], v[24:27], a[184:191], v2
    ds_write_b32 v3, v48 offset:256
    v_smfmac_f32_16x16x64_bf16 v[56:59], v[28:31], a[192:199], v2
    v_smfmac_f32_16x16x64_bf16 v[56:59], v[32:35], a[200:207], v2
    v_add_f32 v52, v52, v54
    v_smfmac_f32_16x16x64_bf16 v[56:59], v[36:39], a[208:215], v2
    v_add_f32 v53, v53, v55
    v_smfmac_f32_16x16x64_bf16 v[56:59], v[40:43], a[216:223], v2
    v_cvt_pk_bf16_f32 v52, v52, v53
    v_smfmac_f32_16x16x64_bf16 v[60:63], v[24:27], a[240:247], v2
    ds_write_b32 v3, v52 offset:512
    v_smfmac_f32_16x16x64_bf16 v[60:63], v[28:31], a[248:255], v2
    v_smfmac_f32_16x16x64_bf16 v[60:63], v[32:35], v[120:127], v2
    v_add_f32 v56, v56, v58
    v_smfmac_f32_16x16x64_bf16 v[60:63], v[36:39], v[128:135], v2
    v_add_f32 v57, v57, v59
    v_smfmac_f32_16x16x64_bf16 v[60:63], v[40:43], v[136:143], v2
    v_cvt_pk_bf16_f32 v56, v56, v57
    v_smfmac_f32_16x16x64_bf16 v[64:67], v[24:27], v[160:167], v2
    ds_write_b32 v3, v56 offset:768
    v_smfmac_f32_16x16x64_bf16 v[64:67], v[28:31], v[168:175], v2
    v_smfmac_f32_16x16x64_bf16 v[64:67], v[32:35], v[176:183], v2
    v_add_f32 v60, v60, v62
    v_smfmac_f32_16x16x64_bf16 v[64:67], v[36:39], v[184:191], v2
    v_add_f32 v61, v61, v63
    v_smfmac_f32_16x16x64_bf16 v[64:67], v[40:43], v[192:199], v2
    v_cvt_pk_bf16_f32 v60, v60, v61
    v_smfmac_f32_16x16x64_bf16 v[68:71], v[24:27], v[216:223], v2
    ds_write_b32 v3, v60 offset:1024
    v_smfmac_f32_16x16x64_bf16 v[68:71], v[28:31], v[224:231], v2
    v_lshrrev_b32 v14, 2, v1
    buffer_load_dword v15, v14, s[4:7], s84 offen sc1
    v_smfmac_f32_16x16x64_bf16 v[68:71], v[32:35], v[232:239], v2
    v_add_f32 v64, v64, v66
    v_smfmac_f32_16x16x64_bf16 v[68:71], v[36:39], v[240:247], v2
    v_add_f32 v65, v65, v67
    v_smfmac_f32_16x16x64_bf16 v[68:71], v[40:43], v[248:255], v2
    v_cvt_pk_bf16_f32 v64, v64, v65
    ds_write_b32 v3, v64 offset:1280
    s_nop 7
    v_add_f32 v68, v68, v70
    v_add_f32 v69, v69, v71
    v_cvt_pk_bf16_f32 v68, v68, v69
    ds_write_b32 v3, v68 offset:1536
    ds_read_b128 v[104:107], v4
    ds_read_b128 v[112:115], v4 offset:224
    s_add_u32 s30, s30, 458752
    s_add_u32 s31, s31, 458752
    s_waitcnt lgkmcnt(0)
    s_nop 11
    v_mov_b32 v44, 0
    s_nop 1
    v_mov_b32 v45, 0
    s_nop 1
    v_mov_b32 v46, 0
    s_nop 1
    v_mov_b32 v47, 0
    s_nop 1
    v_mov_b32 v48, 0
    s_nop 1
    v_mov_b32 v49, 0
    s_nop 1
    v_mov_b32 v50, 0
    s_nop 1
    v_mov_b32 v51, 0
    s_nop 1
    v_mov_b32 v52, 0
    s_nop 1
    v_mov_b32 v53, 0
    s_nop 1
    v_mov_b32 v54, 0
    s_nop 1
    v_mov_b32 v55, 0
    s_nop 1
    v_mov_b32 v56, 0
    s_nop 1
    v_mov_b32 v57, 0
    s_nop 1
    buffer_load_dwordx4 v[24:27], v1, s[4:7], s26 offen sc1
    buffer_load_dwordx4 v[28:31], v1, s[4:7], s26 offen offset:1024 sc1
    buffer_load_dwordx4 v[32:35], v7, s[4:7], s26 offen offset:2048 sc1
    v_mov_b32 v58, 0
    s_nop 1
    v_mov_b32 v59, 0
    s_nop 1
    v_mov_b32 v60, 0
    s_nop 1
    v_mov_b32 v61, 0
    s_nop 1
    v_mov_b32 v62, 0
    s_nop 1
    v_mov_b32 v63, 0
    s_nop 1
    v_mov_b32 v64, 0
    s_nop 1
    v_mov_b32 v65, 0
    s_nop 1
    v_mov_b32 v66, 0
    s_nop 1
    v_mov_b32 v67, 0
    s_nop 1
    buffer_load_dwordx4 v[24:27], v1, s[4:7], s26 offen sc1
    buffer_load_dwordx4 v[28:31], v1, s[4:7], s26 offen offset:1024 sc1
    buffer_load_dwordx4 v[32:35], v7, s[4:7], s26 offen offset:2048 sc1
    v_mov_b32 v68, 0
    s_nop 1
    v_mov_b32 v69, 0
    s_nop 1
    v_mov_b32 v70, 0
    s_nop 1
    v_mov_b32 v71, 0
    s_nop 1
    s_branch Lok_90
Lpp_89:
    buffer_load_dwordx4 v[24:27], v1, s[4:7], s26 offen sc1
    buffer_load_dwordx4 v[28:31], v1, s[4:7], s26 offen offset:1024 sc1
    buffer_load_dwordx4 v[32:35], v7, s[4:7], s26 offen offset:2048 sc1
    s_sub_u32 s19, s19, 1
    s_cbranch_scc1 main_kernel_exit
    s_nop 2
    v_mov_b32 v16, 0
    v_mov_b32 v17, 0
    v_mov_b32 v18, 0
    v_mov_b32 v19, 0
Lok_90:
    s_waitcnt vmcnt(5)
    v_or3_b32 v13, v24, v25, v26
    s_waitcnt vmcnt(4)
    v_or3_b32 v14, v28, v29, v30
    v_or3_b32 v13, v13, v27, v31
    v_smfmac_f32_16x16x64_bf16 v[16:19], v[24:27], v[72:79], v2
    s_waitcnt vmcnt(3)
    v_or3_b32 v14, v14, v32, v33
    v_or3_b32 v13, v13, v34, v35
    v_smfmac_f32_16x16x64_bf16 v[16:19], v[28:31], v[88:95], v2
    v_bitop3_b32 v13, v13, v14, v9 bitop3:0xa8
    v_cmp_ne_u32 vcc, 0, v13
    v_smfmac_f32_16x16x64_bf16 v[16:19], v[32:35], v[104:111], v2
    s_cbranch_vccnz Lpp_89
    v_smfmac_f32_16x16x64_bf16 v[20:23], v[24:27], v[80:87], v2
    v_smfmac_f32_16x16x64_bf16 v[20:23], v[28:31], v[96:103], v2
    v_smfmac_f32_16x16x64_bf16 v[20:23], v[32:35], v[112:119], v2
    v_add_f32 v72, v16, v18
    v_add_f32 v74, v17, v19
    s_cmp_eq_u32 s37, 1
    s_nop 4
    v_add_f32 v73, v20, v22
    v_add_f32 v75, v21, v23
    ds_write_b64 v8, v[72:73] offset:16896
    ds_write_b64 v8, v[74:75] offset:18944
    s_barrier
    s_sleep 1
    s_nop 7
    v_cmp_ne_u32 s[82:83], 0, v15
    s_cmp_ge_u32 s18, 63
    s_cbranch_scc1 Llast_93
    s_add_u32 s35, s35, 47104
    s_add_u32 s26, s26, 47104
    s_sleep 3
    s_nop 3
    buffer_load_dwordx4 v[16:19], v1, s[4:7], s20 offen sc1
    buffer_load_dwordx4 v[20:23], v1, s[4:7], s21 offen sc1
    s_branch LB_83
Lfw_84:
    v_lshrrev_b32 v14, 2, v1
    buffer_load_dword v13, v14, s[4:7], s84 offen sc1
    s_waitcnt vmcnt(0)
    v_cmp_ne_u32 s[82:83], 0, v13
    s_nop 0
    s_bitcmp1_b64 s[82:83], s18
    s_cbranch_scc1 Lfb_85
    s_sub_u32 s19, s19, 1
    s_cbranch_scc1 main_kernel_exit
    s_sleep 2
    s_branch Lfw_84
Llast_93:
    s_branch main_kernel_exit
.p2align 6
LteamB3_10:
    v_lshlrev_b32 v1, 4, v0
    v_mov_b32 v2, 0x44444444
    v_mov_b32 v13, 0xeeeeeeee
    v_and_b32 v14, 2, v0
    v_cmp_ne_u32 vcc, 0, v14
    s_nop 1
    v_cndmask_b32 v2, v2, v13, vcc
    v_mov_b32 v13, 0
    v_lshlrev_b32 v14, 2, v0
    ds_write_b32 v14, v13 offset:24832
    s_mov_b32 s18, 0
    s_mov_b32 s34, 42222592
    s_mov_b64 s[82:83], 0
    s_and_b32 s84, s17, 15
    s_lshl_b32 s84, s84, 8
    s_add_u32 s84, s84, 54767616
    s_mov_b32 s20, 42211328
    s_mov_b32 s21, 42205184
    s_sub_u32 s24, s17, 16
    s_mul_i32 s25, s24, 28
    v_and_b32 v13, 15, v0
    v_lshrrev_b32 v14, 4, v0
    s_mul_i32 s22, s24, 401408
    s_add_u32 s22, s22, 6422528
    s_add_u32 s23, s22, 313344
    buffer_load_dwordx4 a[0:3], v1, s[4:7], s23 offen offset:0
    buffer_load_dwordx4 a[4:7], v1, s[4:7], s23 offen offset:1024
    s_add_u32 s23, s22, 301056
    buffer_load_dwordx4 a[8:11], v1, s[4:7], s23 offen offset:0
    buffer_load_dwordx4 a[12:15], v1, s[4:7], s23 offen offset:1024
    s_add_u32 s23, s22, 303104
    buffer_load_dwordx4 a[16:19], v1, s[4:7], s23 offen offset:0
    buffer_load_dwordx4 a[20:23], v1, s[4:7], s23 offen offset:1024
    s_add_u32 s23, s22, 305152
    buffer_load_dwordx4 a[24:27], v1, s[4:7], s23 offen offset:0
    buffer_load_dwordx4 a[28:31], v1, s[4:7], s23 offen offset:1024
    s_add_u32 s23, s22, 307200
    buffer_load_dwordx4 a[32:35], v1, s[4:7], s23 offen offset:0
    buffer_load_dwordx4 a[36:39], v1, s[4:7], s23 offen offset:1024
    s_add_u32 s23, s22, 309248
    buffer_load_dwordx4 a[40:43], v1, s[4:7], s23 offen offset:0
    buffer_load_dwordx4 a[44:47], v1, s[4:7], s23 offen offset:1024
    s_add_u32 s23, s22, 311296
    buffer_load_dwordx4 a[48:51], v1, s[4:7], s23 offen offset:0
    buffer_load_dwordx4 a[52:55], v1, s[4:7], s23 offen offset:1024
    s_add_u32 s23, s22, 327680
    buffer_load_dwordx4 a[56:59], v1, s[4:7], s23 offen offset:0
    buffer_load_dwordx4 a[60:63], v1, s[4:7], s23 offen offset:1024
    s_add_u32 s23, s22, 315392
    buffer_load_dwordx4 a[64:67], v1, s[4:7], s23 offen offset:0
    buffer_load_dwordx4 a[68:71], v1, s[4:7], s23 offen offset:1024
    s_add_u32 s23, s22, 317440
    buffer_load_dwordx4 a[72:75], v1, s[4:7], s23 offen offset:0
    buffer_load_dwordx4 a[76:79], v1, s[4:7], s23 offen offset:1024
    s_add_u32 s23, s22, 319488
    buffer_load_dwordx4 a[80:83], v1, s[4:7], s23 offen offset:0
    buffer_load_dwordx4 a[84:87], v1, s[4:7], s23 offen offset:1024
    s_add_u32 s23, s22, 321536
    buffer_load_dwordx4 a[88:91], v1, s[4:7], s23 offen offset:0
    buffer_load_dwordx4 a[92:95], v1, s[4:7], s23 offen offset:1024
    s_add_u32 s23, s22, 323584
    buffer_load_dwordx4 a[96:99], v1, s[4:7], s23 offen offset:0
    buffer_load_dwordx4 a[100:103], v1, s[4:7], s23 offen offset:1024
    s_add_u32 s23, s22, 325632
    buffer_load_dwordx4 a[104:107], v1, s[4:7], s23 offen offset:0
    buffer_load_dwordx4 a[108:111], v1, s[4:7], s23 offen offset:1024
    s_add_u32 s23, s22, 342016
    buffer_load_dwordx4 a[112:115], v1, s[4:7], s23 offen offset:0
    buffer_load_dwordx4 a[116:119], v1, s[4:7], s23 offen offset:1024
    s_add_u32 s23, s22, 329728
    buffer_load_dwordx4 a[120:123], v1, s[4:7], s23 offen offset:0
    buffer_load_dwordx4 a[124:127], v1, s[4:7], s23 offen offset:1024
    s_add_u32 s23, s22, 331776
    buffer_load_dwordx4 a[128:131], v1, s[4:7], s23 offen offset:0
    buffer_load_dwordx4 a[132:135], v1, s[4:7], s23 offen offset:1024
    s_add_u32 s23, s22, 333824
    buffer_load_dwordx4 a[136:139], v1, s[4:7], s23 offen offset:0
    buffer_load_dwordx4 a[140:143], v1, s[4:7], s23 offen offset:1024
    s_add_u32 s23, s22, 335872
    buffer_load_dwordx4 a[144:147], v1, s[4:7], s23 offen offset:0
    buffer_load_dwordx4 a[148:151], v1, s[4:7], s23 offen offset:1024
    s_add_u32 s23, s22, 337920
    buffer_load_dwordx4 a[152:155], v1, s[4:7], s23 offen offset:0
    buffer_load_dwordx4 a[156:159], v1, s[4:7], s23 offen offset:1024
    s_add_u32 s23, s22, 339968
    buffer_load_dwordx4 a[160:163], v1, s[4:7], s23 offen offset:0
    buffer_load_dwordx4 a[164:167], v1, s[4:7], s23 offen offset:1024
    s_waitcnt vmcnt(40)
    s_add_u32 s23, s22, 356352
    buffer_load_dwordx4 a[168:171], v1, s[4:7], s23 offen offset:0
    buffer_load_dwordx4 a[172:175], v1, s[4:7], s23 offen offset:1024
    s_add_u32 s23, s22, 344064
    buffer_load_dwordx4 a[176:179], v1, s[4:7], s23 offen offset:0
    buffer_load_dwordx4 a[180:183], v1, s[4:7], s23 offen offset:1024
    s_add_u32 s23, s22, 346112
    buffer_load_dwordx4 a[184:187], v1, s[4:7], s23 offen offset:0
    buffer_load_dwordx4 a[188:191], v1, s[4:7], s23 offen offset:1024
    s_add_u32 s23, s22, 348160
    buffer_load_dwordx4 a[192:195], v1, s[4:7], s23 offen offset:0
    buffer_load_dwordx4 a[196:199], v1, s[4:7], s23 offen offset:1024
    s_add_u32 s23, s22, 350208
    buffer_load_dwordx4 a[200:203], v1, s[4:7], s23 offen offset:0
    buffer_load_dwordx4 a[204:207], v1, s[4:7], s23 offen offset:1024
    s_add_u32 s23, s22, 352256
    buffer_load_dwordx4 a[208:211], v1, s[4:7], s23 offen offset:0
    buffer_load_dwordx4 a[212:215], v1, s[4:7], s23 offen offset:1024
    s_add_u32 s23, s22, 354304
    buffer_load_dwordx4 a[216:219], v1, s[4:7], s23 offen offset:0
    buffer_load_dwordx4 a[220:223], v1, s[4:7], s23 offen offset:1024
    s_waitcnt vmcnt(40)
    s_add_u32 s23, s22, 370688
    buffer_load_dwordx4 a[224:227], v1, s[4:7], s23 offen offset:0
    buffer_load_dwordx4 a[228:231], v1, s[4:7], s23 offen offset:1024
    s_add_u32 s23, s22, 358400
    buffer_load_dwordx4 a[232:235], v1, s[4:7], s23 offen offset:0
    buffer_load_dwordx4 a[236:239], v1, s[4:7], s23 offen offset:1024
    s_add_u32 s23, s22, 360448
    buffer_load_dwordx4 a[240:243], v1, s[4:7], s23 offen offset:0
    buffer_load_dwordx4 a[244:247], v1, s[4:7], s23 offen offset:1024
    s_add_u32 s23, s22, 362496
    buffer_load_dwordx4 a[248:251], v1, s[4:7], s23 offen offset:0
    buffer_load_dwordx4 a[252:255], v1, s[4:7], s23 offen offset:1024
    s_add_u32 s23, s22, 364544
    buffer_load_dwordx4 v[120:123], v1, s[4:7], s23 offen offset:0
    buffer_load_dwordx4 v[124:127], v1, s[4:7], s23 offen offset:1024
    s_add_u32 s23, s22, 366592
    buffer_load_dwordx4 v[128:131], v1, s[4:7], s23 offen offset:0
    buffer_load_dwordx4 v[132:135], v1, s[4:7], s23 offen offset:1024
    s_add_u32 s23, s22, 368640
    buffer_load_dwordx4 v[136:139], v1, s[4:7], s23 offen offset:0
    buffer_load_dwordx4 v[140:143], v1, s[4:7], s23 offen offset:1024
    s_waitcnt vmcnt(40)
    s_add_u32 s23, s22, 385024
    buffer_load_dwordx4 v[144:147], v1, s[4:7], s23 offen offset:0
    buffer_load_dwordx4 v[148:151], v1, s[4:7], s23 offen offset:1024
    s_add_u32 s23, s22, 372736
    buffer_load_dwordx4 v[152:155], v1, s[4:7], s23 offen offset:0
    buffer_load_dwordx4 v[156:159], v1, s[4:7], s23 offen offset:1024
    s_add_u32 s23, s22, 374784
    buffer_load_dwordx4 v[160:163], v1, s[4:7], s23 offen offset:0
    buffer_load_dwordx4 v[164:167], v1, s[4:7], s23 offen offset:1024
    s_add_u32 s23, s22, 376832
    buffer_load_dwordx4 v[168:171], v1, s[4:7], s23 offen offset:0
    buffer_load_dwordx4 v[172:175], v1, s[4:7], s23 offen offset:1024
    s_add_u32 s23, s22, 378880
    buffer_load_dwordx4 v[176:179], v1, s[4:7], s23 offen offset:0
    buffer_load_dwordx4 v[180:183], v1, s[4:7], s23 offen offset:1024
    s_add_u32 s23, s22, 380928
    buffer_load_dwordx4 v[184:187], v1, s[4:7], s23 offen offset:0
    buffer_load_dwordx4 v[188:191], v1, s[4:7], s23 offen offset:1024
    s_add_u32 s23, s22, 382976
    buffer_load_dwordx4 v[192:195], v1, s[4:7], s23 offen offset:0
    buffer_load_dwordx4 v[196:199], v1, s[4:7], s23 offen offset:1024
    s_waitcnt vmcnt(40)
    s_add_u32 s23, s22, 399360
    buffer_load_dwordx4 v[200:203], v1, s[4:7], s23 offen offset:0
    buffer_load_dwordx4 v[204:207], v1, s[4:7], s23 offen offset:1024
    s_add_u32 s23, s22, 387072
    buffer_load_dwordx4 v[208:211], v1, s[4:7], s23 offen offset:0
    buffer_load_dwordx4 v[212:215], v1, s[4:7], s23 offen offset:1024
    s_add_u32 s23, s22, 389120
    buffer_load_dwordx4 v[216:219], v1, s[4:7], s23 offen offset:0
    buffer_load_dwordx4 v[220:223], v1, s[4:7], s23 offen offset:1024
    s_add_u32 s23, s22, 391168
    buffer_load_dwordx4 v[224:227], v1, s[4:7], s23 offen offset:0
    buffer_load_dwordx4 v[228:231], v1, s[4:7], s23 offen offset:1024
    s_add_u32 s23, s22, 393216
    buffer_load_dwordx4 v[232:235], v1, s[4:7], s23 offen offset:0
    buffer_load_dwordx4 v[236:239], v1, s[4:7], s23 offen offset:1024
    s_add_u32 s23, s22, 395264
    buffer_load_dwordx4 v[240:243], v1, s[4:7], s23 offen offset:0
    buffer_load_dwordx4 v[244:247], v1, s[4:7], s23 offen offset:1024
    s_add_u32 s23, s22, 397312
    buffer_load_dwordx4 v[248:251], v1, s[4:7], s23 offen offset:0
    buffer_load_dwordx4 v[252:255], v1, s[4:7], s23 offen offset:1024
    s_waitcnt vmcnt(40)
    s_cmp_lg_u32 s94, 0
    s_cbranch_scc1 Lvf_95
    v_and_b32 v45, 31, v0
    v_lshlrev_b32 v45, 2, v45
Lvf_94:
    buffer_load_dword v44, v45, s[12:15], 0 offen offset:128 sc1
    s_sub_u32 s19, s19, 1
    s_cbranch_scc1 main_kernel_exit
    s_waitcnt vmcnt(0)
    v_cmp_eq_u32 vcc, 0, v44
    s_cbranch_vccnz Lvf_94
    v_readfirstlane_b32 s94, v44
    s_nop 1
    v_cmp_ne_u32 vcc, s94, v44
    s_cbranch_vccnz main_kernel_census
Lvf_95:
    v_lshlrev_b32 v3, 4, v13
    v_lshl_add_u32 v3, v14, 2, v3
    v_add_u32 v3, 13568, v3
    v_mul_u32_u24 v4, 28, v14
    v_add_u32 v4, v4, v13
    v_lshlrev_b32 v4, 4, v4
    v_add_u32 v4, 13568, v4
    v_lshlrev_b32 v12, 1, v13
    v_add_u32 v12, s25, v12
    v_lshrrev_b32 v10, 4, v12
    v_lshlrev_b32 v10, 8, v10
    v_lshl_add_u32 v10, v14, 6, v10
    v_bfe_u32 v11, v12, 3, 1
    v_lshl_add_u32 v10, v11, 5, v10
    v_bfe_u32 v11, v12, 1, 2
    v_lshl_add_u32 v10, v11, 2, v10
    v_add_u32 v10, 16, v10
    v_mov_b32 v12, 0x80000000
    v_cmp_gt_u32 vcc, 14, v13
    s_nop 1
    v_cndmask_b32 v10, v12, v10, vcc
    v_cmp_gt_u32 vcc, 32, v0
    s_nop 1
    v_cndmask_b32 v7, v12, v1, vcc
    v_lshlrev_b32 v8, 3, v0
    v_mov_b32 v9, 0x80008000
    v_min_u32 v5, 13, v13
    v_mul_u32_u24 v6, 14, v14
    v_add_lshl_u32 v5, v5, v6, 4
    s_mul_i32 s25, s24, 28672
    s_add_u32 s30, s25, 12866560
    s_add_u32 s31, s30, 3584
    s_mov_b32 s26, 42220032
    s_mov_b32 s35, 42252288
    s_mov_b32 s39, 48346112
    s_mov_b32 s36, 45320192
    s_cmp_eq_u32 s24, 0
    s_cselect_b32 s22, 0, 0x80000000
    s_cmp_eq_u32 s24, 99
    s_cselect_b32 s23, 0, 0x80000000
    v_or_b32 v6, s22, v1
    v_or_b32 v12, s23, v1
    s_waitcnt vmcnt(0)
    v_mov_b32 v44, 0
    v_mov_b32 v45, 0
    v_mov_b32 v46, 0
    v_mov_b32 v47, 0
    v_mov_b32 v48, 0
    v_mov_b32 v49, 0
    v_mov_b32 v50, 0
    v_mov_b32 v51, 0
    v_mov_b32 v52, 0
    v_mov_b32 v53, 0
    v_mov_b32 v54, 0
    v_mov_b32 v55, 0
    v_mov_b32 v56, 0
    v_mov_b32 v57, 0
    v_mov_b32 v58, 0
    v_mov_b32 v59, 0
    v_mov_b32 v60, 0
    v_mov_b32 v61, 0
    v_mov_b32 v62, 0
    v_mov_b32 v63, 0
    v_mov_b32 v64, 0
    v_mov_b32 v65, 0
    v_mov_b32 v66, 0
    v_mov_b32 v67, 0
    v_mov_b32 v68, 0
    v_mov_b32 v69, 0
    v_mov_b32 v70, 0
    v_mov_b32 v71, 0
    v_mov_b32 v16, -1
    v_mov_b32 v17, -1
    v_mov_b32 v18, 0
    ds_write_b64 v8, v[16:17] offset:17408
    ds_write_b64 v8, v[16:17] offset:19456
    v_lshrrev_b32 v13, 1, v8
    ds_write_b32 v13, v18 offset:15360
    s_waitcnt lgkmcnt(0)
    v_mov_b32 v108, 0
    v_mov_b32 v109, 0
    v_mov_b32 v110, 0
    v_mov_b32 v111, 0
    v_mov_b32 v116, 0
    v_mov_b32 v117, 0
    v_mov_b32 v118, 0
    v_mov_b32 v119, 0
    buffer_load_dwordx4 v[16:19], v1, s[4:7], s20 offen sc1
    buffer_load_dwordx4 v[20:23], v1, s[4:7], s21 offen sc1
LB_96:
    s_branch Lok_100
Lpm_99:
    buffer_load_dwordx4 v[16:19], v1, s[4:7], s20 offen sc1
    buffer_load_dwordx4 v[20:23], v1, s[4:7], s21 offen sc1
    s_sub_u32 s19, s19, 1
    s_cbranch_scc1 main_kernel_exit
    s_nop 2
    v_mov_b32 v44, 0
    v_mov_b32 v45, 0
    v_mov_b32 v46, 0
    v_mov_b32 v47, 0
    v_mov_b32 v48, 0
    v_mov_b32 v49, 0
    v_mov_b32 v50, 0
    v_mov_b32 v51, 0
Lok_100:
    s_waitcnt vmcnt(1)
    v_max3_u32 v13, v16, v17, v18
    s_waitcnt vmcnt(0)
    v_max3_u32 v15, v20, v21, v22
    v_max3_u32 v13, v19, v23, v13
    v_smfmac_f32_16x16x64_bf16 v[44:47], v[16:19], a[0:7], v2
    v_max_u32 v13, v13, v15
    v_cmp_eq_u32 vcc, -1, v13
    v_smfmac_f32_16x16x64_bf16 v[48:51], v[16:19], a[56:63], v2
    ds_write_b128 v1, v[16:19] offset:6144
    s_cbranch_vccnz Lpm_99
    v_smfmac_f32_16x16x64_bf16 v[52:55], v[16:19], a[112:119], v2
    v_smfmac_f32_16x16x64_bf16 v[56:59], v[16:19], a[168:175], v2
    v_smfmac_f32_16x16x64_bf16 v[60:63], v[16:19], a[224:231], v2
    v_smfmac_f32_16x16x64_bf16 v[64:67], v[16:19], v[144:151], v2
    v_smfmac_f32_16x16x64_bf16 v[68:71], v[16:19], v[200:207], v2
    v_smfmac_f32_16x16x64_bf16 v[44:47], v[20:23], a[8:15], v2
    v_smfmac_f32_16x16x64_bf16 v[48:51], v[20:23], a[64:71], v2
    s_waitcnt lgkmcnt(0)
    s_barrier
    ds_read_b128 v[24:27], v1 offset:1024
    s_bitcmp1_b64 s[82:83], s18
    s_cbranch_scc0 Lfw_97
Lfb_98:
    v_smfmac_f32_16x16x64_bf16 v[52:55], v[20:23], a[120:127], v2
    ds_read_b128 v[28:31], v1 offset:2048
    buffer_load_dwordx4 v[72:75], v5, s[4:7], s30 offen offset:0 sc1
    v_smfmac_f32_16x16x64_bf16 v[56:59], v[20:23], a[176:183], v2
    ds_read_b128 v[32:35], v1 offset:3072
    v_smfmac_f32_16x16x64_bf16 v[60:63], v[20:23], a[232:239], v2
    ds_read_b128 v[36:39], v1 offset:4096
    buffer_load_dwordx4 v[80:83], v5, s[4:7], s30 offen offset:896 sc1
    v_smfmac_f32_16x16x64_bf16 v[64:67], v[20:23], v[152:159], v2
    ds_read_b128 v[40:43], v1 offset:5120
    v_smfmac_f32_16x16x64_bf16 v[68:71], v[20:23], v[208:215], v2
    buffer_load_dwordx4 v[76:79], v5, s[4:7], s30 offen offset:1792 sc1
    s_waitcnt lgkmcnt(0)
    v_smfmac_f32_16x16x64_bf16 v[44:47], v[24:27], a[16:23], v2
    s_add_u32 s20, s20, 47104
    v_smfmac_f32_16x16x64_bf16 v[44:47], v[28:31], a[24:31], v2
    buffer_load_dwordx4 v[84:87], v5, s[4:7], s30 offen offset:2688 sc1
    s_add_u32 s21, s21, 47104
    v_smfmac_f32_16x16x64_bf16 v[44:47], v[32:35], a[32:39], v2
    s_cmp_gt_u32 s24, 1
    s_cbranch_scc1 Lpub_101
    buffer_store_dwordx4 v[16:19], v6, s[4:7], s36 offen sc1
    buffer_store_dwordx4 v[20:23], v12, s[4:7], s36 offen offset:1024 sc1
Lpub_101:
    s_add_u32 s18, s18, 1
    v_smfmac_f32_16x16x64_bf16 v[44:47], v[36:39], a[40:47], v2
    buffer_load_dwordx4 v[88:91], v5, s[4:7], s31 offen offset:0 sc1
    s_add_u32 s36, s36, 48128
    v_smfmac_f32_16x16x64_bf16 v[44:47], v[40:43], a[48:55], v2
    s_add_u32 s38, s38, 47104
    v_smfmac_f32_16x16x64_bf16 v[48:51], v[24:27], a[72:79], v2
    ds_read_b128 v[16:19], v1 offset:24064
    buffer_load_dwordx4 v[96:99], v5, s[4:7], s31 offen offset:896 sc1
    v_smfmac_f32_16x16x64_bf16 v[48:51], v[28:31], a[80:87], v2
    ds_read_b128 v[20:23], v1 offset:24064
    v_smfmac_f32_16x16x64_bf16 v[48:51], v[32:35], a[88:95], v2
    v_add_f32 v44, v44, v46
    buffer_load_dwordx4 v[92:95], v5, s[4:7], s31 offen offset:1792 sc1
    v_smfmac_f32_16x16x64_bf16 v[48:51], v[36:39], a[96:103], v2
    v_add_f32 v45, v45, v47
    v_smfmac_f32_16x16x64_bf16 v[48:51], v[40:43], a[104:111], v2
    v_cvt_pk_bf16_f32 v44, v44, v45
    buffer_load_dwordx4 v[100:103], v5, s[4:7], s31 offen offset:2688 sc1
    v_smfmac_f32_16x16x64_bf16 v[52:55], v[24:27], a[128:135], v2
    ds_write_b32 v3, v44 offset:0
    v_smfmac_f32_16x16x64_bf16 v[52:55], v[28:31], a[136:143], v2
    v_smfmac_f32_16x16x64_bf16 v[52:55], v[32:35], a[144:151], v2
    v_add_f32 v48, v48, v50
    v_smfmac_f32_16x16x64_bf16 v[52:55], v[36:39], a[152:159], v2
    v_add_f32 v49, v49, v51
    v_smfmac_f32_16x16x64_bf16 v[52:55], v[40:43], a[160:167], v2
    v_cvt_pk_bf16_f32 v48, v48, v49
    v_smfmac_f32_16x16x64_bf16 v[56:59], v[24:27], a[184:191], v2
    ds_write_b32 v3, v48 offset:256
    v_smfmac_f32_16x16x64_bf16 v[56:59], v[28:31], a[192:199], v2
    v_smfmac_f32_16x16x64_bf16 v[56:59], v[32:35], a[200:207], v2
    v_add_f32 v52, v52, v54
    v_smfmac_f32_16x16x64_bf16 v[56:59], v[36:39], a[208:215], v2
    v_add_f32 v53, v53, v55
    v_smfmac_f32_16x16x64_bf16 v[56:59], v[40:43], a[216:223], v2
    v_cvt_pk_bf16_f32 v52, v52, v53
    v_smfmac_f32_16x16x64_bf16 v[60:63], v[24:27], a[240:247], v2
    ds_write_b32 v3, v52 offset:512
    v_smfmac_f32_16x16x64_bf16 v[60:63], v[28:31], a[248:255], v2
    v_smfmac_f32_16x16x64_bf16 v[60:63], v[32:35], v[120:127], v2
    v_add_f32 v56, v56, v58
    v_smfmac_f32_16x16x64_bf16 v[60:63], v[36:39], v[128:135], v2
    v_add_f32 v57, v57, v59
    v_smfmac_f32_16x16x64_bf16 v[60:63], v[40:43], v[136:143], v2
    v_cvt_pk_bf16_f32 v56, v56, v57
    v_smfmac_f32_16x16x64_bf16 v[64:67], v[24:27], v[160:167], v2
    ds_write_b32 v3, v56 offset:768
    v_smfmac_f32_16x16x64_bf16 v[64:67], v[28:31], v[168:175], v2
    v_smfmac_f32_16x16x64_bf16 v[64:67], v[32:35], v[176:183], v2
    v_add_f32 v60, v60, v62
    v_smfmac_f32_16x16x64_bf16 v[64:67], v[36:39], v[184:191], v2
    v_add_f32 v61, v61, v63
    v_smfmac_f32_16x16x64_bf16 v[64:67], v[40:43], v[192:199], v2
    v_cvt_pk_bf16_f32 v60, v60, v61
    v_smfmac_f32_16x16x64_bf16 v[68:71], v[24:27], v[216:223], v2
    ds_write_b32 v3, v60 offset:1024
    v_smfmac_f32_16x16x64_bf16 v[68:71], v[28:31], v[224:231], v2
    v_lshrrev_b32 v14, 2, v1
    buffer_load_dword v15, v14, s[4:7], s84 offen sc1
    v_smfmac_f32_16x16x64_bf16 v[68:71], v[32:35], v[232:239], v2
    v_add_f32 v64, v64, v66
    v_smfmac_f32_16x16x64_bf16 v[68:71], v[36:39], v[240:247], v2
    v_add_f32 v65, v65, v67
    v_smfmac_f32_16x16x64_bf16 v[68:71], v[40:43], v[248:255], v2
    v_cvt_pk_bf16_f32 v64, v64, v65
    ds_write_b32 v3, v64 offset:1280
    s_nop 7
    v_add_f32 v68, v68, v70
    v_add_f32 v69, v69, v71
    v_cvt_pk_bf16_f32 v68, v68, v69
    ds_write_b32 v3, v68 offset:1536
    ds_read_b128 v[104:107], v4
    ds_read_b128 v[112:115], v4 offset:224
    s_add_u32 s30, s30, 458752
    s_add_u32 s31, s31, 458752
    s_waitcnt lgkmcnt(0)
    s_nop 11
    v_mov_b32 v44, 0
    s_nop 1
    v_mov_b32 v45, 0
    s_nop 1
    v_mov_b32 v46, 0
    s_nop 1
    v_mov_b32 v47, 0
    s_nop 1
    v_mov_b32 v48, 0
    s_nop 1
    v_mov_b32 v49, 0
    s_nop 1
    v_mov_b32 v50, 0
    s_nop 1
    v_mov_b32 v51, 0
    s_nop 1
    v_mov_b32 v52, 0
    s_nop 1
    v_mov_b32 v53, 0
    s_nop 1
    v_mov_b32 v54, 0
    s_nop 1
    v_mov_b32 v55, 0
    s_nop 1
    v_mov_b32 v56, 0
    s_nop 1
    v_mov_b32 v57, 0
    s_nop 1
    buffer_load_dwordx4 v[24:27], v1, s[4:7], s26 offen sc1
    buffer_load_dwordx4 v[28:31], v1, s[4:7], s26 offen offset:1024 sc1
    buffer_load_dwordx4 v[32:35], v7, s[4:7], s26 offen offset:2048 sc1
    v_mov_b32 v58, 0
    s_nop 1
    v_mov_b32 v59, 0
    s_nop 1
    v_mov_b32 v60, 0
    s_nop 1
    v_mov_b32 v61, 0
    s_nop 1
    v_mov_b32 v62, 0
    s_nop 1
    v_mov_b32 v63, 0
    s_nop 1
    v_mov_b32 v64, 0
    s_nop 1
    v_mov_b32 v65, 0
    s_nop 1
    v_mov_b32 v66, 0
    s_nop 1
    v_mov_b32 v67, 0
    s_nop 1
    buffer_load_dwordx4 v[24:27], v1, s[4:7], s26 offen sc1
    buffer_load_dwordx4 v[28:31], v1, s[4:7], s26 offen offset:1024 sc1
    buffer_load_dwordx4 v[32:35], v7, s[4:7], s26 offen offset:2048 sc1
    v_mov_b32 v68, 0
    s_nop 1
    v_mov_b32 v69, 0
    s_nop 1
    v_mov_b32 v70, 0
    s_nop 1
    v_mov_b32 v71, 0
    s_nop 1
    s_branch Lok_103
Lpp_102:
    buffer_load_dwordx4 v[24:27], v1, s[4:7], s26 offen sc1
    buffer_load_dwordx4 v[28:31], v1, s[4:7], s26 offen offset:1024 sc1
    buffer_load_dwordx4 v[32:35], v7, s[4:7], s26 offen offset:2048 sc1
    s_sub_u32 s19, s19, 1
    s_cbranch_scc1 main_kernel_exit
    s_nop 2
    v_mov_b32 v16, 0
    v_mov_b32 v17, 0
    v_mov_b32 v18, 0
    v_mov_b32 v19, 0
Lok_103:
    s_waitcnt vmcnt(5)
    v_or3_b32 v13, v24, v25, v26
    s_waitcnt vmcnt(4)
    v_or3_b32 v14, v28, v29, v30
    v_or3_b32 v13, v13, v27, v31
    v_smfmac_f32_16x16x64_bf16 v[16:19], v[24:27], v[72:79], v2
    s_waitcnt vmcnt(3)
    v_or3_b32 v14, v14, v32, v33
    v_or3_b32 v13, v13, v34, v35
    v_smfmac_f32_16x16x64_bf16 v[16:19], v[28:31], v[88:95], v2
    v_bitop3_b32 v13, v13, v14, v9 bitop3:0xa8
    v_cmp_ne_u32 vcc, 0, v13
    v_smfmac_f32_16x16x64_bf16 v[16:19], v[32:35], v[104:111], v2
    s_cbranch_vccnz Lpp_102
    v_smfmac_f32_16x16x64_bf16 v[20:23], v[24:27], v[80:87], v2
    v_smfmac_f32_16x16x64_bf16 v[20:23], v[28:31], v[96:103], v2
    v_smfmac_f32_16x16x64_bf16 v[20:23], v[32:35], v[112:119], v2
    v_add_f32 v72, v16, v18
    v_add_f32 v74, v17, v19
    s_cmp_eq_u32 s37, 1
    s_nop 4
    v_add_f32 v73, v20, v22
    v_add_f32 v75, v21, v23
    ds_write_b64 v8, v[72:73] offset:17408
    ds_write_b64 v8, v[74:75] offset:19456
    s_barrier
    s_sleep 1
    s_nop 7
    v_cmp_ne_u32 s[82:83], 0, v15
    s_cmp_ge_u32 s18, 63
    s_cbranch_scc1 Llast_106
    s_add_u32 s35, s35, 47104
    s_add_u32 s26, s26, 47104
    s_sleep 3
    s_nop 3
    buffer_load_dwordx4 v[16:19], v1, s[4:7], s20 offen sc1
    buffer_load_dwordx4 v[20:23], v1, s[4:7], s21 offen sc1
    s_branch LB_96
Lfw_97:
    v_lshrrev_b32 v14, 2, v1
    buffer_load_dword v13, v14, s[4:7], s84 offen sc1
    s_waitcnt vmcnt(0)
    v_cmp_ne_u32 s[82:83], 0, v13
    s_nop 0
    s_bitcmp1_b64 s[82:83], s18
    s_cbranch_scc1 Lfb_98
    s_sub_u32 s19, s19, 1
    s_cbranch_scc1 main_kernel_exit
    s_sleep 2
    s_branch Lfw_97
Llast_106:
    s_branch main_kernel_exit
.p2align 6
main_kernel_w:
    s_sub_u32 s22, s22, 32
    s_cmp_ge_u32 s22, 192
    s_cbranch_scc1 main_kernel_hg
    s_mul_i32 s23, s22, 10923
    s_lshr_b32 s23, s23, 16
    s_mul_i32 s24, s23, 6
    s_sub_u32 s18, s22, s24
    s_and_b32 s17, s23, 15
    s_cmp_ge_u32 s23, 16
    s_cbranch_scc1 main_kernel_ta
    v_lshlrev_b32 v1, 4, v0
    v_and_b32 v3, 15, v0
    v_lshrrev_b32 v4, 4, v0
    s_mov_b32 s20, s18
    s_mul_i32 s24, s20, 28672
    s_add_u32 s24, s24, 48402432
    s_add_u32 s25, s24, 14336
    buffer_load_dwordx4 v[72:75], v1, s[4:7], s24 offen offset:0
    buffer_load_dwordx4 v[76:79], v1, s[4:7], s25 offen offset:0
    buffer_load_dwordx4 v[80:83], v1, s[4:7], s24 offen offset:1024
    buffer_load_dwordx4 v[84:87], v1, s[4:7], s25 offen offset:1024
    buffer_load_dwordx4 v[88:91], v1, s[4:7], s24 offen offset:2048
    buffer_load_dwordx4 v[92:95], v1, s[4:7], s25 offen offset:2048
    s_mul_i32 s22, s17, 401408
    s_mul_i32 s23, s16, 100352
    s_add_u32 s22, s22, s23
    s_add_u32 s22, s22, 6422528
    buffer_load_dwordx4 a[0:3], v1, s[4:7], s22 offen offset:0
    buffer_load_dwordx4 a[4:7], v1, s[4:7], s22 offen offset:1024
    s_add_u32 s22, s22, 2048
    buffer_load_dwordx4 a[8:11], v1, s[4:7], s22 offen offset:0
    buffer_load_dwordx4 a[12:15], v1, s[4:7], s22 offen offset:1024
    s_add_u32 s22, s22, 2048
    buffer_load_dwordx4 a[16:19], v1, s[4:7], s22 offen offset:0
    buffer_load_dwordx4 a[20:23], v1, s[4:7], s22 offen offset:1024
    s_add_u32 s22, s22, 2048
    buffer_load_dwordx4 a[24:27], v1, s[4:7], s22 offen offset:0
    buffer_load_dwordx4 a[28:31], v1, s[4:7], s22 offen offset:1024
    s_add_u32 s22, s22, 2048
    buffer_load_dwordx4 a[32:35], v1, s[4:7], s22 offen offset:0
    buffer_load_dwordx4 a[36:39], v1, s[4:7], s22 offen offset:1024
    s_add_u32 s22, s22, 2048
    buffer_load_dwordx4 a[40:43], v1, s[4:7], s22 offen offset:0
    buffer_load_dwordx4 a[44:47], v1, s[4:7], s22 offen offset:1024
    s_add_u32 s22, s22, 2048
    buffer_load_dwordx4 a[48:51], v1, s[4:7], s22 offen offset:0
    buffer_load_dwordx4 a[52:55], v1, s[4:7], s22 offen offset:1024
    s_add_u32 s22, s22, 2048
    buffer_load_dwordx4 a[56:59], v1, s[4:7], s22 offen offset:0
    buffer_load_dwordx4 a[60:63], v1, s[4:7], s22 offen offset:1024
    s_add_u32 s22, s22, 2048
    buffer_load_dwordx4 a[64:67], v1, s[4:7], s22 offen offset:0
    buffer_load_dwordx4 a[68:71], v1, s[4:7], s22 offen offset:1024
    s_add_u32 s22, s22, 2048
    buffer_load_dwordx4 a[72:75], v1, s[4:7], s22 offen offset:0
    buffer_load_dwordx4 a[76:79], v1, s[4:7], s22 offen offset:1024
    s_add_u32 s22, s22, 2048
    buffer_load_dwordx4 a[80:83], v1, s[4:7], s22 offen offset:0
    buffer_load_dwordx4 a[84:87], v1, s[4:7], s22 offen offset:1024
    s_add_u32 s22, s22, 2048
    buffer_load_dwordx4 a[88:91], v1, s[4:7], s22 offen offset:0
    buffer_load_dwordx4 a[92:95], v1, s[4:7], s22 offen offset:1024
    s_add_u32 s22, s22, 2048
    buffer_load_dwordx4 a[96:99], v1, s[4:7], s22 offen offset:0
    buffer_load_dwordx4 a[100:103], v1, s[4:7], s22 offen offset:1024
    s_add_u32 s22, s22, 2048
    buffer_load_dwordx4 a[104:107], v1, s[4:7], s22 offen offset:0
    buffer_load_dwordx4 a[108:111], v1, s[4:7], s22 offen offset:1024
    s_add_u32 s22, s22, 2048
    buffer_load_dwordx4 a[112:115], v1, s[4:7], s22 offen offset:0
    buffer_load_dwordx4 a[116:119], v1, s[4:7], s22 offen offset:1024
    s_add_u32 s22, s22, 2048
    buffer_load_dwordx4 a[120:123], v1, s[4:7], s22 offen offset:0
    buffer_load_dwordx4 a[124:127], v1, s[4:7], s22 offen offset:1024
    s_add_u32 s22, s22, 2048
    buffer_load_dwordx4 a[128:131], v1, s[4:7], s22 offen offset:0
    buffer_load_dwordx4 a[132:135], v1, s[4:7], s22 offen offset:1024
    s_add_u32 s22, s22, 2048
    buffer_load_dwordx4 a[136:139], v1, s[4:7], s22 offen offset:0
    buffer_load_dwordx4 a[140:143], v1, s[4:7], s22 offen offset:1024
    s_add_u32 s22, s22, 2048
    buffer_load_dwordx4 a[144:147], v1, s[4:7], s22 offen offset:0
    buffer_load_dwordx4 a[148:151], v1, s[4:7], s22 offen offset:1024
    s_add_u32 s22, s22, 2048
    buffer_load_dwordx4 a[152:155], v1, s[4:7], s22 offen offset:0
    buffer_load_dwordx4 a[156:159], v1, s[4:7], s22 offen offset:1024
    s_add_u32 s22, s22, 2048
    buffer_load_dwordx4 a[160:163], v1, s[4:7], s22 offen offset:0
    buffer_load_dwordx4 a[164:167], v1, s[4:7], s22 offen offset:1024
    s_add_u32 s22, s22, 2048
    s_waitcnt vmcnt(40)
    buffer_load_dwordx4 a[168:171], v1, s[4:7], s22 offen offset:0
    buffer_load_dwordx4 a[172:175], v1, s[4:7], s22 offen offset:1024
    s_add_u32 s22, s22, 2048
    buffer_load_dwordx4 a[176:179], v1, s[4:7], s22 offen offset:0
    buffer_load_dwordx4 a[180:183], v1, s[4:7], s22 offen offset:1024
    s_add_u32 s22, s22, 2048
    buffer_load_dwordx4 a[184:187], v1, s[4:7], s22 offen offset:0
    buffer_load_dwordx4 a[188:191], v1, s[4:7], s22 offen offset:1024
    s_add_u32 s22, s22, 2048
    buffer_load_dwordx4 a[192:195], v1, s[4:7], s22 offen offset:0
    buffer_load_dwordx4 a[196:199], v1, s[4:7], s22 offen offset:1024
    s_add_u32 s22, s22, 2048
    buffer_load_dwordx4 a[200:203], v1, s[4:7], s22 offen offset:0
    buffer_load_dwordx4 a[204:207], v1, s[4:7], s22 offen offset:1024
    s_add_u32 s22, s22, 2048
    buffer_load_dwordx4 a[208:211], v1, s[4:7], s22 offen offset:0
    buffer_load_dwordx4 a[212:215], v1, s[4:7], s22 offen offset:1024
    s_add_u32 s22, s22, 2048
    buffer_load_dwordx4 a[216:219], v1, s[4:7], s22 offen offset:0
    buffer_load_dwordx4 a[220:223], v1, s[4:7], s22 offen offset:1024
    s_add_u32 s22, s22, 2048
    s_waitcnt vmcnt(40)
    buffer_load_dwordx4 a[224:227], v1, s[4:7], s22 offen offset:0
    buffer_load_dwordx4 a[228:231], v1, s[4:7], s22 offen offset:1024
    s_add_u32 s22, s22, 2048
    buffer_load_dwordx4 a[232:235], v1, s[4:7], s22 offen offset:0
    buffer_load_dwordx4 a[236:239], v1, s[4:7], s22 offen offset:1024
    s_add_u32 s22, s22, 2048
    buffer_load_dwordx4 a[240:243], v1, s[4:7], s22 offen offset:0
    buffer_load_dwordx4 a[244:247], v1, s[4:7], s22 offen offset:1024
    s_add_u32 s22, s22, 2048
    buffer_load_dwordx4 a[248:251], v1, s[4:7], s22 offen offset:0
    buffer_load_dwordx4 a[252:255], v1, s[4:7], s22 offen offset:1024
    s_add_u32 s22, s22, 2048
    buffer_load_dwordx4 v[120:123], v1, s[4:7], s22 offen offset:0
    buffer_load_dwordx4 v[124:127], v1, s[4:7], s22 offen offset:1024
    s_add_u32 s22, s22, 2048
    buffer_load_dwordx4 v[128:131], v1, s[4:7], s22 offen offset:0
    buffer_load_dwordx4 v[132:135], v1, s[4:7], s22 offen offset:1024
    s_add_u32 s22, s22, 2048
    buffer_load_dwordx4 v[136:139], v1, s[4:7], s22 offen offset:0
    buffer_load_dwordx4 v[140:143], v1, s[4:7], s22 offen offset:1024
    s_add_u32 s22, s22, 2048
    s_waitcnt vmcnt(40)
    buffer_load_dwordx4 v[144:147], v1, s[4:7], s22 offen offset:0
    buffer_load_dwordx4 v[148:151], v1, s[4:7], s22 offen offset:1024
    s_add_u32 s22, s22, 2048
    buffer_load_dwordx4 v[152:155], v1, s[4:7], s22 offen offset:0
    buffer_load_dwordx4 v[156:159], v1, s[4:7], s22 offen offset:1024
    s_add_u32 s22, s22, 2048
    buffer_load_dwordx4 v[160:163], v1, s[4:7], s22 offen offset:0
    buffer_load_dwordx4 v[164:167], v1, s[4:7], s22 offen offset:1024
    s_add_u32 s22, s22, 2048
    buffer_load_dwordx4 v[168:171], v1, s[4:7], s22 offen offset:0
    buffer_load_dwordx4 v[172:175], v1, s[4:7], s22 offen offset:1024
    s_add_u32 s22, s22, 2048
    buffer_load_dwordx4 v[176:179], v1, s[4:7], s22 offen offset:0
    buffer_load_dwordx4 v[180:183], v1, s[4:7], s22 offen offset:1024
    s_add_u32 s22, s22, 2048
    buffer_load_dwordx4 v[184:187], v1, s[4:7], s22 offen offset:0
    buffer_load_dwordx4 v[188:191], v1, s[4:7], s22 offen offset:1024
    s_add_u32 s22, s22, 2048
    buffer_load_dwordx4 v[192:195], v1, s[4:7], s22 offen offset:0
    buffer_load_dwordx4 v[196:199], v1, s[4:7], s22 offen offset:1024
    s_add_u32 s22, s22, 2048
    s_waitcnt vmcnt(40)
    buffer_load_dwordx4 v[200:203], v1, s[4:7], s22 offen offset:0
    buffer_load_dwordx4 v[204:207], v1, s[4:7], s22 offen offset:1024
    s_add_u32 s22, s22, 2048
    buffer_load_dwordx4 v[208:211], v1, s[4:7], s22 offen offset:0
    buffer_load_dwordx4 v[212:215], v1, s[4:7], s22 offen offset:1024
    s_add_u32 s22, s22, 2048
    buffer_load_dwordx4 v[216:219], v1, s[4:7], s22 offen offset:0
    buffer_load_dwordx4 v[220:223], v1, s[4:7], s22 offen offset:1024
    s_add_u32 s22, s22, 2048
    buffer_load_dwordx4 v[224:227], v1, s[4:7], s22 offen offset:0
    buffer_load_dwordx4 v[228:231], v1, s[4:7], s22 offen offset:1024
    s_add_u32 s22, s22, 2048
    buffer_load_dwordx4 v[232:235], v1, s[4:7], s22 offen offset:0
    buffer_load_dwordx4 v[236:239], v1, s[4:7], s22 offen offset:1024
    s_add_u32 s22, s22, 2048
    buffer_load_dwordx4 v[240:243], v1, s[4:7], s22 offen offset:0
    buffer_load_dwordx4 v[244:247], v1, s[4:7], s22 offen offset:1024
    s_add_u32 s22, s22, 2048
    buffer_load_dwordx4 v[248:251], v1, s[4:7], s22 offen offset:0
    buffer_load_dwordx4 v[252:255], v1, s[4:7], s22 offen offset:1024
    s_add_u32 s22, s22, 2048
    s_waitcnt vmcnt(40)
    s_cmp_lg_u32 s94, 0
    s_cbranch_scc1 Lvf_108
    v_and_b32 v17, 31, v0
    v_lshlrev_b32 v17, 2, v17
Lvf_107:
    buffer_load_dword v16, v17, s[12:15], 0 offen offset:128 sc1
    s_sub_u32 s19, s19, 1
    s_cbranch_scc1 main_kernel_exit
    s_waitcnt vmcnt(0)
    v_cmp_eq_u32 vcc, 0, v16
    s_cbranch_vccnz Lvf_107
    v_readfirstlane_b32 s94, v16
    s_nop 1
    v_cmp_ne_u32 vcc, s94, v16
    s_cbranch_vccnz main_kernel_census
Lvf_108:
    s_lshl_b32 s26, s16, 13
    v_add_u32 v111, s26, v1
    v_add_u32 v5, 0, v3
    v_mul_u32_u24 v6, 4682, v5
    v_lshrrev_b32 v6, 16, v6
    v_mul_u32_u24 v7, 14, v6
    v_sub_u32 v5, v5, v7
    v_mul_u32_u24 v7, 14, v4
    v_add_lshl_u32 v5, v5, v7, 4
    v_mul_u32_u24 v6, 896, v6
    v_add3_u32 v104, v5, v6, s26
    v_add_u32 v5, 16, v3
    v_mul_u32_u24 v6, 4682, v5
    v_lshrrev_b32 v6, 16, v6
    v_mul_u32_u24 v7, 14, v6
    v_sub_u32 v5, v5, v7
    v_mul_u32_u24 v7, 14, v4
    v_add_lshl_u32 v5, v5, v7, 4
    v_mul_u32_u24 v6, 896, v6
    v_add3_u32 v105, v5, v6, s26
    v_add_u32 v5, 32, v3
    v_mul_u32_u24 v6, 4682, v5
    v_lshrrev_b32 v6, 16, v6
    v_mul_u32_u24 v7, 14, v6
    v_sub_u32 v5, v5, v7
    v_mul_u32_u24 v7, 14, v4
    v_add_lshl_u32 v5, v5, v7, 4
    v_mul_u32_u24 v6, 896, v6
    v_add3_u32 v106, v5, v6, s26
    v_add_u32 v5, 48, v3
    v_mul_u32_u24 v6, 4682, v5
    v_lshrrev_b32 v6, 16, v6
    v_mul_u32_u24 v7, 14, v6
    v_sub_u32 v5, v5, v7
    v_mul_u32_u24 v7, 14, v4
    v_add_lshl_u32 v5, v5, v7, 4
    v_mul_u32_u24 v6, 896, v6
    v_add3_u32 v107, v5, v6, s26
    v_add_u32 v5, 64, v3
    v_mul_u32_u24 v6, 4682, v5
    v_lshrrev_b32 v6, 16, v6
    v_mul_u32_u24 v7, 14, v6
    v_sub_u32 v5, v5, v7
    v_mul_u32_u24 v7, 14, v4
    v_add_lshl_u32 v5, v5, v7, 4
    v_mul_u32_u24 v6, 896, v6
    v_add3_u32 v108, v5, v6, s26
    v_add_u32 v5, 80, v3
    v_mul_u32_u24 v6, 4682, v5
    v_lshrrev_b32 v6, 16, v6
    v_mul_u32_u24 v7, 14, v6
    v_sub_u32 v5, v5, v7
    v_mul_u32_u24 v7, 14, v4
    v_add_lshl_u32 v5, v5, v7, 4
    v_mul_u32_u24 v6, 896, v6
    v_add3_u32 v109, v5, v6, s26
    v_add_u32 v5, 96, v3
    v_mul_u32_u24 v6, 4682, v5
    v_lshrrev_b32 v6, 16, v6
    v_mul_u32_u24 v7, 14, v6
    v_sub_u32 v5, v5, v7
    v_mul_u32_u24 v7, 14, v4
    v_add_lshl_u32 v5, v5, v7, 4
    v_mul_u32_u24 v6, 896, v6
    v_add3_u32 v110, v5, v6, s26
    s_mul_i32 s27, s17, 28672
    s_mul_i32 s23, s16, 7168
    s_add_u32 s27, s27, s23
    s_add_u32 s27, s27, 12845056
    s_mov_b32 s28, 48394240
    s_lshl_b32 s29, s17, 8
    s_add_u32 s29, s29, 54767616
    v_add_u32 v5, s16, v0
    v_cmp_eq_u32 vcc, 0, v5
    v_mov_b32 v7, 0x80000000
    v_mov_b32 v6, 1
    v_cndmask_b32 v5, v7, v5, vcc
    s_waitcnt vmcnt(0)
LW_109:
    buffer_load_dwordx4 v[96:99], v1, s[4:7], s24 offen offset:3072
    buffer_load_dwordx4 v[100:103], v1, s[4:7], s25 offen offset:3072
    s_waitcnt vmcnt(13)
    v_mfma_f32_16x16x32_bf16 v[16:19], v[72:75], a[0:3], 0
    v_mfma_f32_16x16x32_bf16 v[44:47], v[76:79], a[0:3], 0
    v_mfma_f32_16x16x32_bf16 v[20:23], v[72:75], a[56:59], 0
    v_mfma_f32_16x16x32_bf16 v[48:51], v[76:79], a[56:59], 0
    v_mfma_f32_16x16x32_bf16 v[24:27], v[72:75], a[112:115], 0
    v_mfma_f32_16x16x32_bf16 v[52:55], v[76:79], a[112:115], 0
    v_mfma_f32_16x16x32_bf16 v[28:31], v[72:75], a[168:171], 0
    v_mfma_f32_16x16x32_bf16 v[56:59], v[76:79], a[168:171], 0
    v_mfma_f32_16x16x32_bf16 v[32:35], v[72:75], a[224:227], 0
    v_mfma_f32_16x16x32_bf16 v[60:63], v[76:79], a[224:227], 0
    v_mfma_f32_16x16x32_bf16 v[36:39], v[72:75], v[144:147], 0
    v_mfma_f32_16x16x32_bf16 v[64:67], v[76:79], v[144:147], 0
    v_mfma_f32_16x16x32_bf16 v[40:43], v[72:75], v[200:203], 0
    v_mfma_f32_16x16x32_bf16 v[68:71], v[76:79], v[200:203], 0
    s_add_u32 s26, s24, 4096
    buffer_load_dwordx4 v[72:75], v1, s[4:7], s26 offen offset:0
    s_add_u32 s26, s25, 4096
    buffer_load_dwordx4 v[76:79], v1, s[4:7], s26 offen offset:0
    s_waitcnt vmcnt(13)
    v_mfma_f32_16x16x32_bf16 v[16:19], v[80:83], a[4:7], v[16:19]
    v_mfma_f32_16x16x32_bf16 v[44:47], v[84:87], a[4:7], v[44:47]
    v_mfma_f32_16x16x32_bf16 v[20:23], v[80:83], a[60:63], v[20:23]
    v_mfma_f32_16x16x32_bf16 v[48:51], v[84:87], a[60:63], v[48:51]
    v_mfma_f32_16x16x32_bf16 v[24:27], v[80:83], a[116:119], v[24:27]
    v_mfma_f32_16x16x32_bf16 v[52:55], v[84:87], a[116:119], v[52:55]
    v_mfma_f32_16x16x32_bf16 v[28:31], v[80:83], a[172:175], v[28:31]
    v_mfma_f32_16x16x32_bf16 v[56:59], v[84:87], a[172:175], v[56:59]
    v_mfma_f32_16x16x32_bf16 v[32:35], v[80:83], a[228:231], v[32:35]
    v_mfma_f32_16x16x32_bf16 v[60:63], v[84:87], a[228:231], v[60:63]
    v_mfma_f32_16x16x32_bf16 v[36:39], v[80:83], v[148:151], v[36:39]
    v_mfma_f32_16x16x32_bf16 v[64:67], v[84:87], v[148:151], v[64:67]
    v_mfma_f32_16x16x32_bf16 v[40:43], v[80:83], v[204:207], v[40:43]
    v_mfma_f32_16x16x32_bf16 v[68:71], v[84:87], v[204:207], v[68:71]
    s_add_u32 s26, s24, 4096
    buffer_load_dwordx4 v[80:83], v1, s[4:7], s26 offen offset:1024
    s_add_u32 s26, s25, 4096
    buffer_load_dwordx4 v[84:87], v1, s[4:7], s26 offen offset:1024
    s_waitcnt vmcnt(13)
    v_mfma_f32_16x16x32_bf16 v[16:19], v[88:91], a[8:11], v[16:19]
    v_mfma_f32_16x16x32_bf16 v[44:47], v[92:95], a[8:11], v[44:47]
    v_mfma_f32_16x16x32_bf16 v[20:23], v[88:91], a[64:67], v[20:23]
    v_mfma_f32_16x16x32_bf16 v[48:51], v[92:95], a[64:67], v[48:51]
    v_mfma_f32_16x16x32_bf16 v[24:27], v[88:91], a[120:123], v[24:27]
    v_mfma_f32_16x16x32_bf16 v[52:55], v[92:95], a[120:123], v[52:55]
    v_mfma_f32_16x16x32_bf16 v[28:31], v[88:91], a[176:179], v[28:31]
    v_mfma_f32_16x16x32_bf16 v[56:59], v[92:95], a[176:179], v[56:59]
    v_mfma_f32_16x16x32_bf16 v[32:35], v[88:91], a[232:235], v[32:35]
    v_mfma_f32_16x16x32_bf16 v[60:63], v[92:95], a[232:235], v[60:63]
    v_mfma_f32_16x16x32_bf16 v[36:39], v[88:91], v[152:155], v[36:39]
    v_mfma_f32_16x16x32_bf16 v[64:67], v[92:95], v[152:155], v[64:67]
    v_mfma_f32_16x16x32_bf16 v[40:43], v[88:91], v[208:211], v[40:43]
    v_mfma_f32_16x16x32_bf16 v[68:71], v[92:95], v[208:211], v[68:71]
    s_add_u32 s26, s24, 4096
    buffer_load_dwordx4 v[88:91], v1, s[4:7], s26 offen offset:2048
    s_add_u32 s26, s25, 4096
    buffer_load_dwordx4 v[92:95], v1, s[4:7], s26 offen offset:2048
    s_waitcnt vmcnt(6)
    s_barrier
    buffer_store_dword v6, v5, s[4:7], s28 offen sc1
    v_mfma_f32_16x16x32_bf16 v[16:19], v[96:99], a[12:15], v[16:19]
    v_mfma_f32_16x16x32_bf16 v[44:47], v[100:103], a[12:15], v[44:47]
    v_mfma_f32_16x16x32_bf16 v[20:23], v[96:99], a[68:71], v[20:23]
    v_mfma_f32_16x16x32_bf16 v[48:51], v[100:103], a[68:71], v[48:51]
    v_mfma_f32_16x16x32_bf16 v[24:27], v[96:99], a[124:127], v[24:27]
    v_mfma_f32_16x16x32_bf16 v[52:55], v[100:103], a[124:127], v[52:55]
    v_mfma_f32_16x16x32_bf16 v[28:31], v[96:99], a[180:183], v[28:31]
    v_mfma_f32_16x16x32_bf16 v[56:59], v[100:103], a[180:183], v[56:59]
    v_mfma_f32_16x16x32_bf16 v[32:35], v[96:99], a[236:239], v[32:35]
    v_mfma_f32_16x16x32_bf16 v[60:63], v[100:103], a[236:239], v[60:63]
    v_mfma_f32_16x16x32_bf16 v[36:39], v[96:99], v[156:159], v[36:39]
    v_mfma_f32_16x16x32_bf16 v[64:67], v[100:103], v[156:159], v[64:67]
    v_mfma_f32_16x16x32_bf16 v[40:43], v[96:99], v[212:215], v[40:43]
    v_mfma_f32_16x16x32_bf16 v[68:71], v[100:103], v[212:215], v[68:71]
    s_add_u32 s26, s24, 4096
    buffer_load_dwordx4 v[96:99], v1, s[4:7], s26 offen offset:3072
    s_add_u32 s26, s25, 4096
    buffer_load_dwordx4 v[100:103], v1, s[4:7], s26 offen offset:3072
    s_waitcnt vmcnt(6)
    v_mfma_f32_16x16x32_bf16 v[16:19], v[72:75], a[16:19], v[16:19]
    v_mfma_f32_16x16x32_bf16 v[44:47], v[76:79], a[16:19], v[44:47]
    v_mfma_f32_16x16x32_bf16 v[20:23], v[72:75], a[72:75], v[20:23]
    v_mfma_f32_16x16x32_bf16 v[48:51], v[76:79], a[72:75], v[48:51]
    v_mfma_f32_16x16x32_bf16 v[24:27], v[72:75], a[128:131], v[24:27]
    v_mfma_f32_16x16x32_bf16 v[52:55], v[76:79], a[128:131], v[52:55]
    v_mfma_f32_16x16x32_bf16 v[28:31], v[72:75], a[184:187], v[28:31]
    v_mfma_f32_16x16x32_bf16 v[56:59], v[76:79], a[184:187], v[56:59]
    v_mfma_f32_16x16x32_bf16 v[32:35], v[72:75], a[240:243], v[32:35]
    v_mfma_f32_16x16x32_bf16 v[60:63], v[76:79], a[240:243], v[60:63]
    v_mfma_f32_16x16x32_bf16 v[36:39], v[72:75], v[160:163], v[36:39]
    v_mfma_f32_16x16x32_bf16 v[64:67], v[76:79], v[160:163], v[64:67]
    v_mfma_f32_16x16x32_bf16 v[40:43], v[72:75], v[216:219], v[40:43]
    v_mfma_f32_16x16x32_bf16 v[68:71], v[76:79], v[216:219], v[68:71]
    s_add_u32 s26, s24, 8192
    buffer_load_dwordx4 v[72:75], v1, s[4:7], s26 offen offset:0
    s_add_u32 s26, s25, 8192
    buffer_load_dwordx4 v[76:79], v1, s[4:7], s26 offen offset:0
    s_waitcnt vmcnt(6)
    v_mfma_f32_16x16x32_bf16 v[16:19], v[80:83], a[20:23], v[16:19]
    v_mfma_f32_16x16x32_bf16 v[44:47], v[84:87], a[20:23], v[44:47]
    v_mfma_f32_16x16x32_bf16 v[20:23], v[80:83], a[76:79], v[20:23]
    v_mfma_f32_16x16x32_bf16 v[48:51], v[84:87], a[76:79], v[48:51]
    v_mfma_f32_16x16x32_bf16 v[24:27], v[80:83], a[132:135], v[24:27]
    v_mfma_f32_16x16x32_bf16 v[52:55], v[84:87], a[132:135], v[52:55]
    v_mfma_f32_16x16x32_bf16 v[28:31], v[80:83], a[188:191], v[28:31]
    v_mfma_f32_16x16x32_bf16 v[56:59], v[84:87], a[188:191], v[56:59]
    v_mfma_f32_16x16x32_bf16 v[32:35], v[80:83], a[244:247], v[32:35]
    v_mfma_f32_16x16x32_bf16 v[60:63], v[84:87], a[244:247], v[60:63]
    v_mfma_f32_16x16x32_bf16 v[36:39], v[80:83], v[164:167], v[36:39]
    v_mfma_f32_16x16x32_bf16 v[64:67], v[84:87], v[164:167], v[64:67]
    v_mfma_f32_16x16x32_bf16 v[40:43], v[80:83], v[220:223], v[40:43]
    v_mfma_f32_16x16x32_bf16 v[68:71], v[84:87], v[220:223], v[68:71]
    s_add_u32 s26, s24, 8192
    buffer_load_dwordx4 v[80:83], v1, s[4:7], s26 offen offset:1024
    s_add_u32 s26, s25, 8192
    buffer_load_dwordx4 v[84:87], v1, s[4:7], s26 offen offset:1024
    s_waitcnt vmcnt(6)
    v_mfma_f32_16x16x32_bf16 v[16:19], v[88:91], a[24:27], v[16:19]
    v_mfma_f32_16x16x32_bf16 v[44:47], v[92:95], a[24:27], v[44:47]
    v_mfma_f32_16x16x32_bf16 v[20:23], v[88:91], a[80:83], v[20:23]
    v_mfma_f32_16x16x32_bf16 v[48:51], v[92:95], a[80:83], v[48:51]
    v_mfma_f32_16x16x32_bf16 v[24:27], v[88:91], a[136:139], v[24:27]
    v_mfma_f32_16x16x32_bf16 v[52:55], v[92:95], a[136:139], v[52:55]
    v_mfma_f32_16x16x32_bf16 v[28:31], v[88:91], a[192:195], v[28:31]
    v_mfma_f32_16x16x32_bf16 v[56:59], v[92:95], a[192:195], v[56:59]
    v_mfma_f32_16x16x32_bf16 v[32:35], v[88:91], a[248:251], v[32:35]
    v_mfma_f32_16x16x32_bf16 v[60:63], v[92:95], a[248:251], v[60:63]
    v_mfma_f32_16x16x32_bf16 v[36:39], v[88:91], v[168:171], v[36:39]
    v_mfma_f32_16x16x32_bf16 v[64:67], v[92:95], v[168:171], v[64:67]
    v_mfma_f32_16x16x32_bf16 v[40:43], v[88:91], v[224:227], v[40:43]
    v_mfma_f32_16x16x32_bf16 v[68:71], v[92:95], v[224:227], v[68:71]
    s_add_u32 s26, s24, 8192
    buffer_load_dwordx4 v[88:91], v1, s[4:7], s26 offen offset:2048
    s_add_u32 s26, s25, 8192
    buffer_load_dwordx4 v[92:95], v1, s[4:7], s26 offen offset:2048
    s_waitcnt vmcnt(6)
    v_mfma_f32_16x16x32_bf16 v[16:19], v[96:99], a[28:31], v[16:19]
    v_mfma_f32_16x16x32_bf16 v[44:47], v[100:103], a[28:31], v[44:47]
    v_mfma_f32_16x16x32_bf16 v[20:23], v[96:99], a[84:87], v[20:23]
    v_mfma_f32_16x16x32_bf16 v[48:51], v[100:103], a[84:87], v[48:51]
    v_mfma_f32_16x16x32_bf16 v[24:27], v[96:99], a[140:143], v[24:27]
    v_mfma_f32_16x16x32_bf16 v[52:55], v[100:103], a[140:143], v[52:55]
    v_mfma_f32_16x16x32_bf16 v[28:31], v[96:99], a[196:199], v[28:31]
    v_mfma_f32_16x16x32_bf16 v[56:59], v[100:103], a[196:199], v[56:59]
    v_mfma_f32_16x16x32_bf16 v[32:35], v[96:99], a[252:255], v[32:35]
    v_mfma_f32_16x16x32_bf16 v[60:63], v[100:103], a[252:255], v[60:63]
    v_mfma_f32_16x16x32_bf16 v[36:39], v[96:99], v[172:175], v[36:39]
    v_mfma_f32_16x16x32_bf16 v[64:67], v[100:103], v[172:175], v[64:67]
    v_mfma_f32_16x16x32_bf16 v[40:43], v[96:99], v[228:231], v[40:43]
    v_mfma_f32_16x16x32_bf16 v[68:71], v[100:103], v[228:231], v[68:71]
    s_add_u32 s26, s24, 8192
    buffer_load_dwordx4 v[96:99], v1, s[4:7], s26 offen offset:3072
    s_add_u32 s26, s25, 8192
    buffer_load_dwordx4 v[100:103], v1, s[4:7], s26 offen offset:3072
    s_waitcnt vmcnt(6)
    v_mfma_f32_16x16x32_bf16 v[16:19], v[72:75], a[32:35], v[16:19]
    v_mfma_f32_16x16x32_bf16 v[44:47], v[76:79], a[32:35], v[44:47]
    v_mfma_f32_16x16x32_bf16 v[20:23], v[72:75], a[88:91], v[20:23]
    v_mfma_f32_16x16x32_bf16 v[48:51], v[76:79], a[88:91], v[48:51]
    v_mfma_f32_16x16x32_bf16 v[24:27], v[72:75], a[144:147], v[24:27]
    v_mfma_f32_16x16x32_bf16 v[52:55], v[76:79], a[144:147], v[52:55]
    v_mfma_f32_16x16x32_bf16 v[28:31], v[72:75], a[200:203], v[28:31]
    v_mfma_f32_16x16x32_bf16 v[56:59], v[76:79], a[200:203], v[56:59]
    v_mfma_f32_16x16x32_bf16 v[32:35], v[72:75], v[120:123], v[32:35]
    v_mfma_f32_16x16x32_bf16 v[60:63], v[76:79], v[120:123], v[60:63]
    v_mfma_f32_16x16x32_bf16 v[36:39], v[72:75], v[176:179], v[36:39]
    v_mfma_f32_16x16x32_bf16 v[64:67], v[76:79], v[176:179], v[64:67]
    v_mfma_f32_16x16x32_bf16 v[40:43], v[72:75], v[232:235], v[40:43]
    v_mfma_f32_16x16x32_bf16 v[68:71], v[76:79], v[232:235], v[68:71]
    s_add_u32 s26, s24, 12288
    buffer_load_dwordx4 v[72:75], v1, s[4:7], s26 offen offset:0
    s_add_u32 s26, s25, 12288
    buffer_load_dwordx4 v[76:79], v1, s[4:7], s26 offen offset:0
    s_waitcnt vmcnt(6)
    v_mfma_f32_16x16x32_bf16 v[16:19], v[80:83], a[36:39], v[16:19]
    v_mfma_f32_16x16x32_bf16 v[44:47], v[84:87], a[36:39], v[44:47]
    v_mfma_f32_16x16x32_bf16 v[20:23], v[80:83], a[92:95], v[20:23]
    v_mfma_f32_16x16x32_bf16 v[48:51], v[84:87], a[92:95], v[48:51]
    v_mfma_f32_16x16x32_bf16 v[24:27], v[80:83], a[148:151], v[24:27]
    v_mfma_f32_16x16x32_bf16 v[52:55], v[84:87], a[148:151], v[52:55]
    v_mfma_f32_16x16x32_bf16 v[28:31], v[80:83], a[204:207], v[28:31]
    v_mfma_f32_16x16x32_bf16 v[56:59], v[84:87], a[204:207], v[56:59]
    v_mfma_f32_16x16x32_bf16 v[32:35], v[80:83], v[124:127], v[32:35]
    v_mfma_f32_16x16x32_bf16 v[60:63], v[84:87], v[124:127], v[60:63]
    v_mfma_f32_16x16x32_bf16 v[36:39], v[80:83], v[180:183], v[36:39]
    v_mfma_f32_16x16x32_bf16 v[64:67], v[84:87], v[180:183], v[64:67]
    v_mfma_f32_16x16x32_bf16 v[40:43], v[80:83], v[236:239], v[40:43]
    v_mfma_f32_16x16x32_bf16 v[68:71], v[84:87], v[236:239], v[68:71]
    s_add_u32 s26, s24, 12288
    buffer_load_dwordx4 v[80:83], v1, s[4:7], s26 offen offset:1024
    s_add_u32 s26, s25, 12288
    buffer_load_dwordx4 v[84:87], v1, s[4:7], s26 offen offset:1024
    s_waitcnt vmcnt(6)
    v_mfma_f32_16x16x32_bf16 v[16:19], v[88:91], a[40:43], v[16:19]
    v_mfma_f32_16x16x32_bf16 v[44:47], v[92:95], a[40:43], v[44:47]
    v_mfma_f32_16x16x32_bf16 v[20:23], v[88:91], a[96:99], v[20:23]
    v_mfma_f32_16x16x32_bf16 v[48:51], v[92:95], a[96:99], v[48:51]
    v_mfma_f32_16x16x32_bf16 v[24:27], v[88:91], a[152:155], v[24:27]
    v_mfma_f32_16x16x32_bf16 v[52:55], v[92:95], a[152:155], v[52:55]
    v_mfma_f32_16x16x32_bf16 v[28:31], v[88:91], a[208:211], v[28:31]
    v_mfma_f32_16x16x32_bf16 v[56:59], v[92:95], a[208:211], v[56:59]
    v_mfma_f32_16x16x32_bf16 v[32:35], v[88:91], v[128:131], v[32:35]
    v_mfma_f32_16x16x32_bf16 v[60:63], v[92:95], v[128:131], v[60:63]
    v_mfma_f32_16x16x32_bf16 v[36:39], v[88:91], v[184:187], v[36:39]
    v_mfma_f32_16x16x32_bf16 v[64:67], v[92:95], v[184:187], v[64:67]
    v_mfma_f32_16x16x32_bf16 v[40:43], v[88:91], v[240:243], v[40:43]
    v_mfma_f32_16x16x32_bf16 v[68:71], v[92:95], v[240:243], v[68:71]
    s_waitcnt vmcnt(4)
    v_mfma_f32_16x16x32_bf16 v[16:19], v[96:99], a[44:47], v[16:19]
    v_mfma_f32_16x16x32_bf16 v[44:47], v[100:103], a[44:47], v[44:47]
    v_mfma_f32_16x16x32_bf16 v[20:23], v[96:99], a[100:103], v[20:23]
    v_mfma_f32_16x16x32_bf16 v[48:51], v[100:103], a[100:103], v[48:51]
    v_mfma_f32_16x16x32_bf16 v[24:27], v[96:99], a[156:159], v[24:27]
    v_mfma_f32_16x16x32_bf16 v[52:55], v[100:103], a[156:159], v[52:55]
    v_mfma_f32_16x16x32_bf16 v[28:31], v[96:99], a[212:215], v[28:31]
    v_mfma_f32_16x16x32_bf16 v[56:59], v[100:103], a[212:215], v[56:59]
    v_mfma_f32_16x16x32_bf16 v[32:35], v[96:99], v[132:135], v[32:35]
    v_mfma_f32_16x16x32_bf16 v[60:63], v[100:103], v[132:135], v[60:63]
    v_mfma_f32_16x16x32_bf16 v[36:39], v[96:99], v[188:191], v[36:39]
    v_mfma_f32_16x16x32_bf16 v[64:67], v[100:103], v[188:191], v[64:67]
    v_mfma_f32_16x16x32_bf16 v[40:43], v[96:99], v[244:247], v[40:43]
    v_mfma_f32_16x16x32_bf16 v[68:71], v[100:103], v[244:247], v[68:71]
    s_waitcnt vmcnt(2)
    v_mfma_f32_16x16x32_bf16 v[16:19], v[72:75], a[48:51], v[16:19]
    v_mfma_f32_16x16x32_bf16 v[44:47], v[76:79], a[48:51], v[44:47]
    v_mfma_f32_16x16x32_bf16 v[20:23], v[72:75], a[104:107], v[20:23]
    v_mfma_f32_16x16x32_bf16 v[48:51], v[76:79], a[104:107], v[48:51]
    v_mfma_f32_16x16x32_bf16 v[24:27], v[72:75], a[160:163], v[24:27]
    v_mfma_f32_16x16x32_bf16 v[52:55], v[76:79], a[160:163], v[52:55]
    v_mfma_f32_16x16x32_bf16 v[28:31], v[72:75], a[216:219], v[28:31]
    v_mfma_f32_16x16x32_bf16 v[56:59], v[76:79], a[216:219], v[56:59]
    v_mfma_f32_16x16x32_bf16 v[32:35], v[72:75], v[136:139], v[32:35]
    v_mfma_f32_16x16x32_bf16 v[60:63], v[76:79], v[136:139], v[60:63]
    v_mfma_f32_16x16x32_bf16 v[36:39], v[72:75], v[192:195], v[36:39]
    v_mfma_f32_16x16x32_bf16 v[64:67], v[76:79], v[192:195], v[64:67]
    v_mfma_f32_16x16x32_bf16 v[40:43], v[72:75], v[248:251], v[40:43]
    v_mfma_f32_16x16x32_bf16 v[68:71], v[76:79], v[248:251], v[68:71]
    s_waitcnt vmcnt(0)
    v_mfma_f32_16x16x32_bf16 v[16:19], v[80:83], a[52:55], v[16:19]
    v_mfma_f32_16x16x32_bf16 v[44:47], v[84:87], a[52:55], v[44:47]
    v_mfma_f32_16x16x32_bf16 v[20:23], v[80:83], a[108:111], v[20:23]
    v_mfma_f32_16x16x32_bf16 v[48:51], v[84:87], a[108:111], v[48:51]
    v_mfma_f32_16x16x32_bf16 v[24:27], v[80:83], a[164:167], v[24:27]
    v_mfma_f32_16x16x32_bf16 v[52:55], v[84:87], a[164:167], v[52:55]
    v_mfma_f32_16x16x32_bf16 v[28:31], v[80:83], a[220:223], v[28:31]
    v_mfma_f32_16x16x32_bf16 v[56:59], v[84:87], a[220:223], v[56:59]
    v_mfma_f32_16x16x32_bf16 v[32:35], v[80:83], v[140:143], v[32:35]
    v_mfma_f32_16x16x32_bf16 v[60:63], v[84:87], v[140:143], v[60:63]
    v_mfma_f32_16x16x32_bf16 v[36:39], v[80:83], v[196:199], v[36:39]
    v_mfma_f32_16x16x32_bf16 v[64:67], v[84:87], v[196:199], v[64:67]
    v_mfma_f32_16x16x32_bf16 v[40:43], v[80:83], v[252:255], v[40:43]
    v_mfma_f32_16x16x32_bf16 v[68:71], v[84:87], v[252:255], v[68:71]
    s_mul_i32 s30, s20, 458752
    s_add_u32 s30, s30, s27
    s_lshl_b32 s28, s20, 2
    s_add_u32 s28, s28, s29
    s_add_u32 s20, s20, 6
    s_min_u32 s31, s20, 63
    s_mul_i32 s24, s31, 28672
    s_add_u32 s24, s24, 48402432
    s_add_u32 s25, s24, 14336
    buffer_load_dwordx4 v[72:75], v1, s[4:7], s24 offen offset:0
    buffer_load_dwordx4 v[76:79], v1, s[4:7], s25 offen offset:0
    buffer_load_dwordx4 v[80:83], v1, s[4:7], s24 offen offset:1024
    buffer_load_dwordx4 v[84:87], v1, s[4:7], s25 offen offset:1024
    buffer_load_dwordx4 v[88:91], v1, s[4:7], s24 offen offset:2048
    buffer_load_dwordx4 v[92:95], v1, s[4:7], s25 offen offset:2048
    v_cvt_pk_bf16_f32 v16, v16, v44
    v_cvt_pk_bf16_f32 v17, v17, v45
    v_cvt_pk_bf16_f32 v18, v18, v46
    v_cvt_pk_bf16_f32 v19, v19, v47
    ds_write_b128 v104, v[16:19]
    v_cvt_pk_bf16_f32 v20, v20, v48
    v_cvt_pk_bf16_f32 v21, v21, v49
    v_cvt_pk_bf16_f32 v22, v22, v50
    v_cvt_pk_bf16_f32 v23, v23, v51
    ds_write_b128 v105, v[20:23]
    v_cvt_pk_bf16_f32 v24, v24, v52
    v_cvt_pk_bf16_f32 v25, v25, v53
    v_cvt_pk_bf16_f32 v26, v26, v54
    v_cvt_pk_bf16_f32 v27, v27, v55
    ds_write_b128 v106, v[24:27]
    v_cvt_pk_bf16_f32 v28, v28, v56
    v_cvt_pk_bf16_f32 v29, v29, v57
    v_cvt_pk_bf16_f32 v30, v30, v58
    v_cvt_pk_bf16_f32 v31, v31, v59
    ds_write_b128 v107, v[28:31]
    v_cvt_pk_bf16_f32 v32, v32, v60
    v_cvt_pk_bf16_f32 v33, v33, v61
    v_cvt_pk_bf16_f32 v34, v34, v62
    v_cvt_pk_bf16_f32 v35, v35, v63
    ds_write_b128 v108, v[32:35]
    v_cvt_pk_bf16_f32 v36, v36, v64
    v_cvt_pk_bf16_f32 v37, v37, v65
    v_cvt_pk_bf16_f32 v38, v38, v66
    v_cvt_pk_bf16_f32 v39, v39, v67
    ds_write_b128 v109, v[36:39]
    v_cvt_pk_bf16_f32 v40, v40, v68
    v_cvt_pk_bf16_f32 v41, v41, v69
    v_cvt_pk_bf16_f32 v42, v42, v70
    v_cvt_pk_bf16_f32 v43, v43, v71
    ds_write_b128 v110, v[40:43]
    ds_read_b128 v[44:47], v111 offset:0
    ds_read_b128 v[48:51], v111 offset:1024
    ds_read_b128 v[52:55], v111 offset:2048
    ds_read_b128 v[56:59], v111 offset:3072
    ds_read_b128 v[60:63], v111 offset:4096
    ds_read_b128 v[64:67], v111 offset:5120
    ds_read_b128 v[68:71], v111 offset:6144
    s_add_u32 s31, s30, 4096
    s_waitcnt lgkmcnt(6)
    buffer_store_dwordx4 v[44:47], v1, s[4:7], s30 offen offset:0 sc1
    s_waitcnt lgkmcnt(5)
    buffer_store_dwordx4 v[48:51], v1, s[4:7], s30 offen offset:1024 sc1
    s_waitcnt lgkmcnt(4)
    buffer_store_dwordx4 v[52:55], v1, s[4:7], s30 offen offset:2048 sc1
    s_waitcnt lgkmcnt(3)
    buffer_store_dwordx4 v[56:59], v1, s[4:7], s30 offen offset:3072 sc1
    s_waitcnt lgkmcnt(2)
    buffer_store_dwordx4 v[60:63], v1, s[4:7], s31 offen offset:0 sc1
    s_waitcnt lgkmcnt(1)
    buffer_store_dwordx4 v[64:67], v1, s[4:7], s31 offen offset:1024 sc1
    s_waitcnt lgkmcnt(0)
    buffer_store_dwordx4 v[68:71], v1, s[4:7], s31 offen offset:2048 sc1
    s_cmp_lt_u32 s20, 64
    s_cbranch_scc1 LW_109
    s_waitcnt vmcnt(0)
    s_barrier
    buffer_store_dword v6, v5, s[4:7], s28 offen sc1
    v_mul_u32_u24 v11, 3584, v4
    v_lshl_add_u32 v11, v3, 2, v11
    v_mov_b32 v13, 0x80000000
    v_cmp_gt_u32 vcc, 3, v4
    s_mul_i32 s22, s16, 100352
    s_mul_i32 s23, s17, 56
    v_cndmask_b32 v12, v13, v11, vcc
    s_add_u32 s22, s22, s23
    s_add_u32 s23, s22, 0
    buffer_load_dword v32, v11, s[44:47], s23 offen offset:0
    buffer_load_dword v33, v11, s[44:47], s23 offen offset:896
    buffer_load_dword v34, v11, s[44:47], s23 offen offset:1792
    buffer_load_dword v35, v11, s[44:47], s23 offen offset:2688
    s_add_u32 s23, s22, 14336
    buffer_load_dword v36, v12, s[44:47], s23 offen offset:0
    buffer_load_dword v37, v12, s[44:47], s23 offen offset:896
    buffer_load_dword v38, v12, s[44:47], s23 offen offset:1792
    buffer_load_dword v39, v12, s[44:47], s23 offen offset:2688
    s_add_u32 s23, s22, 25088
    buffer_load_dword v40, v11, s[44:47], s23 offen offset:0
    buffer_load_dword v41, v11, s[44:47], s23 offen offset:896
    buffer_load_dword v42, v11, s[44:47], s23 offen offset:1792
    buffer_load_dword v43, v11, s[44:47], s23 offen offset:2688
    s_add_u32 s23, s22, 39424
    buffer_load_dword v44, v12, s[44:47], s23 offen offset:0
    buffer_load_dword v45, v12, s[44:47], s23 offen offset:896
    buffer_load_dword v46, v12, s[44:47], s23 offen offset:1792
    buffer_load_dword v47, v12, s[44:47], s23 offen offset:2688
    s_add_u32 s23, s22, 50176
    buffer_load_dword v48, v11, s[44:47], s23 offen offset:0
    buffer_load_dword v49, v11, s[44:47], s23 offen offset:896
    buffer_load_dword v50, v11, s[44:47], s23 offen offset:1792
    buffer_load_dword v51, v11, s[44:47], s23 offen offset:2688
    s_add_u32 s23, s22, 64512
    buffer_load_dword v52, v12, s[44:47], s23 offen offset:0
    buffer_load_dword v53, v12, s[44:47], s23 offen offset:896
    buffer_load_dword v54, v12, s[44:47], s23 offen offset:1792
    buffer_load_dword v55, v12, s[44:47], s23 offen offset:2688
    s_add_u32 s23, s22, 75264
    buffer_load_dword v56, v11, s[44:47], s23 offen offset:0
    buffer_load_dword v57, v11, s[44:47], s23 offen offset:896
    buffer_load_dword v58, v11, s[44:47], s23 offen offset:1792
    buffer_load_dword v59, v11, s[44:47], s23 offen offset:2688
    s_add_u32 s23, s22, 89600
    buffer_load_dword v60, v12, s[44:47], s23 offen offset:0
    buffer_load_dword v61, v12, s[44:47], s23 offen offset:896
    buffer_load_dword v62, v12, s[44:47], s23 offen offset:1792
    buffer_load_dword v63, v12, s[44:47], s23 offen offset:2688
    s_mov_b32 s22, 0x05040100
    s_mov_b32 s23, 0x07060302
    s_lshl_b32 s26, s16, 13
    v_add_u32 v7, s26, v1
    s_waitcnt vmcnt(0)
    v_perm_b32 v64, v33, v32, s22
    v_perm_b32 v65, v35, v34, s22
    v_perm_b32 v66, v37, v36, s22
    v_perm_b32 v67, v39, v38, s22
    ds_write_b128 v7, v[64:67] offset:0
    v_perm_b32 v68, v33, v32, s23
    v_perm_b32 v69, v35, v34, s23
    v_perm_b32 v70, v37, v36, s23
    v_perm_b32 v71, v39, v38, s23
    ds_write_b128 v7, v[68:71] offset:1024
    v_perm_b32 v64, v41, v40, s22
    v_perm_b32 v65, v43, v42, s22
    v_perm_b32 v66, v45, v44, s22
    v_perm_b32 v67, v47, v46, s22
    ds_write_b128 v7, v[64:67] offset:2048
    v_perm_b32 v68, v41, v40, s23
    v_perm_b32 v69, v43, v42, s23
    v_perm_b32 v70, v45, v44, s23
    v_perm_b32 v71, v47, v46, s23
    ds_write_b128 v7, v[68:71] offset:3072
    v_perm_b32 v64, v49, v48, s22
    v_perm_b32 v65, v51, v50, s22
    v_perm_b32 v66, v53, v52, s22
    v_perm_b32 v67, v55, v54, s22
    ds_write_b128 v7, v[64:67] offset:4096
    v_perm_b32 v68, v49, v48, s23
    v_perm_b32 v69, v51, v50, s23
    v_perm_b32 v70, v53, v52, s23
    v_perm_b32 v71, v55, v54, s23
    ds_write_b128 v7, v[68:71] offset:5120
    v_perm_b32 v64, v57, v56, s22
    v_perm_b32 v65, v59, v58, s22
    v_perm_b32 v66, v61, v60, s22
    v_perm_b32 v67, v63, v62, s22
    ds_write_b128 v7, v[64:67] offset:6144
    v_perm_b32 v68, v57, v56, s23
    v_perm_b32 v69, v59, v58, s23
    v_perm_b32 v70, v61, v60, s23
    v_perm_b32 v71, v63, v62, s23
    ds_write_b128 v7, v[68:71] offset:7168
    v_mov_b32 v2, 0x44444444
    v_mov_b32 v11, 0xeeeeeeee
    v_and_b32 v12, 2, v0
    v_cmp_ne_u32 vcc, 0, v12
    s_lshl_b32 s26, s16, 11
    s_add_u32 s26, s26, 32768
    v_cndmask_b32 v2, v2, v11, vcc
    v_lshlrev_b32 v5, 4, v3
    v_lshl_add_u32 v5, v4, 2, v5
    v_add_u32 v5, s26, v5
    v_mul_u32_u24 v6, 28, v4
    v_add_lshl_u32 v6, v6, v3, 4
    v_add_u32 v6, s26, v6
    v_min_u32 v14, 13, v3
    v_mul_u32_u24 v11, 14, v4
    v_add_lshl_u32 v14, v14, v11, 4
    s_lshl_b32 s26, s16, 10
    s_add_u32 s26, s26, 65536
    v_add_u32 v9, s26, v1
    s_lshl_b32 s26, s16, 12
    s_add_u32 s26, s26, 65536
    v_add_u32 v10, s26, v1
    v_lshrrev_b32 v11, 1, v4
    v_lshlrev_b32 v11, 3, v11
    v_and_b32 v12, 1, v4
    v_lshl_add_u32 v11, v12, 1, v11
    s_lshr_b32 s22, s16, 1
    s_lshl_b32 s22, s22, 4
    s_and_b32 s23, s16, 1
    s_add_u32 s22, s22, s23
    v_add_u32 v11, s22, v11
    v_mul_u32_u24 v11, 896, v11
    v_lshl_add_u32 v11, v3, 2, v11
    s_mul_i32 s22, s17, 56
    v_add_u32 v11, s22, v11
    v_cmp_gt_u32 vcc, 14, v3
    v_mov_b32 v15, 0x80008000
    s_mov_b32 s20, s18
    v_cndmask_b32 v8, v13, v11, vcc
LF_110:
    s_lshr_b32 s22, s20, 3
    s_lshl_b32 s22, s22, 7
    s_add_u32 s22, s22, 54772736
    v_mov_b32 v12, 0
Lpc_111:
    buffer_load_dword v11, v12, s[4:7], s22 offen sc1
    s_sub_u32 s19, s19, 1
    s_cbranch_scc1 main_kernel_exit
    s_waitcnt vmcnt(0)
    v_cmp_le_u32 vcc, 4, v11
    s_sleep 8
    s_cbranch_vccz Lpc_111
    s_lshl_b32 s22, s20, 15
    s_lshl_b32 s23, s16, 13
    s_add_u32 s22, s22, s23
    s_add_u32 s22, s22, 51613696
    s_add_u32 s23, s22, 4096
    s_mul_i32 s30, s20, 458752
    s_add_u32 s30, s30, s27
    s_add_u32 s31, s30, 3584
    s_mul_i32 s32, s20, 48128
    s_add_u32 s32, s32, 45314048
    s_add_u32 s33, s32, 4096
    buffer_load_dwordx4 v[64:67], v1, s[4:7], s22 offen offset:0 sc1
    buffer_load_dwordx4 v[68:71], v1, s[4:7], s22 offen offset:1024 sc1
    buffer_load_dwordx4 v[72:75], v1, s[4:7], s22 offen offset:2048 sc1
    buffer_load_dwordx4 v[76:79], v1, s[4:7], s22 offen offset:3072 sc1
    buffer_load_dwordx4 v[80:83], v1, s[4:7], s23 offen offset:0 sc1
    buffer_load_dwordx4 v[84:87], v1, s[4:7], s23 offen offset:1024 sc1
    buffer_load_dwordx4 v[88:91], v1, s[4:7], s23 offen offset:2048 sc1
    buffer_load_dwordx4 v[92:95], v1, s[4:7], s23 offen offset:3072 sc1
    ds_read_b128 v[32:35], v7 offset:0
    ds_read_b128 v[36:39], v7 offset:1024
    ds_read_b128 v[40:43], v7 offset:2048
    ds_read_b128 v[44:47], v7 offset:3072
    ds_read_b128 v[48:51], v7 offset:4096
    ds_read_b128 v[52:55], v7 offset:5120
    ds_read_b128 v[56:59], v7 offset:6144
    ds_read_b128 v[60:63], v7 offset:7168
    s_waitcnt vmcnt(0) lgkmcnt(0)
    v_mfma_f32_16x16x32_bf16 v[16:19], v[64:67], v[32:35], 0
    v_mfma_f32_16x16x32_bf16 v[20:23], v[64:67], v[36:39], 0
    v_mfma_f32_16x16x32_bf16 v[24:27], v[68:71], v[32:35], 0
    v_mfma_f32_16x16x32_bf16 v[28:31], v[68:71], v[36:39], 0
    v_mfma_f32_16x16x32_bf16 v[16:19], v[72:75], v[40:43], v[16:19]
    v_mfma_f32_16x16x32_bf16 v[20:23], v[72:75], v[44:47], v[20:23]
    v_mfma_f32_16x16x32_bf16 v[24:27], v[76:79], v[40:43], v[24:27]
    v_mfma_f32_16x16x32_bf16 v[28:31], v[76:79], v[44:47], v[28:31]
    v_mfma_f32_16x16x32_bf16 v[16:19], v[80:83], v[48:51], v[16:19]
    v_mfma_f32_16x16x32_bf16 v[20:23], v[80:83], v[52:55], v[20:23]
    v_mfma_f32_16x16x32_bf16 v[24:27], v[84:87], v[48:51], v[24:27]
    v_mfma_f32_16x16x32_bf16 v[28:31], v[84:87], v[52:55], v[28:31]
    v_mfma_f32_16x16x32_bf16 v[16:19], v[88:91], v[56:59], v[16:19]
    v_mfma_f32_16x16x32_bf16 v[20:23], v[88:91], v[60:63], v[20:23]
    v_mfma_f32_16x16x32_bf16 v[24:27], v[92:95], v[56:59], v[24:27]
    v_mfma_f32_16x16x32_bf16 v[28:31], v[92:95], v[60:63], v[28:31]
    buffer_load_dwordx4 v[32:35], v14, s[4:7], s30 offen offset:0 sc1
    buffer_load_dwordx4 v[36:39], v14, s[4:7], s30 offen offset:896 sc1
    buffer_load_dwordx4 v[40:43], v14, s[4:7], s30 offen offset:1792 sc1
    buffer_load_dwordx4 v[44:47], v14, s[4:7], s30 offen offset:2688 sc1
    buffer_load_dwordx4 v[48:51], v14, s[4:7], s31 offen offset:0 sc1
    buffer_load_dwordx4 v[52:55], v14, s[4:7], s31 offen offset:896 sc1
    buffer_load_dwordx4 v[56:59], v14, s[4:7], s31 offen offset:1792 sc1
    buffer_load_dwordx4 v[60:63], v14, s[4:7], s31 offen offset:2688 sc1
    s_cmp_eq_u32 s20, 63
    s_cbranch_scc1 LS_112
    v_mov_b32 v12, 0
    s_mov_b64 exec, 1
Lww_113:
    buffer_load_dword v11, v12, s[4:7], s33 offen offset:3072 sc1
    s_sub_u32 s19, s19, 1
    s_cbranch_scc1 main_kernel_exit
    s_waitcnt vmcnt(0)
    v_cmp_eq_u32 vcc, -1, v11
    s_cbranch_vccz Lww_114
    s_sleep 8
    s_branch Lww_113
Lww_114:
    s_mov_b64 exec, -1
LS_112:
LM_115:
    buffer_load_dwordx4 v[64:67], v1, s[4:7], s32 offen offset:0 sc1
    buffer_load_dwordx4 v[68:71], v1, s[4:7], s32 offen offset:1024 sc1
    buffer_load_dwordx4 v[72:75], v1, s[4:7], s32 offen offset:2048 sc1
    buffer_load_dwordx4 v[76:79], v1, s[4:7], s32 offen offset:3072 sc1
    buffer_load_dwordx4 v[80:83], v1, s[4:7], s33 offen offset:0 sc1
    buffer_load_dwordx4 v[84:87], v1, s[4:7], s33 offen offset:1024 sc1
    buffer_load_dwordx4 v[88:91], v1, s[4:7], s33 offen offset:2048 sc1
    s_sub_u32 s19, s19, 1
    s_cbranch_scc1 main_kernel_exit
    s_waitcnt vmcnt(0)
    v_max_u32 v11, v64, v65
    v_max3_u32 v11, v11, v66, v67
    v_max3_u32 v11, v11, v68, v69
    v_max3_u32 v11, v11, v70, v71
    v_max3_u32 v11, v11, v72, v73
    v_max3_u32 v11, v11, v74, v75
    v_max3_u32 v11, v11, v76, v77
    v_max3_u32 v11, v11, v78, v79
    v_max3_u32 v11, v11, v80, v81
    v_max3_u32 v11, v11, v82, v83
    v_max3_u32 v11, v11, v84, v85
    v_max3_u32 v11, v11, v86, v87
    v_max3_u32 v11, v11, v88, v89
    v_max3_u32 v11, v11, v90, v91
    v_cmp_eq_u32 vcc, -1, v11
    s_cbranch_vccz LM_116
    s_sleep 6
    s_branch LM_115
LM_116:
    v_mov_b32 v92, 0
    v_mov_b32 v93, 0
    v_mov_b32 v94, 0
    v_mov_b32 v95, 0
    v_mov_b32 v96, 0
    v_mov_b32 v97, 0
    v_mov_b32 v98, 0
    v_mov_b32 v99, 0
    s_nop 0
    v_smfmac_f32_16x16x64_bf16 v[92:95], v[64:67], a[0:7], v2
    v_smfmac_f32_16x16x64_bf16 v[92:95], v[68:71], a[8:15], v2
    v_smfmac_f32_16x16x64_bf16 v[92:95], v[72:75], a[16:23], v2
    v_smfmac_f32_16x16x64_bf16 v[92:95], v[76:79], a[24:31], v2
    v_smfmac_f32_16x16x64_bf16 v[92:95], v[80:83], a[32:39], v2
    v_smfmac_f32_16x16x64_bf16 v[92:95], v[84:87], a[40:47], v2
    v_smfmac_f32_16x16x64_bf16 v[92:95], v[88:91], a[48:55], v2
    v_smfmac_f32_16x16x64_bf16 v[96:99], v[64:67], a[56:63], v2
    v_mov_b32 v100, 0
    v_mov_b32 v101, 0
    v_smfmac_f32_16x16x64_bf16 v[96:99], v[68:71], a[64:71], v2
    v_mov_b32 v102, 0
    v_mov_b32 v103, 0
    v_smfmac_f32_16x16x64_bf16 v[96:99], v[72:75], a[72:79], v2
    v_add_f32 v92, v92, v94
    v_smfmac_f32_16x16x64_bf16 v[96:99], v[76:79], a[80:87], v2
    v_add_f32 v93, v93, v95
    v_smfmac_f32_16x16x64_bf16 v[96:99], v[80:83], a[88:95], v2
    v_cvt_pk_bf16_f32 v92, v92, v93
    v_smfmac_f32_16x16x64_bf16 v[96:99], v[84:87], a[96:103], v2
    ds_write_b32 v5, v92 offset:0
    v_smfmac_f32_16x16x64_bf16 v[96:99], v[88:91], a[104:111], v2
    v_smfmac_f32_16x16x64_bf16 v[100:103], v[64:67], a[112:119], v2
    v_mov_b32 v92, 0
    v_mov_b32 v93, 0
    v_smfmac_f32_16x16x64_bf16 v[100:103], v[68:71], a[120:127], v2
    v_mov_b32 v94, 0
    v_mov_b32 v95, 0
    v_smfmac_f32_16x16x64_bf16 v[100:103], v[72:75], a[128:135], v2
    v_add_f32 v96, v96, v98
    v_smfmac_f32_16x16x64_bf16 v[100:103], v[76:79], a[136:143], v2
    v_add_f32 v97, v97, v99
    v_smfmac_f32_16x16x64_bf16 v[100:103], v[80:83], a[144:151], v2
    v_cvt_pk_bf16_f32 v96, v96, v97
    v_smfmac_f32_16x16x64_bf16 v[100:103], v[84:87], a[152:159], v2
    ds_write_b32 v5, v96 offset:256
    v_smfmac_f32_16x16x64_bf16 v[100:103], v[88:91], a[160:167], v2
    v_smfmac_f32_16x16x64_bf16 v[92:95], v[64:67], a[168:175], v2
    v_mov_b32 v96, 0
    v_mov_b32 v97, 0
    v_smfmac_f32_16x16x64_bf16 v[92:95], v[68:71], a[176:183], v2
    v_mov_b32 v98, 0
    v_mov_b32 v99, 0
    v_smfmac_f32_16x16x64_bf16 v[92:95], v[72:75], a[184:191], v2
    v_add_f32 v100, v100, v102
    v_smfmac_f32_16x16x64_bf16 v[92:95], v[76:79], a[192:199], v2
    v_add_f32 v101, v101, v103
    v_smfmac_f32_16x16x64_bf16 v[92:95], v[80:83], a[200:207], v2
    v_cvt_pk_bf16_f32 v100, v100, v101
    v_smfmac_f32_16x16x64_bf16 v[92:95], v[84:87], a[208:215], v2
    ds_write_b32 v5, v100 offset:512
    v_smfmac_f32_16x16x64_bf16 v[92:95], v[88:91], a[216:223], v2
    v_smfmac_f32_16x16x64_bf16 v[96:99], v[64:67], a[224:231], v2
    v_mov_b32 v100, 0
    v_mov_b32 v101, 0
    v_smfmac_f32_16x16x64_bf16 v[96:99], v[68:71], a[232:239], v2
    v_mov_b32 v102, 0
    v_mov_b32 v103, 0
    v_smfmac_f32_16x16x64_bf16 v[96:99], v[72:75], a[240:247], v2
    v_add_f32 v92, v92, v94
    v_smfmac_f32_16x16x64_bf16 v[96:99], v[76:79], a[248:255], v2
    v_add_f32 v93, v93, v95
    v_smfmac_f32_16x16x64_bf16 v[96:99], v[80:83], v[120:127], v2
    v_cvt_pk_bf16_f32 v92, v92, v93
    v_smfmac_f32_16x16x64_bf16 v[96:99], v[84:87], v[128:135], v2
    ds_write_b32 v5, v92 offset:768
    v_smfmac_f32_16x16x64_bf16 v[96:99], v[88:91], v[136:143], v2
    v_smfmac_f32_16x16x64_bf16 v[100:103], v[64:67], v[144:151], v2
    v_mov_b32 v92, 0
    v_mov_b32 v93, 0
    v_smfmac_f32_16x16x64_bf16 v[100:103], v[68:71], v[152:159], v2
    v_mov_b32 v94, 0
    v_mov_b32 v95, 0
    v_smfmac_f32_16x16x64_bf16 v[100:103], v[72:75], v[160:167], v2
    v_add_f32 v96, v96, v98
    v_smfmac_f32_16x16x64_bf16 v[100:103], v[76:79], v[168:175], v2
    v_add_f32 v97, v97, v99
    v_smfmac_f32_16x16x64_bf16 v[100:103], v[80:83], v[176:183], v2
    v_cvt_pk_bf16_f32 v96, v96, v97
    v_smfmac_f32_16x16x64_bf16 v[100:103], v[84:87], v[184:191], v2
    ds_write_b32 v5, v96 offset:1024
    v_smfmac_f32_16x16x64_bf16 v[100:103], v[88:91], v[192:199], v2
    v_smfmac_f32_16x16x64_bf16 v[92:95], v[64:67], v[200:207], v2
    v_smfmac_f32_16x16x64_bf16 v[92:95], v[68:71], v[208:215], v2
    v_smfmac_f32_16x16x64_bf16 v[92:95], v[72:75], v[216:223], v2
    v_add_f32 v100, v100, v102
    v_smfmac_f32_16x16x64_bf16 v[92:95], v[76:79], v[224:231], v2
    v_add_f32 v101, v101, v103
    v_smfmac_f32_16x16x64_bf16 v[92:95], v[80:83], v[232:239], v2
    v_cvt_pk_bf16_f32 v100, v100, v101
    v_smfmac_f32_16x16x64_bf16 v[92:95], v[84:87], v[240:247], v2
    ds_write_b32 v5, v100 offset:1280
    v_smfmac_f32_16x16x64_bf16 v[92:95], v[88:91], v[248:255], v2
    s_nop 7
    v_add_f32 v92, v92, v94
    v_add_f32 v93, v93, v95
    v_cvt_pk_bf16_f32 v92, v92, v93
    ds_write_b32 v5, v92 offset:1536
    ds_read_b128 v[104:107], v6
    ds_read_b128 v[108:111], v6 offset:224
    s_lshl_b32 s22, s16, 13
    s_add_u32 s22, s22, s32
    s_add_u32 s22, s22, 7168
    s_add_u32 s23, s22, 4096
    s_lshl_b32 s26, s16, 11
    s_add_u32 s26, s26, s32
    s_add_u32 s26, s26, 39936
    s_waitcnt lgkmcnt(0)
LP_117:
    buffer_load_dwordx4 v[64:67], v1, s[4:7], s22 offen offset:0 sc1
    buffer_load_dwordx4 v[68:71], v1, s[4:7], s22 offen offset:1024 sc1
    buffer_load_dwordx4 v[72:75], v1, s[4:7], s22 offen offset:2048 sc1
    buffer_load_dwordx4 v[76:79], v1, s[4:7], s22 offen offset:3072 sc1
    buffer_load_dwordx4 v[80:83], v1, s[4:7], s23 offen offset:0 sc1
    buffer_load_dwordx4 v[84:87], v1, s[4:7], s23 offen offset:1024 sc1
    buffer_load_dwordx4 v[88:91], v1, s[4:7], s23 offen offset:2048 sc1
    buffer_load_dwordx4 v[92:95], v1, s[4:7], s23 offen offset:3072 sc1
    buffer_load_dwordx4 v[96:99], v1, s[4:7], s26 offen offset:0 sc1
    buffer_load_dwordx4 v[100:103], v1, s[4:7], s26 offen offset:1024 sc1
    s_sub_u32 s19, s19, 1
    s_cbranch_scc1 main_kernel_exit
    s_waitcnt vmcnt(0)
    v_or_b32 v11, v64, v65
    v_or3_b32 v11, v11, v66, v67
    v_or3_b32 v11, v11, v68, v69
    v_or3_b32 v11, v11, v70, v71
    v_or3_b32 v11, v11, v72, v73
    v_or3_b32 v11, v11, v74, v75
    v_or3_b32 v11, v11, v76, v77
    v_or3_b32 v11, v11, v78, v79
    v_or3_b32 v11, v11, v80, v81
    v_or3_b32 v11, v11, v82, v83
    v_or3_b32 v11, v11, v84, v85
    v_or3_b32 v11, v11, v86, v87
    v_or3_b32 v11, v11, v88, v89
    v_or3_b32 v11, v11, v90, v91
    v_or3_b32 v11, v11, v92, v93
    v_or3_b32 v11, v11, v94, v95
    v_or3_b32 v11, v11, v96, v97
    v_or3_b32 v11, v11, v98, v99
    v_or3_b32 v11, v11, v100, v101
    v_or3_b32 v11, v11, v102, v103
    v_and_b32 v11, v11, v15
    v_cmp_ne_u32 vcc, 0, v11
    s_cbranch_vccz LP_118
    s_sleep 2
    s_branch LP_117
LP_118:
    v_mfma_f32_16x16x32_bf16 v[16:19], v[64:67], v[32:35], v[16:19]
    v_mfma_f32_16x16x32_bf16 v[20:23], v[64:67], v[36:39], v[20:23]
    v_mfma_f32_16x16x32_bf16 v[24:27], v[68:71], v[32:35], v[24:27]
    v_mfma_f32_16x16x32_bf16 v[28:31], v[68:71], v[36:39], v[28:31]
    v_mfma_f32_16x16x32_bf16 v[16:19], v[72:75], v[40:43], v[16:19]
    v_mfma_f32_16x16x32_bf16 v[20:23], v[72:75], v[44:47], v[20:23]
    v_mfma_f32_16x16x32_bf16 v[24:27], v[76:79], v[40:43], v[24:27]
    v_mfma_f32_16x16x32_bf16 v[28:31], v[76:79], v[44:47], v[28:31]
    v_mfma_f32_16x16x32_bf16 v[16:19], v[80:83], v[48:51], v[16:19]
    v_mfma_f32_16x16x32_bf16 v[20:23], v[80:83], v[52:55], v[20:23]
    v_mfma_f32_16x16x32_bf16 v[24:27], v[84:87], v[48:51], v[24:27]
    v_mfma_f32_16x16x32_bf16 v[28:31], v[84:87], v[52:55], v[28:31]
    v_mfma_f32_16x16x32_bf16 v[16:19], v[88:91], v[56:59], v[16:19]
    v_mfma_f32_16x16x32_bf16 v[20:23], v[88:91], v[60:63], v[20:23]
    v_mfma_f32_16x16x32_bf16 v[24:27], v[92:95], v[56:59], v[24:27]
    v_mfma_f32_16x16x32_bf16 v[28:31], v[92:95], v[60:63], v[28:31]
    v_mfma_f32_16x16x32_bf16 v[16:19], v[96:99], v[104:107], v[16:19]
    v_mfma_f32_16x16x32_bf16 v[20:23], v[96:99], v[108:111], v[20:23]
    v_mfma_f32_16x16x32_bf16 v[24:27], v[100:103], v[104:107], v[24:27]
    v_mfma_f32_16x16x32_bf16 v[28:31], v[100:103], v[108:111], v[28:31]
    s_nop 7
    ds_write_b64 v9, v[16:17] offset:0
    ds_write_b64 v9, v[20:21] offset:8
    ds_write_b64 v9, v[18:19] offset:4096
    ds_write_b64 v9, v[22:23] offset:4104
    ds_write_b64 v9, v[24:25] offset:8192
    ds_write_b64 v9, v[28:29] offset:8200
    ds_write_b64 v9, v[26:27] offset:12288
    ds_write_b64 v9, v[30:31] offset:12296
    s_waitcnt lgkmcnt(0)
    s_barrier
    ds_read_b128 v[32:35], v10 offset:0
    ds_read_b128 v[36:39], v10 offset:1024
    ds_read_b128 v[40:43], v10 offset:2048
    ds_read_b128 v[44:47], v10 offset:3072
    s_mul_i32 s22, s20, 28672
    v_xor_b32 v9, 0x4000, v9
    v_xor_b32 v10, 0x4000, v10
    s_add_u32 s20, s20, 6
    s_waitcnt lgkmcnt(0)
    v_add_f32 v32, v32, v36
    v_add_f32 v40, v40, v44
    v_add_f32 v33, v33, v37
    v_add_f32 v41, v41, v45
    v_add_f32 v34, v34, v38
    v_add_f32 v42, v42, v46
    v_add_f32 v35, v35, v39
    v_add_f32 v43, v43, v47
    v_add_f32 v32, v32, v40
    v_add_f32 v33, v33, v41
    v_add_f32 v34, v34, v42
    v_add_f32 v35, v35, v43
    v_cvt_pk_bf16_f32 v11, v32, v34
    v_cvt_pk_bf16_f32 v112, v33, v35
    buffer_store_dword v11, v8, s[8:11], s22 offen
    buffer_store_dword v112, v8, s[8:11], s22 offen offset:3584
    s_cmp_lt_u32 s20, 64
    s_cbranch_scc1 LF_110
    s_branch main_kernel_exit
main_kernel_ta:
    v_lshlrev_b32 v1, 4, v0
    v_and_b32 v3, 15, v0
    v_lshrrev_b32 v4, 4, v0
    s_mov_b32 s20, s18
    s_mul_i32 s24, s20, 28672
    s_add_u32 s24, s24, 48402432
    s_add_u32 s25, s24, 14336
    buffer_load_dwordx4 v[72:75], v1, s[4:7], s24 offen offset:0
    buffer_load_dwordx4 v[76:79], v1, s[4:7], s25 offen offset:0
    buffer_load_dwordx4 v[80:83], v1, s[4:7], s24 offen offset:1024
    buffer_load_dwordx4 v[84:87], v1, s[4:7], s25 offen offset:1024
    buffer_load_dwordx4 v[88:91], v1, s[4:7], s24 offen offset:2048
    buffer_load_dwordx4 v[92:95], v1, s[4:7], s25 offen offset:2048
    s_mul_i32 s22, s17, 401408
    s_mul_i32 s23, s16, 100352
    s_add_u32 s22, s22, s23
    s_add_u32 s22, s22, 0
    buffer_load_dwordx4 a[0:3], v1, s[4:7], s22 offen offset:0
    buffer_load_dwordx4 a[4:7], v1, s[4:7], s22 offen offset:1024
    s_add_u32 s22, s22, 2048
    buffer_load_dwordx4 a[8:11], v1, s[4:7], s22 offen offset:0
    buffer_load_dwordx4 a[12:15], v1, s[4:7], s22 offen offset:1024
    s_add_u32 s22, s22, 2048
    buffer_load_dwordx4 a[16:19], v1, s[4:7], s22 offen offset:0
    buffer_load_dwordx4 a[20:23], v1, s[4:7], s22 offen offset:1024
    s_add_u32 s22, s22, 2048
    buffer_load_dwordx4 a[24:27], v1, s[4:7], s22 offen offset:0
    buffer_load_dwordx4 a[28:31], v1, s[4:7], s22 offen offset:1024
    s_add_u32 s22, s22, 2048
    buffer_load_dwordx4 a[32:35], v1, s[4:7], s22 offen offset:0
    buffer_load_dwordx4 a[36:39], v1, s[4:7], s22 offen offset:1024
    s_add_u32 s22, s22, 2048
    buffer_load_dwordx4 a[40:43], v1, s[4:7], s22 offen offset:0
    buffer_load_dwordx4 a[44:47], v1, s[4:7], s22 offen offset:1024
    s_add_u32 s22, s22, 2048
    buffer_load_dwordx4 a[48:51], v1, s[4:7], s22 offen offset:0
    buffer_load_dwordx4 a[52:55], v1, s[4:7], s22 offen offset:1024
    s_add_u32 s22, s22, 2048
    buffer_load_dwordx4 a[56:59], v1, s[4:7], s22 offen offset:0
    buffer_load_dwordx4 a[60:63], v1, s[4:7], s22 offen offset:1024
    s_add_u32 s22, s22, 2048
    buffer_load_dwordx4 a[64:67], v1, s[4:7], s22 offen offset:0
    buffer_load_dwordx4 a[68:71], v1, s[4:7], s22 offen offset:1024
    s_add_u32 s22, s22, 2048
    buffer_load_dwordx4 a[72:75], v1, s[4:7], s22 offen offset:0
    buffer_load_dwordx4 a[76:79], v1, s[4:7], s22 offen offset:1024
    s_add_u32 s22, s22, 2048
    buffer_load_dwordx4 a[80:83], v1, s[4:7], s22 offen offset:0
    buffer_load_dwordx4 a[84:87], v1, s[4:7], s22 offen offset:1024
    s_add_u32 s22, s22, 2048
    buffer_load_dwordx4 a[88:91], v1, s[4:7], s22 offen offset:0
    buffer_load_dwordx4 a[92:95], v1, s[4:7], s22 offen offset:1024
    s_add_u32 s22, s22, 2048
    buffer_load_dwordx4 a[96:99], v1, s[4:7], s22 offen offset:0
    buffer_load_dwordx4 a[100:103], v1, s[4:7], s22 offen offset:1024
    s_add_u32 s22, s22, 2048
    buffer_load_dwordx4 a[104:107], v1, s[4:7], s22 offen offset:0
    buffer_load_dwordx4 a[108:111], v1, s[4:7], s22 offen offset:1024
    s_add_u32 s22, s22, 2048
    buffer_load_dwordx4 a[112:115], v1, s[4:7], s22 offen offset:0
    buffer_load_dwordx4 a[116:119], v1, s[4:7], s22 offen offset:1024
    s_add_u32 s22, s22, 2048
    buffer_load_dwordx4 a[120:123], v1, s[4:7], s22 offen offset:0
    buffer_load_dwordx4 a[124:127], v1, s[4:7], s22 offen offset:1024
    s_add_u32 s22, s22, 2048
    buffer_load_dwordx4 a[128:131], v1, s[4:7], s22 offen offset:0
    buffer_load_dwordx4 a[132:135], v1, s[4:7], s22 offen offset:1024
    s_add_u32 s22, s22, 2048
    buffer_load_dwordx4 a[136:139], v1, s[4:7], s22 offen offset:0
    buffer_load_dwordx4 a[140:143], v1, s[4:7], s22 offen offset:1024
    s_add_u32 s22, s22, 2048
    buffer_load_dwordx4 a[144:147], v1, s[4:7], s22 offen offset:0
    buffer_load_dwordx4 a[148:151], v1, s[4:7], s22 offen offset:1024
    s_add_u32 s22, s22, 2048
    buffer_load_dwordx4 a[152:155], v1, s[4:7], s22 offen offset:0
    buffer_load_dwordx4 a[156:159], v1, s[4:7], s22 offen offset:1024
    s_add_u32 s22, s22, 2048
    buffer_load_dwordx4 a[160:163], v1, s[4:7], s22 offen offset:0
    buffer_load_dwordx4 a[164:167], v1, s[4:7], s22 offen offset:1024
    s_add_u32 s22, s22, 2048
    s_waitcnt vmcnt(40)
    buffer_load_dwordx4 a[168:171], v1, s[4:7], s22 offen offset:0
    buffer_load_dwordx4 a[172:175], v1, s[4:7], s22 offen offset:1024
    s_add_u32 s22, s22, 2048
    buffer_load_dwordx4 a[176:179], v1, s[4:7], s22 offen offset:0
    buffer_load_dwordx4 a[180:183], v1, s[4:7], s22 offen offset:1024
    s_add_u32 s22, s22, 2048
    buffer_load_dwordx4 a[184:187], v1, s[4:7], s22 offen offset:0
    buffer_load_dwordx4 a[188:191], v1, s[4:7], s22 offen offset:1024
    s_add_u32 s22, s22, 2048
    buffer_load_dwordx4 a[192:195], v1, s[4:7], s22 offen offset:0
    buffer_load_dwordx4 a[196:199], v1, s[4:7], s22 offen offset:1024
    s_add_u32 s22, s22, 2048
    buffer_load_dwordx4 a[200:203], v1, s[4:7], s22 offen offset:0
    buffer_load_dwordx4 a[204:207], v1, s[4:7], s22 offen offset:1024
    s_add_u32 s22, s22, 2048
    buffer_load_dwordx4 a[208:211], v1, s[4:7], s22 offen offset:0
    buffer_load_dwordx4 a[212:215], v1, s[4:7], s22 offen offset:1024
    s_add_u32 s22, s22, 2048
    buffer_load_dwordx4 a[216:219], v1, s[4:7], s22 offen offset:0
    buffer_load_dwordx4 a[220:223], v1, s[4:7], s22 offen offset:1024
    s_add_u32 s22, s22, 2048
    s_waitcnt vmcnt(40)
    buffer_load_dwordx4 a[224:227], v1, s[4:7], s22 offen offset:0
    buffer_load_dwordx4 a[228:231], v1, s[4:7], s22 offen offset:1024
    s_add_u32 s22, s22, 2048
    buffer_load_dwordx4 a[232:235], v1, s[4:7], s22 offen offset:0
    buffer_load_dwordx4 a[236:239], v1, s[4:7], s22 offen offset:1024
    s_add_u32 s22, s22, 2048
    buffer_load_dwordx4 a[240:243], v1, s[4:7], s22 offen offset:0
    buffer_load_dwordx4 a[244:247], v1, s[4:7], s22 offen offset:1024
    s_add_u32 s22, s22, 2048
    buffer_load_dwordx4 a[248:251], v1, s[4:7], s22 offen offset:0
    buffer_load_dwordx4 a[252:255], v1, s[4:7], s22 offen offset:1024
    s_add_u32 s22, s22, 2048
    buffer_load_dwordx4 v[120:123], v1, s[4:7], s22 offen offset:0
    buffer_load_dwordx4 v[124:127], v1, s[4:7], s22 offen offset:1024
    s_add_u32 s22, s22, 2048
    buffer_load_dwordx4 v[128:131], v1, s[4:7], s22 offen offset:0
    buffer_load_dwordx4 v[132:135], v1, s[4:7], s22 offen offset:1024
    s_add_u32 s22, s22, 2048
    buffer_load_dwordx4 v[136:139], v1, s[4:7], s22 offen offset:0
    buffer_load_dwordx4 v[140:143], v1, s[4:7], s22 offen offset:1024
    s_add_u32 s22, s22, 2048
    s_waitcnt vmcnt(40)
    buffer_load_dwordx4 v[144:147], v1, s[4:7], s22 offen offset:0
    buffer_load_dwordx4 v[148:151], v1, s[4:7], s22 offen offset:1024
    s_add_u32 s22, s22, 2048
    buffer_load_dwordx4 v[152:155], v1, s[4:7], s22 offen offset:0
    buffer_load_dwordx4 v[156:159], v1, s[4:7], s22 offen offset:1024
    s_add_u32 s22, s22, 2048
    buffer_load_dwordx4 v[160:163], v1, s[4:7], s22 offen offset:0
    buffer_load_dwordx4 v[164:167], v1, s[4:7], s22 offen offset:1024
    s_add_u32 s22, s22, 2048
    buffer_load_dwordx4 v[168:171], v1, s[4:7], s22 offen offset:0
    buffer_load_dwordx4 v[172:175], v1, s[4:7], s22 offen offset:1024
    s_add_u32 s22, s22, 2048
    buffer_load_dwordx4 v[176:179], v1, s[4:7], s22 offen offset:0
    buffer_load_dwordx4 v[180:183], v1, s[4:7], s22 offen offset:1024
    s_add_u32 s22, s22, 2048
    buffer_load_dwordx4 v[184:187], v1, s[4:7], s22 offen offset:0
    buffer_load_dwordx4 v[188:191], v1, s[4:7], s22 offen offset:1024
    s_add_u32 s22, s22, 2048
    buffer_load_dwordx4 v[192:195], v1, s[4:7], s22 offen offset:0
    buffer_load_dwordx4 v[196:199], v1, s[4:7], s22 offen offset:1024
    s_add_u32 s22, s22, 2048
    s_waitcnt vmcnt(40)
    buffer_load_dwordx4 v[200:203], v1, s[4:7], s22 offen offset:0
    buffer_load_dwordx4 v[204:207], v1, s[4:7], s22 offen offset:1024
    s_add_u32 s22, s22, 2048
    buffer_load_dwordx4 v[208:211], v1, s[4:7], s22 offen offset:0
    buffer_load_dwordx4 v[212:215], v1, s[4:7], s22 offen offset:1024
    s_add_u32 s22, s22, 2048
    buffer_load_dwordx4 v[216:219], v1, s[4:7], s22 offen offset:0
    buffer_load_dwordx4 v[220:223], v1, s[4:7], s22 offen offset:1024
    s_add_u32 s22, s22, 2048
    buffer_load_dwordx4 v[224:227], v1, s[4:7], s22 offen offset:0
    buffer_load_dwordx4 v[228:231], v1, s[4:7], s22 offen offset:1024
    s_add_u32 s22, s22, 2048
    buffer_load_dwordx4 v[232:235], v1, s[4:7], s22 offen offset:0
    buffer_load_dwordx4 v[236:239], v1, s[4:7], s22 offen offset:1024
    s_add_u32 s22, s22, 2048
    buffer_load_dwordx4 v[240:243], v1, s[4:7], s22 offen offset:0
    buffer_load_dwordx4 v[244:247], v1, s[4:7], s22 offen offset:1024
    s_add_u32 s22, s22, 2048
    buffer_load_dwordx4 v[248:251], v1, s[4:7], s22 offen offset:0
    buffer_load_dwordx4 v[252:255], v1, s[4:7], s22 offen offset:1024
    s_add_u32 s22, s22, 2048
    s_waitcnt vmcnt(40)
    s_cmp_lg_u32 s94, 0
    s_cbranch_scc1 Lvf_120
    v_and_b32 v17, 31, v0
    v_lshlrev_b32 v17, 2, v17
Lvf_119:
    buffer_load_dword v16, v17, s[12:15], 0 offen offset:128 sc1
    s_sub_u32 s19, s19, 1
    s_cbranch_scc1 main_kernel_exit
    s_waitcnt vmcnt(0)
    v_cmp_eq_u32 vcc, 0, v16
    s_cbranch_vccnz Lvf_119
    v_readfirstlane_b32 s94, v16
    s_nop 1
    v_cmp_ne_u32 vcc, s94, v16
    s_cbranch_vccnz main_kernel_census
Lvf_120:
    v_and_b32 v8, 8, v0
    v_and_b32 v10, 1, v0
    v_lshl_add_u32 v8, v10, 2, v8
    v_bfe_u32 v10, v0, 2, 1
    v_lshl_add_u32 v8, v10, 1, v8
    v_bfe_u32 v10, v0, 1, 1
    v_add_u32 v8, v8, v10
    v_lshrrev_b32 v10, 1, v4
    v_and_b32 v11, 1, v4
    v_lshlrev_b32 v5, 4, v8
    v_lshl_add_u32 v5, v10, 8, v5
    v_lshl_add_u32 v5, v11, 3, v5
    v_and_b32 v6, 13, v0
    v_lshlrev_b32 v6, 4, v6
    v_lshl_add_u32 v6, v10, 5, v6
    v_lshl_add_u32 v6, v11, 3, v6
    v_lshlrev_b32 v10, 3, v10
    v_lshl_add_u32 v10, v11, 1, v10
    v_sub_u32 v10, v8, v10
    v_cmp_le_i32 s[48:49], 0, v10
    v_cmp_le_i32 s[50:51], 4, v10
    v_cmp_le_i32 s[52:53], 1, v10
    v_cmp_le_i32 s[54:55], 5, v10
    v_lshlrev_b32 v8, 2, v8
    s_mul_i32 s26, s16, 6144
    v_add_u32 v7, s26, v1
    v_lshlrev_b32 v2, 4, v3
    v_lshl_add_u32 v9, v4, 2, v2
    v_mov_b32 v14, v1
    s_waitcnt vmcnt(0)
LT_121:
    buffer_load_dwordx4 v[96:99], v1, s[4:7], s24 offen offset:3072
    buffer_load_dwordx4 v[100:103], v1, s[4:7], s25 offen offset:3072
    s_waitcnt vmcnt(6)
    v_mfma_f32_16x16x32_bf16 v[16:19], a[0:3], v[72:75], 0
    v_mfma_f32_16x16x32_bf16 v[44:47], a[0:3], v[76:79], 0
    v_mfma_f32_16x16x32_bf16 v[20:23], a[56:59], v[72:75], 0
    v_mfma_f32_16x16x32_bf16 v[48:51], a[56:59], v[76:79], 0
    v_mfma_f32_16x16x32_bf16 v[24:27], a[112:115], v[72:75], 0
    v_mfma_f32_16x16x32_bf16 v[52:55], a[112:115], v[76:79], 0
    v_mfma_f32_16x16x32_bf16 v[28:31], a[168:171], v[72:75], 0
    v_mfma_f32_16x16x32_bf16 v[56:59], a[168:171], v[76:79], 0
    v_mfma_f32_16x16x32_bf16 v[32:35], a[224:227], v[72:75], 0
    v_mfma_f32_16x16x32_bf16 v[60:63], a[224:227], v[76:79], 0
    v_mfma_f32_16x16x32_bf16 v[36:39], v[144:147], v[72:75], 0
    v_mfma_f32_16x16x32_bf16 v[64:67], v[144:147], v[76:79], 0
    v_mfma_f32_16x16x32_bf16 v[40:43], v[200:203], v[72:75], 0
    v_mfma_f32_16x16x32_bf16 v[68:71], v[200:203], v[76:79], 0
    s_add_u32 s26, s24, 4096
    buffer_load_dwordx4 v[72:75], v1, s[4:7], s26 offen offset:0
    s_add_u32 s26, s25, 4096
    buffer_load_dwordx4 v[76:79], v1, s[4:7], s26 offen offset:0
    s_waitcnt vmcnt(6)
    v_mfma_f32_16x16x32_bf16 v[16:19], a[4:7], v[80:83], v[16:19]
    v_mfma_f32_16x16x32_bf16 v[44:47], a[4:7], v[84:87], v[44:47]
    v_mfma_f32_16x16x32_bf16 v[20:23], a[60:63], v[80:83], v[20:23]
    v_mfma_f32_16x16x32_bf16 v[48:51], a[60:63], v[84:87], v[48:51]
    v_mfma_f32_16x16x32_bf16 v[24:27], a[116:119], v[80:83], v[24:27]
    v_mfma_f32_16x16x32_bf16 v[52:55], a[116:119], v[84:87], v[52:55]
    v_mfma_f32_16x16x32_bf16 v[28:31], a[172:175], v[80:83], v[28:31]
    v_mfma_f32_16x16x32_bf16 v[56:59], a[172:175], v[84:87], v[56:59]
    v_mfma_f32_16x16x32_bf16 v[32:35], a[228:231], v[80:83], v[32:35]
    v_mfma_f32_16x16x32_bf16 v[60:63], a[228:231], v[84:87], v[60:63]
    v_mfma_f32_16x16x32_bf16 v[36:39], v[148:151], v[80:83], v[36:39]
    v_mfma_f32_16x16x32_bf16 v[64:67], v[148:151], v[84:87], v[64:67]
    v_mfma_f32_16x16x32_bf16 v[40:43], v[204:207], v[80:83], v[40:43]
    v_mfma_f32_16x16x32_bf16 v[68:71], v[204:207], v[84:87], v[68:71]
    s_add_u32 s26, s24, 4096
    buffer_load_dwordx4 v[80:83], v1, s[4:7], s26 offen offset:1024
    s_add_u32 s26, s25, 4096
    buffer_load_dwordx4 v[84:87], v1, s[4:7], s26 offen offset:1024
    s_waitcnt vmcnt(6)
    v_mfma_f32_16x16x32_bf16 v[16:19], a[8:11], v[88:91], v[16:19]
    v_mfma_f32_16x16x32_bf16 v[44:47], a[8:11], v[92:95], v[44:47]
    v_mfma_f32_16x16x32_bf16 v[20:23], a[64:67], v[88:91], v[20:23]
    v_mfma_f32_16x16x32_bf16 v[48:51], a[64:67], v[92:95], v[48:51]
    v_mfma_f32_16x16x32_bf16 v[24:27], a[120:123], v[88:91], v[24:27]
    v_mfma_f32_16x16x32_bf16 v[52:55], a[120:123], v[92:95], v[52:55]
    v_mfma_f32_16x16x32_bf16 v[28:31], a[176:179], v[88:91], v[28:31]
    v_mfma_f32_16x16x32_bf16 v[56:59], a[176:179], v[92:95], v[56:59]
    v_mfma_f32_16x16x32_bf16 v[32:35], a[232:235], v[88:91], v[32:35]
    v_mfma_f32_16x16x32_bf16 v[60:63], a[232:235], v[92:95], v[60:63]
    v_mfma_f32_16x16x32_bf16 v[36:39], v[152:155], v[88:91], v[36:39]
    v_mfma_f32_16x16x32_bf16 v[64:67], v[152:155], v[92:95], v[64:67]
    v_mfma_f32_16x16x32_bf16 v[40:43], v[208:211], v[88:91], v[40:43]
    v_mfma_f32_16x16x32_bf16 v[68:71], v[208:211], v[92:95], v[68:71]
    s_add_u32 s26, s24, 4096
    buffer_load_dwordx4 v[88:91], v1, s[4:7], s26 offen offset:2048
    s_add_u32 s26, s25, 4096
    buffer_load_dwordx4 v[92:95], v1, s[4:7], s26 offen offset:2048
    s_waitcnt vmcnt(6)
    v_mfma_f32_16x16x32_bf16 v[16:19], a[12:15], v[96:99], v[16:19]
    v_mfma_f32_16x16x32_bf16 v[44:47], a[12:15], v[100:103], v[44:47]
    v_mfma_f32_16x16x32_bf16 v[20:23], a[68:71], v[96:99], v[20:23]
    v_mfma_f32_16x16x32_bf16 v[48:51], a[68:71], v[100:103], v[48:51]
    v_mfma_f32_16x16x32_bf16 v[24:27], a[124:127], v[96:99], v[24:27]
    v_mfma_f32_16x16x32_bf16 v[52:55], a[124:127], v[100:103], v[52:55]
    v_mfma_f32_16x16x32_bf16 v[28:31], a[180:183], v[96:99], v[28:31]
    v_mfma_f32_16x16x32_bf16 v[56:59], a[180:183], v[100:103], v[56:59]
    v_mfma_f32_16x16x32_bf16 v[32:35], a[236:239], v[96:99], v[32:35]
    v_mfma_f32_16x16x32_bf16 v[60:63], a[236:239], v[100:103], v[60:63]
    v_mfma_f32_16x16x32_bf16 v[36:39], v[156:159], v[96:99], v[36:39]
    v_mfma_f32_16x16x32_bf16 v[64:67], v[156:159], v[100:103], v[64:67]
    v_mfma_f32_16x16x32_bf16 v[40:43], v[212:215], v[96:99], v[40:43]
    v_mfma_f32_16x16x32_bf16 v[68:71], v[212:215], v[100:103], v[68:71]
    s_add_u32 s26, s24, 4096
    buffer_load_dwordx4 v[96:99], v1, s[4:7], s26 offen offset:3072
    s_add_u32 s26, s25, 4096
    buffer_load_dwordx4 v[100:103], v1, s[4:7], s26 offen offset:3072
    s_waitcnt vmcnt(6)
    v_mfma_f32_16x16x32_bf16 v[16:19], a[16:19], v[72:75], v[16:19]
    v_mfma_f32_16x16x32_bf16 v[44:47], a[16:19], v[76:79], v[44:47]
    v_mfma_f32_16x16x32_bf16 v[20:23], a[72:75], v[72:75], v[20:23]
    v_mfma_f32_16x16x32_bf16 v[48:51], a[72:75], v[76:79], v[48:51]
    v_mfma_f32_16x16x32_bf16 v[24:27], a[128:131], v[72:75], v[24:27]
    v_mfma_f32_16x16x32_bf16 v[52:55], a[128:131], v[76:79], v[52:55]
    v_mfma_f32_16x16x32_bf16 v[28:31], a[184:187], v[72:75], v[28:31]
    v_mfma_f32_16x16x32_bf16 v[56:59], a[184:187], v[76:79], v[56:59]
    v_mfma_f32_16x16x32_bf16 v[32:35], a[240:243], v[72:75], v[32:35]
    v_mfma_f32_16x16x32_bf16 v[60:63], a[240:243], v[76:79], v[60:63]
    v_mfma_f32_16x16x32_bf16 v[36:39], v[160:163], v[72:75], v[36:39]
    v_mfma_f32_16x16x32_bf16 v[64:67], v[160:163], v[76:79], v[64:67]
    v_mfma_f32_16x16x32_bf16 v[40:43], v[216:219], v[72:75], v[40:43]
    v_mfma_f32_16x16x32_bf16 v[68:71], v[216:219], v[76:79], v[68:71]
    s_add_u32 s26, s24, 8192
    buffer_load_dwordx4 v[72:75], v1, s[4:7], s26 offen offset:0
    s_add_u32 s26, s25, 8192
    buffer_load_dwordx4 v[76:79], v1, s[4:7], s26 offen offset:0
    s_waitcnt vmcnt(6)
    v_mfma_f32_16x16x32_bf16 v[16:19], a[20:23], v[80:83], v[16:19]
    v_mfma_f32_16x16x32_bf16 v[44:47], a[20:23], v[84:87], v[44:47]
    v_mfma_f32_16x16x32_bf16 v[20:23], a[76:79], v[80:83], v[20:23]
    v_mfma_f32_16x16x32_bf16 v[48:51], a[76:79], v[84:87], v[48:51]
    v_mfma_f32_16x16x32_bf16 v[24:27], a[132:135], v[80:83], v[24:27]
    v_mfma_f32_16x16x32_bf16 v[52:55], a[132:135], v[84:87], v[52:55]
    v_mfma_f32_16x16x32_bf16 v[28:31], a[188:191], v[80:83], v[28:31]
    v_mfma_f32_16x16x32_bf16 v[56:59], a[188:191], v[84:87], v[56:59]
    v_mfma_f32_16x16x32_bf16 v[32:35], a[244:247], v[80:83], v[32:35]
    v_mfma_f32_16x16x32_bf16 v[60:63], a[244:247], v[84:87], v[60:63]
    v_mfma_f32_16x16x32_bf16 v[36:39], v[164:167], v[80:83], v[36:39]
    v_mfma_f32_16x16x32_bf16 v[64:67], v[164:167], v[84:87], v[64:67]
    v_mfma_f32_16x16x32_bf16 v[40:43], v[220:223], v[80:83], v[40:43]
    v_mfma_f32_16x16x32_bf16 v[68:71], v[220:223], v[84:87], v[68:71]
    s_add_u32 s26, s24, 8192
    buffer_load_dwordx4 v[80:83], v1, s[4:7], s26 offen offset:1024
    s_add_u32 s26, s25, 8192
    buffer_load_dwordx4 v[84:87], v1, s[4:7], s26 offen offset:1024
    s_waitcnt vmcnt(6)
    v_mfma_f32_16x16x32_bf16 v[16:19], a[24:27], v[88:91], v[16:19]
    v_mfma_f32_16x16x32_bf16 v[44:47], a[24:27], v[92:95], v[44:47]
    v_mfma_f32_16x16x32_bf16 v[20:23], a[80:83], v[88:91], v[20:23]
    v_mfma_f32_16x16x32_bf16 v[48:51], a[80:83], v[92:95], v[48:51]
    v_mfma_f32_16x16x32_bf16 v[24:27], a[136:139], v[88:91], v[24:27]
    v_mfma_f32_16x16x32_bf16 v[52:55], a[136:139], v[92:95], v[52:55]
    v_mfma_f32_16x16x32_bf16 v[28:31], a[192:195], v[88:91], v[28:31]
    v_mfma_f32_16x16x32_bf16 v[56:59], a[192:195], v[92:95], v[56:59]
    v_mfma_f32_16x16x32_bf16 v[32:35], a[248:251], v[88:91], v[32:35]
    v_mfma_f32_16x16x32_bf16 v[60:63], a[248:251], v[92:95], v[60:63]
    v_mfma_f32_16x16x32_bf16 v[36:39], v[168:171], v[88:91], v[36:39]
    v_mfma_f32_16x16x32_bf16 v[64:67], v[168:171], v[92:95], v[64:67]
    v_mfma_f32_16x16x32_bf16 v[40:43], v[224:227], v[88:91], v[40:43]
    v_mfma_f32_16x16x32_bf16 v[68:71], v[224:227], v[92:95], v[68:71]
    s_add_u32 s26, s24, 8192
    buffer_load_dwordx4 v[88:91], v1, s[4:7], s26 offen offset:2048
    s_add_u32 s26, s25, 8192
    buffer_load_dwordx4 v[92:95], v1, s[4:7], s26 offen offset:2048
    s_waitcnt vmcnt(6)
    v_mfma_f32_16x16x32_bf16 v[16:19], a[28:31], v[96:99], v[16:19]
    v_mfma_f32_16x16x32_bf16 v[44:47], a[28:31], v[100:103], v[44:47]
    v_mfma_f32_16x16x32_bf16 v[20:23], a[84:87], v[96:99], v[20:23]
    v_mfma_f32_16x16x32_bf16 v[48:51], a[84:87], v[100:103], v[48:51]
    v_mfma_f32_16x16x32_bf16 v[24:27], a[140:143], v[96:99], v[24:27]
    v_mfma_f32_16x16x32_bf16 v[52:55], a[140:143], v[100:103], v[52:55]
    v_mfma_f32_16x16x32_bf16 v[28:31], a[196:199], v[96:99], v[28:31]
    v_mfma_f32_16x16x32_bf16 v[56:59], a[196:199], v[100:103], v[56:59]
    v_mfma_f32_16x16x32_bf16 v[32:35], a[252:255], v[96:99], v[32:35]
    v_mfma_f32_16x16x32_bf16 v[60:63], a[252:255], v[100:103], v[60:63]
    v_mfma_f32_16x16x32_bf16 v[36:39], v[172:175], v[96:99], v[36:39]
    v_mfma_f32_16x16x32_bf16 v[64:67], v[172:175], v[100:103], v[64:67]
    v_mfma_f32_16x16x32_bf16 v[40:43], v[228:231], v[96:99], v[40:43]
    v_mfma_f32_16x16x32_bf16 v[68:71], v[228:231], v[100:103], v[68:71]
    s_add_u32 s26, s24, 8192
    buffer_load_dwordx4 v[96:99], v1, s[4:7], s26 offen offset:3072
    s_add_u32 s26, s25, 8192
    buffer_load_dwordx4 v[100:103], v1, s[4:7], s26 offen offset:3072
    s_waitcnt vmcnt(6)
    v_mfma_f32_16x16x32_bf16 v[16:19], a[32:35], v[72:75], v[16:19]
    v_mfma_f32_16x16x32_bf16 v[44:47], a[32:35], v[76:79], v[44:47]
    v_mfma_f32_16x16x32_bf16 v[20:23], a[88:91], v[72:75], v[20:23]
    v_mfma_f32_16x16x32_bf16 v[48:51], a[88:91], v[76:79], v[48:51]
    v_mfma_f32_16x16x32_bf16 v[24:27], a[144:147], v[72:75], v[24:27]
    v_mfma_f32_16x16x32_bf16 v[52:55], a[144:147], v[76:79], v[52:55]
    v_mfma_f32_16x16x32_bf16 v[28:31], a[200:203], v[72:75], v[28:31]
    v_mfma_f32_16x16x32_bf16 v[56:59], a[200:203], v[76:79], v[56:59]
    v_mfma_f32_16x16x32_bf16 v[32:35], v[120:123], v[72:75], v[32:35]
    v_mfma_f32_16x16x32_bf16 v[60:63], v[120:123], v[76:79], v[60:63]
    v_mfma_f32_16x16x32_bf16 v[36:39], v[176:179], v[72:75], v[36:39]
    v_mfma_f32_16x16x32_bf16 v[64:67], v[176:179], v[76:79], v[64:67]
    v_mfma_f32_16x16x32_bf16 v[40:43], v[232:235], v[72:75], v[40:43]
    v_mfma_f32_16x16x32_bf16 v[68:71], v[232:235], v[76:79], v[68:71]
    s_add_u32 s26, s24, 12288
    buffer_load_dwordx4 v[72:75], v1, s[4:7], s26 offen offset:0
    s_add_u32 s26, s25, 12288
    buffer_load_dwordx4 v[76:79], v1, s[4:7], s26 offen offset:0
    s_waitcnt vmcnt(6)
    v_mfma_f32_16x16x32_bf16 v[16:19], a[36:39], v[80:83], v[16:19]
    v_mfma_f32_16x16x32_bf16 v[44:47], a[36:39], v[84:87], v[44:47]
    v_mfma_f32_16x16x32_bf16 v[20:23], a[92:95], v[80:83], v[20:23]
    v_mfma_f32_16x16x32_bf16 v[48:51], a[92:95], v[84:87], v[48:51]
    v_mfma_f32_16x16x32_bf16 v[24:27], a[148:151], v[80:83], v[24:27]
    v_mfma_f32_16x16x32_bf16 v[52:55], a[148:151], v[84:87], v[52:55]
    v_mfma_f32_16x16x32_bf16 v[28:31], a[204:207], v[80:83], v[28:31]
    v_mfma_f32_16x16x32_bf16 v[56:59], a[204:207], v[84:87], v[56:59]
    v_mfma_f32_16x16x32_bf16 v[32:35], v[124:127], v[80:83], v[32:35]
    v_mfma_f32_16x16x32_bf16 v[60:63], v[124:127], v[84:87], v[60:63]
    v_mfma_f32_16x16x32_bf16 v[36:39], v[180:183], v[80:83], v[36:39]
    v_mfma_f32_16x16x32_bf16 v[64:67], v[180:183], v[84:87], v[64:67]
    v_mfma_f32_16x16x32_bf16 v[40:43], v[236:239], v[80:83], v[40:43]
    v_mfma_f32_16x16x32_bf16 v[68:71], v[236:239], v[84:87], v[68:71]
    s_add_u32 s26, s24, 12288
    buffer_load_dwordx4 v[80:83], v1, s[4:7], s26 offen offset:1024
    s_add_u32 s26, s25, 12288
    buffer_load_dwordx4 v[84:87], v1, s[4:7], s26 offen offset:1024
    s_waitcnt vmcnt(6)
    v_mfma_f32_16x16x32_bf16 v[16:19], a[40:43], v[88:91], v[16:19]
    v_mfma_f32_16x16x32_bf16 v[44:47], a[40:43], v[92:95], v[44:47]
    v_mfma_f32_16x16x32_bf16 v[20:23], a[96:99], v[88:91], v[20:23]
    v_mfma_f32_16x16x32_bf16 v[48:51], a[96:99], v[92:95], v[48:51]
    v_mfma_f32_16x16x32_bf16 v[24:27], a[152:155], v[88:91], v[24:27]
    v_mfma_f32_16x16x32_bf16 v[52:55], a[152:155], v[92:95], v[52:55]
    v_mfma_f32_16x16x32_bf16 v[28:31], a[208:211], v[88:91], v[28:31]
    v_mfma_f32_16x16x32_bf16 v[56:59], a[208:211], v[92:95], v[56:59]
    v_mfma_f32_16x16x32_bf16 v[32:35], v[128:131], v[88:91], v[32:35]
    v_mfma_f32_16x16x32_bf16 v[60:63], v[128:131], v[92:95], v[60:63]
    v_mfma_f32_16x16x32_bf16 v[36:39], v[184:187], v[88:91], v[36:39]
    v_mfma_f32_16x16x32_bf16 v[64:67], v[184:187], v[92:95], v[64:67]
    v_mfma_f32_16x16x32_bf16 v[40:43], v[240:243], v[88:91], v[40:43]
    v_mfma_f32_16x16x32_bf16 v[68:71], v[240:243], v[92:95], v[68:71]
    s_waitcnt vmcnt(4)
    v_mfma_f32_16x16x32_bf16 v[16:19], a[44:47], v[96:99], v[16:19]
    v_mfma_f32_16x16x32_bf16 v[44:47], a[44:47], v[100:103], v[44:47]
    v_mfma_f32_16x16x32_bf16 v[20:23], a[100:103], v[96:99], v[20:23]
    v_mfma_f32_16x16x32_bf16 v[48:51], a[100:103], v[100:103], v[48:51]
    v_mfma_f32_16x16x32_bf16 v[24:27], a[156:159], v[96:99], v[24:27]
    v_mfma_f32_16x16x32_bf16 v[52:55], a[156:159], v[100:103], v[52:55]
    v_mfma_f32_16x16x32_bf16 v[28:31], a[212:215], v[96:99], v[28:31]
    v_mfma_f32_16x16x32_bf16 v[56:59], a[212:215], v[100:103], v[56:59]
    v_mfma_f32_16x16x32_bf16 v[32:35], v[132:135], v[96:99], v[32:35]
    v_mfma_f32_16x16x32_bf16 v[60:63], v[132:135], v[100:103], v[60:63]
    v_mfma_f32_16x16x32_bf16 v[36:39], v[188:191], v[96:99], v[36:39]
    v_mfma_f32_16x16x32_bf16 v[64:67], v[188:191], v[100:103], v[64:67]
    v_mfma_f32_16x16x32_bf16 v[40:43], v[244:247], v[96:99], v[40:43]
    v_mfma_f32_16x16x32_bf16 v[68:71], v[244:247], v[100:103], v[68:71]
    s_waitcnt vmcnt(2)
    v_mfma_f32_16x16x32_bf16 v[16:19], a[48:51], v[72:75], v[16:19]
    v_mfma_f32_16x16x32_bf16 v[44:47], a[48:51], v[76:79], v[44:47]
    v_mfma_f32_16x16x32_bf16 v[20:23], a[104:107], v[72:75], v[20:23]
    v_mfma_f32_16x16x32_bf16 v[48:51], a[104:107], v[76:79], v[48:51]
    v_mfma_f32_16x16x32_bf16 v[24:27], a[160:163], v[72:75], v[24:27]
    v_mfma_f32_16x16x32_bf16 v[52:55], a[160:163], v[76:79], v[52:55]
    v_mfma_f32_16x16x32_bf16 v[28:31], a[216:219], v[72:75], v[28:31]
    v_mfma_f32_16x16x32_bf16 v[56:59], a[216:219], v[76:79], v[56:59]
    v_mfma_f32_16x16x32_bf16 v[32:35], v[136:139], v[72:75], v[32:35]
    v_mfma_f32_16x16x32_bf16 v[60:63], v[136:139], v[76:79], v[60:63]
    v_mfma_f32_16x16x32_bf16 v[36:39], v[192:195], v[72:75], v[36:39]
    v_mfma_f32_16x16x32_bf16 v[64:67], v[192:195], v[76:79], v[64:67]
    v_mfma_f32_16x16x32_bf16 v[40:43], v[248:251], v[72:75], v[40:43]
    v_mfma_f32_16x16x32_bf16 v[68:71], v[248:251], v[76:79], v[68:71]
    s_waitcnt vmcnt(0)
    v_mfma_f32_16x16x32_bf16 v[16:19], a[52:55], v[80:83], v[16:19]
    v_mfma_f32_16x16x32_bf16 v[44:47], a[52:55], v[84:87], v[44:47]
    v_mfma_f32_16x16x32_bf16 v[20:23], a[108:111], v[80:83], v[20:23]
    v_mfma_f32_16x16x32_bf16 v[48:51], a[108:111], v[84:87], v[48:51]
    v_mfma_f32_16x16x32_bf16 v[24:27], a[164:167], v[80:83], v[24:27]
    v_mfma_f32_16x16x32_bf16 v[52:55], a[164:167], v[84:87], v[52:55]
    v_mfma_f32_16x16x32_bf16 v[28:31], a[220:223], v[80:83], v[28:31]
    v_mfma_f32_16x16x32_bf16 v[56:59], a[220:223], v[84:87], v[56:59]
    v_mfma_f32_16x16x32_bf16 v[32:35], v[140:143], v[80:83], v[32:35]
    v_mfma_f32_16x16x32_bf16 v[60:63], v[140:143], v[84:87], v[60:63]
    v_mfma_f32_16x16x32_bf16 v[36:39], v[196:199], v[80:83], v[36:39]
    v_mfma_f32_16x16x32_bf16 v[64:67], v[196:199], v[84:87], v[64:67]
    v_mfma_f32_16x16x32_bf16 v[40:43], v[252:255], v[80:83], v[40:43]
    v_mfma_f32_16x16x32_bf16 v[68:71], v[252:255], v[84:87], v[68:71]
    s_mul_i32 s30, s20, 47104
    s_mul_i32 s22, s16, 3584
    s_add_u32 s30, s30, s22
    s_add_u32 s30, s30, 42223616
    s_add_u32 s31, s30, 14336
    s_mul_i32 s32, s20, 48128
    s_add_u32 s32, s32, 45314048
    s_mul_i32 s22, s16, 1792
    s_add_u32 s33, s32, s22
    s_lshl_b32 s34, s20, 7
    s_lshl_b32 s22, s16, 6
    s_add_u32 s34, s34, s22
    s_add_u32 s34, s34, 54759424
    v_cvt_pk_bf16_f32 v16, v16, v17
    v_cvt_pk_bf16_f32 v17, v18, v19
    buffer_load_dwordx2 v[18:19], v5, s[4:7], s30 offen offset:0
    v_cvt_pk_bf16_f32 v44, v44, v45
    v_cvt_pk_bf16_f32 v45, v46, v47
    buffer_load_dwordx2 v[46:47], v5, s[4:7], s31 offen offset:0
    v_cvt_pk_bf16_f32 v20, v20, v21
    v_cvt_pk_bf16_f32 v21, v22, v23
    buffer_load_dwordx2 v[22:23], v5, s[4:7], s30 offen offset:512
    v_cvt_pk_bf16_f32 v48, v48, v49
    v_cvt_pk_bf16_f32 v49, v50, v51
    buffer_load_dwordx2 v[50:51], v5, s[4:7], s31 offen offset:512
    v_cvt_pk_bf16_f32 v24, v24, v25
    v_cvt_pk_bf16_f32 v25, v26, v27
    buffer_load_dwordx2 v[26:27], v5, s[4:7], s30 offen offset:1024
    v_cvt_pk_bf16_f32 v52, v52, v53
    v_cvt_pk_bf16_f32 v53, v54, v55
    buffer_load_dwordx2 v[54:55], v5, s[4:7], s31 offen offset:1024
    v_cvt_pk_bf16_f32 v28, v28, v29
    v_cvt_pk_bf16_f32 v29, v30, v31
    buffer_load_dwordx2 v[30:31], v5, s[4:7], s30 offen offset:1536
    v_cvt_pk_bf16_f32 v56, v56, v57
    v_cvt_pk_bf16_f32 v57, v58, v59
    buffer_load_dwordx2 v[58:59], v5, s[4:7], s31 offen offset:1536
    v_cvt_pk_bf16_f32 v32, v32, v33
    v_cvt_pk_bf16_f32 v33, v34, v35
    buffer_load_dwordx2 v[34:35], v5, s[4:7], s30 offen offset:2048
    v_cvt_pk_bf16_f32 v60, v60, v61
    v_cvt_pk_bf16_f32 v61, v62, v63
    buffer_load_dwordx2 v[62:63], v5, s[4:7], s31 offen offset:2048
    v_cvt_pk_bf16_f32 v36, v36, v37
    v_cvt_pk_bf16_f32 v37, v38, v39
    buffer_load_dwordx2 v[38:39], v5, s[4:7], s30 offen offset:2560
    v_cvt_pk_bf16_f32 v64, v64, v65
    v_cvt_pk_bf16_f32 v65, v66, v67
    buffer_load_dwordx2 v[66:67], v5, s[4:7], s31 offen offset:2560
    v_cvt_pk_bf16_f32 v40, v40, v41
    v_cvt_pk_bf16_f32 v41, v42, v43
    buffer_load_dwordx2 v[42:43], v5, s[4:7], s30 offen offset:3072
    v_cvt_pk_bf16_f32 v68, v68, v69
    v_cvt_pk_bf16_f32 v69, v70, v71
    buffer_load_dwordx2 v[70:71], v5, s[4:7], s31 offen offset:3072
    buffer_load_dword v15, v8, s[4:7], s34 offen
    s_waitcnt vmcnt(0)
    v_mfma_f32_16x16x16_bf16 v[72:75], v[18:19], v[16:17], 0
    v_mfma_f32_16x16x16_bf16 v[76:79], v[18:19], v[44:45], 0
    v_mfma_f32_16x16x16_bf16 v[80:83], v[46:47], v[44:45], 0
    v_mfma_f32_16x16x16_bf16 v[72:75], v[22:23], v[20:21], v[72:75]
    v_mfma_f32_16x16x16_bf16 v[76:79], v[22:23], v[48:49], v[76:79]
    v_mfma_f32_16x16x16_bf16 v[80:83], v[50:51], v[48:49], v[80:83]
    v_mfma_f32_16x16x16_bf16 v[72:75], v[26:27], v[24:25], v[72:75]
    v_mfma_f32_16x16x16_bf16 v[76:79], v[26:27], v[52:53], v[76:79]
    v_mfma_f32_16x16x16_bf16 v[80:83], v[54:55], v[52:53], v[80:83]
    v_mfma_f32_16x16x16_bf16 v[72:75], v[30:31], v[28:29], v[72:75]
    v_mfma_f32_16x16x16_bf16 v[76:79], v[30:31], v[56:57], v[76:79]
    v_mfma_f32_16x16x16_bf16 v[80:83], v[58:59], v[56:57], v[80:83]
    v_mfma_f32_16x16x16_bf16 v[72:75], v[34:35], v[32:33], v[72:75]
    v_mfma_f32_16x16x16_bf16 v[76:79], v[34:35], v[60:61], v[76:79]
    v_mfma_f32_16x16x16_bf16 v[80:83], v[62:63], v[60:61], v[80:83]
    v_mfma_f32_16x16x16_bf16 v[72:75], v[38:39], v[36:37], v[72:75]
    v_mfma_f32_16x16x16_bf16 v[76:79], v[38:39], v[64:65], v[76:79]
    v_mfma_f32_16x16x16_bf16 v[80:83], v[66:67], v[64:65], v[80:83]
    v_mfma_f32_16x16x16_bf16 v[72:75], v[42:43], v[40:41], v[72:75]
    v_mfma_f32_16x16x16_bf16 v[76:79], v[42:43], v[68:69], v[76:79]
    v_mfma_f32_16x16x16_bf16 v[80:83], v[70:71], v[68:69], v[80:83]
    s_cmp_eq_u32 s20, 63
    s_cbranch_scc1 LS_122
    v_mov_b32 v11, 0
    s_mov_b64 exec, 1
Lww_123:
    buffer_load_dword v10, v11, s[4:7], s32 offen offset:0 sc1
    s_sub_u32 s19, s19, 1
    s_cbranch_scc1 main_kernel_exit
    s_waitcnt vmcnt(0)
    v_cmp_eq_u32 vcc, -1, v10
    s_cbranch_vccz Lww_124
    s_sleep 8
    s_branch Lww_123
Lww_124:
    s_mov_b64 exec, -1
LS_122:
LM_125:
    buffer_load_dwordx2 v[18:19], v6, s[4:7], s33 offen offset:0 sc1
    buffer_load_dwordx2 v[22:23], v6, s[4:7], s33 offen offset:256 sc1
    buffer_load_dwordx2 v[26:27], v6, s[4:7], s33 offen offset:512 sc1
    buffer_load_dwordx2 v[30:31], v6, s[4:7], s33 offen offset:768 sc1
    buffer_load_dwordx2 v[34:35], v6, s[4:7], s33 offen offset:1024 sc1
    buffer_load_dwordx2 v[38:39], v6, s[4:7], s33 offen offset:1280 sc1
    buffer_load_dwordx2 v[42:43], v6, s[4:7], s33 offen offset:1536 sc1
    s_sub_u32 s19, s19, 1
    s_cbranch_scc1 main_kernel_exit
    ds_write_b128 v7, v[72:75]
    ds_write_b128 v7, v[76:79] offset:3072
    ds_write_b128 v7, v[80:83] offset:4096
    s_waitcnt vmcnt(0)
    v_max_u32 v10, v18, v19
    v_max3_u32 v10, v10, v22, v23
    v_max3_u32 v10, v10, v26, v27
    v_max3_u32 v10, v10, v30, v31
    v_max3_u32 v10, v10, v34, v35
    v_max3_u32 v10, v10, v38, v39
    v_max3_u32 v10, v10, v42, v43
    v_cmp_eq_u32 vcc, -1, v10
    s_cbranch_vccz LM_126
    s_sleep 4
    s_branch LM_125
LM_126:
    v_mfma_f32_16x16x16_bf16 v[84:87], v[18:19], v[16:17], 0
    v_mfma_f32_16x16x16_bf16 v[88:91], v[18:19], v[44:45], 0
    v_mfma_f32_16x16x16_bf16 v[84:87], v[22:23], v[20:21], v[84:87]
    v_mfma_f32_16x16x16_bf16 v[88:91], v[22:23], v[48:49], v[88:91]
    v_mfma_f32_16x16x16_bf16 v[84:87], v[26:27], v[24:25], v[84:87]
    v_mfma_f32_16x16x16_bf16 v[88:91], v[26:27], v[52:53], v[88:91]
    v_mfma_f32_16x16x16_bf16 v[84:87], v[30:31], v[28:29], v[84:87]
    v_mfma_f32_16x16x16_bf16 v[88:91], v[30:31], v[56:57], v[88:91]
    v_mfma_f32_16x16x16_bf16 v[84:87], v[34:35], v[32:33], v[84:87]
    v_mfma_f32_16x16x16_bf16 v[88:91], v[34:35], v[60:61], v[88:91]
    v_mfma_f32_16x16x16_bf16 v[84:87], v[38:39], v[36:37], v[84:87]
    v_mfma_f32_16x16x16_bf16 v[88:91], v[38:39], v[64:65], v[88:91]
    v_mfma_f32_16x16x16_bf16 v[84:87], v[42:43], v[40:41], v[84:87]
    v_mfma_f32_16x16x16_bf16 v[88:91], v[42:43], v[68:69], v[88:91]
    s_nop 7
    ds_write_b64 v7, v[84:85] offset:2048
    ds_write_b64 v7, v[88:89] offset:5120
    s_mov_b32 s35, s20
    s_add_u32 s20, s20, 6
    s_min_u32 s31, s20, 63
    s_waitcnt lgkmcnt(0)
    s_barrier
    s_cmp_ge_u32 s16, 2
    s_cbranch_scc1 LN_127
    s_cmp_eq_u32 s16, 1
    s_cbranch_scc1 L1_128
    ds_read_b128 v[16:19], v14 offset:0
    ds_read_b64 v[24:25], v14 offset:2048
    ds_read_b128 v[28:31], v14 offset:6144
    ds_read_b64 v[36:37], v14 offset:8192
    ds_read_b128 v[40:43], v14 offset:12288
    ds_read_b64 v[48:49], v14 offset:14336
    ds_read_b128 v[52:55], v14 offset:18432
    ds_read_b64 v[60:61], v14 offset:20480
    v_mov_b32 v11, 0xff800000
    v_sub_f32 v15, 1.0, v15
    s_waitcnt lgkmcnt(0)
    v_add_f32 v16, v16, v28
    v_add_f32 v40, v40, v52
    v_add_f32 v17, v17, v29
    v_add_f32 v41, v41, v53
    v_add_f32 v18, v18, v30
    v_add_f32 v42, v42, v54
    v_add_f32 v19, v19, v31
    v_add_f32 v43, v43, v55
    v_add_f32 v24, v24, v36
    v_add_f32 v48, v48, v60
    v_add_f32 v25, v25, v37
    v_add_f32 v49, v49, v61
    v_add_f32 v16, v16, v40
    v_add_f32 v17, v17, v41
    v_add_f32 v18, v18, v42
    v_add_f32 v19, v19, v43
    v_add_f32 v24, v24, v48
    v_add_f32 v25, v25, v49
    v_cndmask_b32 v16, v11, v16, s[48:49]
    v_cndmask_b32 v17, v11, v17, s[50:51]
    v_cndmask_b32 v18, v11, v18, s[52:53]
    v_cndmask_b32 v19, v11, v19, s[54:55]
    v_max_f32 v10, v24, v25
    v_max3_f32 v10, v10, v16, v17
    v_max3_f32 v10, v10, v18, v19
    v_mov_b32 v12, v10
    s_nop 1
    v_permlane16_swap_b32 v10, v12
    v_max_f32 v10, v10, v12
    v_mov_b32 v12, v10
    s_nop 1
    v_permlane32_swap_b32 v10, v12
    v_max_f32 v10, v10, v12
    v_sub_f32 v16, v16, v10
    v_sub_f32 v17, v17, v10
    v_sub_f32 v18, v18, v10
    v_sub_f32 v19, v19, v10
    v_sub_f32 v24, v24, v10
    v_sub_f32 v25, v25, v10
    v_exp_f32 v16, v16
    v_exp_f32 v17, v17
    v_exp_f32 v18, v18
    v_exp_f32 v19, v19
    v_exp_f32 v24, v24
    v_exp_f32 v25, v25
    s_nop 0
    v_add_f32 v10, v24, v25
    v_add_f32 v10, v10, v16
    v_add_f32 v10, v10, v17
    v_add_f32 v10, v10, v18
    v_add_f32 v10, v10, v19
    v_mov_b32 v12, v10
    s_nop 1
    v_permlane16_swap_b32 v10, v12
    v_add_f32 v10, v10, v12
    v_mov_b32 v12, v10
    s_nop 1
    v_permlane32_swap_b32 v10, v12
    v_add_f32 v10, v10, v12
    v_rcp_f32 v10, v10
    s_nop 0
    v_mul_f32 v10, v10, v15
    v_mul_f32 v16, v16, v10
    v_mul_f32 v17, v17, v10
    v_mul_f32 v18, v18, v10
    v_mul_f32 v19, v19, v10
    v_mul_f32 v24, v24, v10
    v_mul_f32 v25, v25, v10
    v_cvt_pk_bf16_f32 v108, |v24|, |v25|
    ds_write_b32 v9, v108 offset:24576
    ds_read_b128 v[112:115], v2 offset:24576
    v_cvt_pk_bf16_f32 v104, |v16|, 0
    v_cvt_pk_bf16_f32 v105, |v17|, 0
    v_cvt_pk_bf16_f32 v106, |v18|, 0
    v_cvt_pk_bf16_f32 v107, |v19|, 0
    s_lshl_b32 s22, s17, 11
    s_add_u32 s22, s22, s32
    s_add_u32 s22, s22, 7168
    s_lshr_b32 s23, s17, 2
    s_lshl_b32 s23, s23, 11
    s_add_u32 s23, s23, s32
    s_add_u32 s23, s23, 39936
    s_and_b32 s26, s17, 3
    s_lshl_b32 s26, s26, 8
    s_add_u32 s23, s23, s26
    buffer_store_dwordx4 v[104:107], v1, s[4:7], s22 offen sc1
    s_mov_b64 exec, 0xffff
    s_waitcnt lgkmcnt(0)
    buffer_store_dwordx4 v[112:115], v2, s[4:7], s23 offen sc1
    s_mov_b64 exec, -1
    s_branch LN_127
L1_128:
    ds_read_b128 v[16:19], v14 offset:3072
    ds_read_b128 v[20:23], v14 offset:4096
    ds_read_b64 v[24:25], v14 offset:5120
    ds_read_b128 v[28:31], v14 offset:9216
    ds_read_b128 v[32:35], v14 offset:10240
    ds_read_b64 v[36:37], v14 offset:11264
    ds_read_b128 v[40:43], v14 offset:15360
    ds_read_b128 v[44:47], v14 offset:16384
    ds_read_b64 v[48:49], v14 offset:17408
    ds_read_b128 v[52:55], v14 offset:21504
    ds_read_b128 v[56:59], v14 offset:22528
    ds_read_b64 v[60:61], v14 offset:23552
    v_mov_b32 v11, 0xff800000
    v_sub_f32 v15, 1.0, v15
    s_waitcnt lgkmcnt(0)
    v_add_f32 v16, v16, v28
    v_add_f32 v40, v40, v52
    v_add_f32 v17, v17, v29
    v_add_f32 v41, v41, v53
    v_add_f32 v18, v18, v30
    v_add_f32 v42, v42, v54
    v_add_f32 v19, v19, v31
    v_add_f32 v43, v43, v55
    v_add_f32 v20, v20, v32
    v_add_f32 v44, v44, v56
    v_add_f32 v21, v21, v33
    v_add_f32 v45, v45, v57
    v_add_f32 v22, v22, v34
    v_add_f32 v46, v46, v58
    v_add_f32 v23, v23, v35
    v_add_f32 v47, v47, v59
    v_add_f32 v24, v24, v36
    v_add_f32 v48, v48, v60
    v_add_f32 v25, v25, v37
    v_add_f32 v49, v49, v61
    v_add_f32 v16, v16, v40
    v_add_f32 v17, v17, v41
    v_add_f32 v18, v18, v42
    v_add_f32 v19, v19, v43
    v_add_f32 v20, v20, v44
    v_add_f32 v21, v21, v45
    v_add_f32 v22, v22, v46
    v_add_f32 v23, v23, v47
    v_add_f32 v24, v24, v48
    v_add_f32 v25, v25, v49
    v_cndmask_b32 v20, v11, v20, s[48:49]
    v_cndmask_b32 v21, v11, v21, s[50:51]
    v_cndmask_b32 v22, v11, v22, s[52:53]
    v_cndmask_b32 v23, v11, v23, s[54:55]
    v_max_f32 v10, v24, v25
    v_max3_f32 v10, v10, v16, v17
    v_max3_f32 v10, v10, v18, v19
    v_max3_f32 v10, v10, v20, v21
    v_max3_f32 v10, v10, v22, v23
    v_mov_b32 v12, v10
    s_nop 1
    v_permlane16_swap_b32 v10, v12
    v_max_f32 v10, v10, v12
    v_mov_b32 v12, v10
    s_nop 1
    v_permlane32_swap_b32 v10, v12
    v_max_f32 v10, v10, v12
    v_sub_f32 v16, v16, v10
    v_sub_f32 v17, v17, v10
    v_sub_f32 v18, v18, v10
    v_sub_f32 v19, v19, v10
    v_sub_f32 v20, v20, v10
    v_sub_f32 v21, v21, v10
    v_sub_f32 v22, v22, v10
    v_sub_f32 v23, v23, v10
    v_sub_f32 v24, v24, v10
    v_sub_f32 v25, v25, v10
    v_exp_f32 v16, v16
    v_exp_f32 v17, v17
    v_exp_f32 v18, v18
    v_exp_f32 v19, v19
    v_exp_f32 v20, v20
    v_exp_f32 v21, v21
    v_exp_f32 v22, v22
    v_exp_f32 v23, v23
    v_exp_f32 v24, v24
    v_exp_f32 v25, v25
    s_nop 0
    v_add_f32 v10, v24, v25
    v_add_f32 v10, v10, v16
    v_add_f32 v10, v10, v17
    v_add_f32 v10, v10, v18
    v_add_f32 v10, v10, v19
    v_add_f32 v10, v10, v20
    v_add_f32 v10, v10, v21
    v_add_f32 v10, v10, v22
    v_add_f32 v10, v10, v23
    v_mov_b32 v12, v10
    s_nop 1
    v_permlane16_swap_b32 v10, v12
    v_add_f32 v10, v10, v12
    v_mov_b32 v12, v10
    s_nop 1
    v_permlane32_swap_b32 v10, v12
    v_add_f32 v10, v10, v12
    v_rcp_f32 v10, v10
    s_nop 0
    v_mul_f32 v10, v10, v15
    v_mul_f32 v16, v16, v10
    v_mul_f32 v17, v17, v10
    v_mul_f32 v18, v18, v10
    v_mul_f32 v19, v19, v10
    v_mul_f32 v20, v20, v10
    v_mul_f32 v21, v21, v10
    v_mul_f32 v22, v22, v10
    v_mul_f32 v23, v23, v10
    v_mul_f32 v24, v24, v10
    v_mul_f32 v25, v25, v10
    v_cvt_pk_bf16_f32 v108, |v24|, |v25|
    ds_write_b32 v9, v108 offset:24832
    ds_read_b128 v[112:115], v2 offset:24832
    v_cvt_pk_bf16_f32 v104, |v16|, |v20|
    v_cvt_pk_bf16_f32 v105, |v17|, |v21|
    v_cvt_pk_bf16_f32 v106, |v18|, |v22|
    v_cvt_pk_bf16_f32 v107, |v19|, |v23|
    s_lshl_b32 s22, s17, 11
    s_add_u32 s22, s22, s32
    s_add_u32 s22, s22, 8192
    s_lshr_b32 s23, s17, 2
    s_lshl_b32 s23, s23, 11
    s_add_u32 s23, s23, s32
    s_add_u32 s23, s23, 40960
    s_and_b32 s26, s17, 3
    s_lshl_b32 s26, s26, 8
    s_add_u32 s23, s23, s26
    buffer_store_dwordx4 v[104:107], v1, s[4:7], s22 offen sc1
    s_mov_b64 exec, 0xffff
    s_waitcnt lgkmcnt(0)
    buffer_store_dwordx4 v[112:115], v2, s[4:7], s23 offen sc1
    s_mov_b64 exec, -1
LN_127:
    v_xor_b32 v7, 0x8000, v7
    v_xor_b32 v14, 0x8000, v14
    s_mul_i32 s24, s31, 28672
    s_add_u32 s24, s24, 48402432
    s_add_u32 s25, s24, 14336
    buffer_load_dwordx4 v[72:75], v1, s[4:7], s24 offen offset:0
    buffer_load_dwordx4 v[76:79], v1, s[4:7], s25 offen offset:0
    buffer_load_dwordx4 v[80:83], v1, s[4:7], s24 offen offset:1024
    buffer_load_dwordx4 v[84:87], v1, s[4:7], s25 offen offset:1024
    buffer_load_dwordx4 v[88:91], v1, s[4:7], s24 offen offset:2048
    buffer_load_dwordx4 v[92:95], v1, s[4:7], s25 offen offset:2048
    s_cmp_lt_u32 s20, 64
    s_cbranch_scc1 LT_121
    s_branch main_kernel_exit
main_kernel_hg:
    s_sub_u32 s22, s22, 192
    s_lshr_b32 s17, s22, 3
    s_and_b32 s18, s22, 7
    s_cmp_lg_u32 s94, 0
    s_cbranch_scc1 Lvf_130
    v_and_b32 v17, 31, v0
    v_lshlrev_b32 v17, 2, v17
Lvf_129:
    buffer_load_dword v16, v17, s[12:15], 0 offen offset:128 sc1
    s_sub_u32 s19, s19, 1
    s_cbranch_scc1 main_kernel_exit
    s_waitcnt vmcnt(0)
    v_cmp_eq_u32 vcc, 0, v16
    s_cbranch_vccnz Lvf_129
    v_readfirstlane_b32 s94, v16
    s_nop 1
    v_cmp_ne_u32 vcc, s94, v16
    s_cbranch_vccnz main_kernel_census
Lvf_130:
    s_lshl_b32 s20, s18, 3
    s_lshl_b32 s27, s17, 2
    s_add_u32 s27, s27, s16
    s_load_dwordx2 s[52:53], s[0:1], 8
    s_load_dwordx2 s[56:57], s[0:1], 16
    s_mov_b32 s54, 1204224
    s_mov_b32 s55, 0x20000
    s_mov_b32 s58, 25088
    s_mov_b32 s59, 0x20000
    s_and_b32 s33, s18, 1
    s_mov_b32 s34, s27
    s_lshr_b32 s35, s18, 1
    v_lshlrev_b32 v1, 4, v0
    v_and_b32 v2, 15, v0
    v_lshrrev_b32 v3, 4, v0
    s_waitcnt lgkmcnt(0)
    s_cmp_ge_u32 s18, 6
    s_cbranch_scc1 LH_131
    v_bfe_u32 v6, v0, 3, 1
    v_lshlrev_b32 v6, 4, v6
    v_bfe_u32 v7, v0, 1, 1
    v_lshl_add_u32 v6, v7, 3, v6
    v_bfe_u32 v7, v0, 2, 1
    v_lshl_add_u32 v6, v7, 2, v6
    v_and_b32 v7, 1, v0
    v_add_u32 v6, v6, v7
    v_mul_u32_u24 v6, 2688, v6
    v_lshl_add_u32 v6, v3, 4, v6
    s_mul_i32 s22, s33, 602112
    s_mul_i32 s23, s35, 896
    s_add_u32 s22, s22, s23
    s_mul_i32 s23, s34, 56
    s_add_u32 s22, s22, s23
    s_add_u32 s23, s22, 0
    buffer_load_dwordx2 v[32:33], v6, s[52:55], s23 offen
    buffer_load_dwordx2 v[34:35], v6, s[52:55], s23 offen offset:8
    s_add_u32 s23, s22, 5376
    buffer_load_dwordx2 v[36:37], v6, s[52:55], s23 offen
    buffer_load_dwordx2 v[38:39], v6, s[52:55], s23 offen offset:8
    s_add_u32 s23, s22, 86016
    buffer_load_dwordx2 v[40:41], v6, s[52:55], s23 offen
    buffer_load_dwordx2 v[42:43], v6, s[52:55], s23 offen offset:8
    s_add_u32 s23, s22, 91392
    buffer_load_dwordx2 v[44:45], v6, s[52:55], s23 offen
    buffer_load_dwordx2 v[46:47], v6, s[52:55], s23 offen offset:8
    s_add_u32 s23, s22, 172032
    buffer_load_dwordx2 v[48:49], v6, s[52:55], s23 offen
    buffer_load_dwordx2 v[50:51], v6, s[52:55], s23 offen offset:8
    s_add_u32 s23, s22, 177408
    buffer_load_dwordx2 v[52:53], v6, s[52:55], s23 offen
    buffer_load_dwordx2 v[54:55], v6, s[52:55], s23 offen offset:8
    s_add_u32 s23, s22, 258048
    buffer_load_dwordx2 v[56:57], v6, s[52:55], s23 offen
    buffer_load_dwordx2 v[58:59], v6, s[52:55], s23 offen offset:8
    s_add_u32 s23, s22, 263424
    buffer_load_dwordx2 v[60:61], v6, s[52:55], s23 offen
    buffer_load_dwordx2 v[62:63], v6, s[52:55], s23 offen offset:8
    s_add_u32 s23, s22, 344064
    buffer_load_dwordx2 v[64:65], v6, s[52:55], s23 offen
    buffer_load_dwordx2 v[66:67], v6, s[52:55], s23 offen offset:8
    s_add_u32 s23, s22, 349440
    buffer_load_dwordx2 v[68:69], v6, s[52:55], s23 offen
    buffer_load_dwordx2 v[70:71], v6, s[52:55], s23 offen offset:8
    s_add_u32 s23, s22, 430080
    buffer_load_dwordx2 v[72:73], v6, s[52:55], s23 offen
    buffer_load_dwordx2 v[74:75], v6, s[52:55], s23 offen offset:8
    s_add_u32 s23, s22, 435456
    buffer_load_dwordx2 v[76:77], v6, s[52:55], s23 offen
    buffer_load_dwordx2 v[78:79], v6, s[52:55], s23 offen offset:8
    s_add_u32 s23, s22, 516096
    buffer_load_dwordx2 v[80:81], v6, s[52:55], s23 offen
    buffer_load_dwordx2 v[82:83], v6, s[52:55], s23 offen offset:8
    s_add_u32 s23, s22, 521472
    buffer_load_dwordx2 v[84:85], v6, s[52:55], s23 offen
    buffer_load_dwordx2 v[86:87], v6, s[52:55], s23 offen offset:8
    v_mul_u32_u24 v7, 448, v3
    v_lshl_add_u32 v7, v2, 1, v7
    v_mov_b32 v9, 0x80000000
    v_cmp_gt_u32 vcc, 12, v2
    s_mul_i32 s23, s34, 1568
    s_nop 0
    v_cndmask_b32 v8, v9, v7, vcc
    v_cmp_gt_u32 vcc, 3, v3
    s_nop 1
    v_cndmask_b32 v10, v9, v7, vcc
    v_cndmask_b32 v11, v9, v8, vcc
    buffer_load_ushort v104, v7, s[56:59], s23 offen offset:0
    buffer_load_ushort v105, v7, s[56:59], s23 offen offset:56
    buffer_load_ushort v106, v7, s[56:59], s23 offen offset:112
    buffer_load_ushort v107, v7, s[56:59], s23 offen offset:168
    buffer_load_ushort v108, v10, s[56:59], s23 offen offset:224
    buffer_load_ushort v109, v10, s[56:59], s23 offen offset:280
    buffer_load_ushort v110, v10, s[56:59], s23 offen offset:336
    buffer_load_ushort v111, v10, s[56:59], s23 offen offset:392
    buffer_load_ushort v112, v8, s[56:59], s23 offen offset:32
    buffer_load_ushort v113, v8, s[56:59], s23 offen offset:88
    buffer_load_ushort v114, v8, s[56:59], s23 offen offset:144
    buffer_load_ushort v115, v8, s[56:59], s23 offen offset:200
    buffer_load_ushort v116, v11, s[56:59], s23 offen offset:256
    buffer_load_ushort v117, v11, s[56:59], s23 offen offset:312
    buffer_load_ushort v118, v11, s[56:59], s23 offen offset:368
    buffer_load_ushort v119, v11, s[56:59], s23 offen offset:424
    s_waitcnt vmcnt(0)
    s_mov_b32 s30, 0x3fb8aa3b
    s_cmp_lg_u32 s35, 2
    s_cbranch_scc1 Lphi_132
    s_mov_b32 s30, 1.0
    v_lshlrev_b32 v7, 3, v3
    v_sub_u32 v7, v2, v7
    v_mov_b32 v8, 0x3f80
    v_cmp_gt_u32 vcc, 12, v2
    s_nop 1
    v_cndmask_b32 v9, 0, v8, vcc
    v_cmp_eq_u32 vcc, 0, v7
    s_nop 1
    v_cndmask_b32 v104, 0, v8, vcc
    v_cmp_eq_u32 vcc, 1, v7
    s_nop 1
    v_cndmask_b32 v105, 0, v8, vcc
    v_cmp_eq_u32 vcc, 2, v7
    s_nop 1
    v_cndmask_b32 v106, 0, v8, vcc
    v_cmp_eq_u32 vcc, 3, v7
    s_nop 1
    v_cndmask_b32 v107, 0, v8, vcc
    v_cmp_eq_u32 vcc, 4, v7
    s_nop 1
    v_cndmask_b32 v108, 0, v8, vcc
    v_cmp_eq_u32 vcc, 5, v7
    s_nop 1
    v_cndmask_b32 v109, 0, v8, vcc
    v_cmp_eq_u32 vcc, 6, v7
    s_nop 1
    v_cndmask_b32 v110, 0, v8, vcc
    v_cmp_eq_u32 vcc, 7, v7
    s_nop 1
    v_cndmask_b32 v111, 0, v8, vcc
    v_cmp_eq_u32 vcc, -16, v7
    s_nop 1
    v_cndmask_b32 v112, 0, v9, vcc
    v_cmp_eq_u32 vcc, -15, v7
    s_nop 1
    v_cndmask_b32 v113, 0, v9, vcc
    v_cmp_eq_u32 vcc, -14, v7
    s_nop 1
    v_cndmask_b32 v114, 0, v9, vcc
    v_cmp_eq_u32 vcc, -13, v7
    s_nop 1
    v_cndmask_b32 v115, 0, v9, vcc
    v_cmp_eq_u32 vcc, -12, v7
    s_nop 1
    v_cndmask_b32 v116, 0, v9, vcc
    v_cmp_eq_u32 vcc, -11, v7
    s_nop 1
    v_cndmask_b32 v117, 0, v9, vcc
    v_cmp_eq_u32 vcc, -10, v7
    s_nop 1
    v_cndmask_b32 v118, 0, v9, vcc
    v_cmp_eq_u32 vcc, -9, v7
    s_nop 1
    v_cndmask_b32 v119, 0, v9, vcc
Lphi_132:
    v_lshl_or_b32 v96, v105, 16, v104
    v_lshl_or_b32 v97, v107, 16, v106
    v_lshl_or_b32 v98, v109, 16, v108
    v_lshl_or_b32 v99, v111, 16, v110
    v_lshl_or_b32 v100, v113, 16, v112
    v_lshl_or_b32 v101, v115, 16, v114
    v_lshl_or_b32 v102, v117, 16, v116
    v_lshl_or_b32 v103, v119, 16, v118
    s_mul_i32 s31, s34, 86016
    s_mul_i32 s23, s35, 28672
    s_add_u32 s31, s31, s23
    s_mul_i32 s23, s33, 7168
    s_add_u32 s31, s31, s23
    s_add_u32 s31, s31, 50237440
    s_add_u32 s32, s31, 14336
    v_mfma_f32_16x16x32_bf16 v[124:127], v[32:35], v[96:99], 0
    v_mfma_f32_16x16x32_bf16 v[128:131], v[36:39], v[96:99], 0
    v_mfma_f32_16x16x32_bf16 v[132:135], v[32:35], v[100:103], 0
    v_mfma_f32_16x16x32_bf16 v[136:139], v[36:39], v[100:103], 0
    v_mfma_f32_16x16x32_bf16 v[140:143], v[40:43], v[96:99], 0
    v_mfma_f32_16x16x32_bf16 v[144:147], v[44:47], v[96:99], 0
    v_mfma_f32_16x16x32_bf16 v[148:151], v[40:43], v[100:103], 0
    v_mfma_f32_16x16x32_bf16 v[152:155], v[44:47], v[100:103], 0
    v_mfma_f32_16x16x32_bf16 v[156:159], v[48:51], v[96:99], 0
    v_mfma_f32_16x16x32_bf16 v[160:163], v[52:55], v[96:99], 0
    v_mfma_f32_16x16x32_bf16 v[164:167], v[48:51], v[100:103], 0
    v_mfma_f32_16x16x32_bf16 v[168:171], v[52:55], v[100:103], 0
    v_mfma_f32_16x16x32_bf16 v[172:175], v[56:59], v[96:99], 0
    v_mfma_f32_16x16x32_bf16 v[176:179], v[60:63], v[96:99], 0
    v_mfma_f32_16x16x32_bf16 v[180:183], v[56:59], v[100:103], 0
    v_mfma_f32_16x16x32_bf16 v[184:187], v[60:63], v[100:103], 0
    v_mfma_f32_16x16x32_bf16 v[188:191], v[64:67], v[96:99], 0
    v_mfma_f32_16x16x32_bf16 v[192:195], v[68:71], v[96:99], 0
    v_mfma_f32_16x16x32_bf16 v[196:199], v[64:67], v[100:103], 0
    v_mfma_f32_16x16x32_bf16 v[200:203], v[68:71], v[100:103], 0
    v_mfma_f32_16x16x32_bf16 v[204:207], v[72:75], v[96:99], 0
    v_mfma_f32_16x16x32_bf16 v[208:211], v[76:79], v[96:99], 0
    v_mfma_f32_16x16x32_bf16 v[212:215], v[72:75], v[100:103], 0
    v_mfma_f32_16x16x32_bf16 v[216:219], v[76:79], v[100:103], 0
    v_mfma_f32_16x16x32_bf16 v[220:223], v[80:83], v[96:99], 0
    v_mfma_f32_16x16x32_bf16 v[224:227], v[84:87], v[96:99], 0
    v_mfma_f32_16x16x32_bf16 v[228:231], v[80:83], v[100:103], 0
    v_mfma_f32_16x16x32_bf16 v[232:235], v[84:87], v[100:103], 0
    s_nop 7
    v_mul_f32 v124, s30, v124
    v_mul_f32 v125, s30, v125
    v_mul_f32 v126, s30, v126
    v_mul_f32 v127, s30, v127
    v_mul_f32 v128, s30, v128
    v_mul_f32 v129, s30, v129
    v_mul_f32 v130, s30, v130
    v_mul_f32 v131, s30, v131
    v_cvt_pk_bf16_f32 v124, v124, v125
    v_cvt_pk_bf16_f32 v125, v126, v127
    v_cvt_pk_bf16_f32 v126, v128, v129
    v_cvt_pk_bf16_f32 v127, v130, v131
    buffer_store_dwordx4 v[124:127], v1, s[4:7], s31 offen offset:0 sc1
    v_mul_f32 v132, s30, v132
    v_mul_f32 v133, s30, v133
    v_mul_f32 v134, s30, v134
    v_mul_f32 v135, s30, v135
    v_mul_f32 v136, s30, v136
    v_mul_f32 v137, s30, v137
    v_mul_f32 v138, s30, v138
    v_mul_f32 v139, s30, v139
    v_cvt_pk_bf16_f32 v132, v132, v133
    v_cvt_pk_bf16_f32 v133, v134, v135
    v_cvt_pk_bf16_f32 v134, v136, v137
    v_cvt_pk_bf16_f32 v135, v138, v139
    buffer_store_dwordx4 v[132:135], v1, s[4:7], s32 offen offset:0 sc1
    v_mul_f32 v140, s30, v140
    v_mul_f32 v141, s30, v141
    v_mul_f32 v142, s30, v142
    v_mul_f32 v143, s30, v143
    v_mul_f32 v144, s30, v144
    v_mul_f32 v145, s30, v145
    v_mul_f32 v146, s30, v146
    v_mul_f32 v147, s30, v147
    v_cvt_pk_bf16_f32 v140, v140, v141
    v_cvt_pk_bf16_f32 v141, v142, v143
    v_cvt_pk_bf16_f32 v142, v144, v145
    v_cvt_pk_bf16_f32 v143, v146, v147
    buffer_store_dwordx4 v[140:143], v1, s[4:7], s31 offen offset:1024 sc1
    v_mul_f32 v148, s30, v148
    v_mul_f32 v149, s30, v149
    v_mul_f32 v150, s30, v150
    v_mul_f32 v151, s30, v151
    v_mul_f32 v152, s30, v152
    v_mul_f32 v153, s30, v153
    v_mul_f32 v154, s30, v154
    v_mul_f32 v155, s30, v155
    v_cvt_pk_bf16_f32 v148, v148, v149
    v_cvt_pk_bf16_f32 v149, v150, v151
    v_cvt_pk_bf16_f32 v150, v152, v153
    v_cvt_pk_bf16_f32 v151, v154, v155
    buffer_store_dwordx4 v[148:151], v1, s[4:7], s32 offen offset:1024 sc1
    v_mul_f32 v156, s30, v156
    v_mul_f32 v157, s30, v157
    v_mul_f32 v158, s30, v158
    v_mul_f32 v159, s30, v159
    v_mul_f32 v160, s30, v160
    v_mul_f32 v161, s30, v161
    v_mul_f32 v162, s30, v162
    v_mul_f32 v163, s30, v163
    v_cvt_pk_bf16_f32 v156, v156, v157
    v_cvt_pk_bf16_f32 v157, v158, v159
    v_cvt_pk_bf16_f32 v158, v160, v161
    v_cvt_pk_bf16_f32 v159, v162, v163
    buffer_store_dwordx4 v[156:159], v1, s[4:7], s31 offen offset:2048 sc1
    v_mul_f32 v164, s30, v164
    v_mul_f32 v165, s30, v165
    v_mul_f32 v166, s30, v166
    v_mul_f32 v167, s30, v167
    v_mul_f32 v168, s30, v168
    v_mul_f32 v169, s30, v169
    v_mul_f32 v170, s30, v170
    v_mul_f32 v171, s30, v171
    v_cvt_pk_bf16_f32 v164, v164, v165
    v_cvt_pk_bf16_f32 v165, v166, v167
    v_cvt_pk_bf16_f32 v166, v168, v169
    v_cvt_pk_bf16_f32 v167, v170, v171
    buffer_store_dwordx4 v[164:167], v1, s[4:7], s32 offen offset:2048 sc1
    v_mul_f32 v172, s30, v172
    v_mul_f32 v173, s30, v173
    v_mul_f32 v174, s30, v174
    v_mul_f32 v175, s30, v175
    v_mul_f32 v176, s30, v176
    v_mul_f32 v177, s30, v177
    v_mul_f32 v178, s30, v178
    v_mul_f32 v179, s30, v179
    v_cvt_pk_bf16_f32 v172, v172, v173
    v_cvt_pk_bf16_f32 v173, v174, v175
    v_cvt_pk_bf16_f32 v174, v176, v177
    v_cvt_pk_bf16_f32 v175, v178, v179
    buffer_store_dwordx4 v[172:175], v1, s[4:7], s31 offen offset:3072 sc1
    v_mul_f32 v180, s30, v180
    v_mul_f32 v181, s30, v181
    v_mul_f32 v182, s30, v182
    v_mul_f32 v183, s30, v183
    v_mul_f32 v184, s30, v184
    v_mul_f32 v185, s30, v185
    v_mul_f32 v186, s30, v186
    v_mul_f32 v187, s30, v187
    v_cvt_pk_bf16_f32 v180, v180, v181
    v_cvt_pk_bf16_f32 v181, v182, v183
    v_cvt_pk_bf16_f32 v182, v184, v185
    v_cvt_pk_bf16_f32 v183, v186, v187
    buffer_store_dwordx4 v[180:183], v1, s[4:7], s32 offen offset:3072 sc1
    s_add_u32 s31, s31, 4096
    s_add_u32 s32, s32, 4096
    v_mul_f32 v188, s30, v188
    v_mul_f32 v189, s30, v189
    v_mul_f32 v190, s30, v190
    v_mul_f32 v191, s30, v191
    v_mul_f32 v192, s30, v192
    v_mul_f32 v193, s30, v193
    v_mul_f32 v194, s30, v194
    v_mul_f32 v195, s30, v195
    v_cvt_pk_bf16_f32 v188, v188, v189
    v_cvt_pk_bf16_f32 v189, v190, v191
    v_cvt_pk_bf16_f32 v190, v192, v193
    v_cvt_pk_bf16_f32 v191, v194, v195
    buffer_store_dwordx4 v[188:191], v1, s[4:7], s31 offen offset:0 sc1
    v_mul_f32 v196, s30, v196
    v_mul_f32 v197, s30, v197
    v_mul_f32 v198, s30, v198
    v_mul_f32 v199, s30, v199
    v_mul_f32 v200, s30, v200
    v_mul_f32 v201, s30, v201
    v_mul_f32 v202, s30, v202
    v_mul_f32 v203, s30, v203
    v_cvt_pk_bf16_f32 v196, v196, v197
    v_cvt_pk_bf16_f32 v197, v198, v199
    v_cvt_pk_bf16_f32 v198, v200, v201
    v_cvt_pk_bf16_f32 v199, v202, v203
    buffer_store_dwordx4 v[196:199], v1, s[4:7], s32 offen offset:0 sc1
    v_mul_f32 v204, s30, v204
    v_mul_f32 v205, s30, v205
    v_mul_f32 v206, s30, v206
    v_mul_f32 v207, s30, v207
    v_mul_f32 v208, s30, v208
    v_mul_f32 v209, s30, v209
    v_mul_f32 v210, s30, v210
    v_mul_f32 v211, s30, v211
    v_cvt_pk_bf16_f32 v204, v204, v205
    v_cvt_pk_bf16_f32 v205, v206, v207
    v_cvt_pk_bf16_f32 v206, v208, v209
    v_cvt_pk_bf16_f32 v207, v210, v211
    buffer_store_dwordx4 v[204:207], v1, s[4:7], s31 offen offset:1024 sc1
    v_mul_f32 v212, s30, v212
    v_mul_f32 v213, s30, v213
    v_mul_f32 v214, s30, v214
    v_mul_f32 v215, s30, v215
    v_mul_f32 v216, s30, v216
    v_mul_f32 v217, s30, v217
    v_mul_f32 v218, s30, v218
    v_mul_f32 v219, s30, v219
    v_cvt_pk_bf16_f32 v212, v212, v213
    v_cvt_pk_bf16_f32 v213, v214, v215
    v_cvt_pk_bf16_f32 v214, v216, v217
    v_cvt_pk_bf16_f32 v215, v218, v219
    buffer_store_dwordx4 v[212:215], v1, s[4:7], s32 offen offset:1024 sc1
    v_mul_f32 v220, s30, v220
    v_mul_f32 v221, s30, v221
    v_mul_f32 v222, s30, v222
    v_mul_f32 v223, s30, v223
    v_mul_f32 v224, s30, v224
    v_mul_f32 v225, s30, v225
    v_mul_f32 v226, s30, v226
    v_mul_f32 v227, s30, v227
    v_cvt_pk_bf16_f32 v220, v220, v221
    v_cvt_pk_bf16_f32 v221, v222, v223
    v_cvt_pk_bf16_f32 v222, v224, v225
    v_cvt_pk_bf16_f32 v223, v226, v227
    buffer_store_dwordx4 v[220:223], v1, s[4:7], s31 offen offset:2048 sc1
    v_mul_f32 v228, s30, v228
    v_mul_f32 v229, s30, v229
    v_mul_f32 v230, s30, v230
    v_mul_f32 v231, s30, v231
    v_mul_f32 v232, s30, v232
    v_mul_f32 v233, s30, v233
    v_mul_f32 v234, s30, v234
    v_mul_f32 v235, s30, v235
    v_cvt_pk_bf16_f32 v228, v228, v229
    v_cvt_pk_bf16_f32 v229, v230, v231
    v_cvt_pk_bf16_f32 v230, v232, v233
    v_cvt_pk_bf16_f32 v231, v234, v235
    buffer_store_dwordx4 v[228:231], v1, s[4:7], s32 offen offset:2048 sc1
LH_131:
    s_lshl_b32 s30, s17, 7
    s_add_u32 s30, s30, 54772224
    s_waitcnt vmcnt(0)
    s_barrier
    s_cmp_lg_u32 s16, 0
    s_cbranch_scc1 Lsg_133
    v_mov_b32 v12, 1
    v_mov_b32 v13, 0
    s_mov_b64 exec, 1
    buffer_atomic_add v12, v13, s[4:7], s30 offen
    s_mov_b64 exec, -1
Lsg_133:
    v_mov_b32 v13, 0
Lpc_134:
    buffer_load_dword v12, v13, s[4:7], s30 offen sc1
    s_sub_u32 s19, s19, 1
    s_cbranch_scc1 main_kernel_exit
    s_waitcnt vmcnt(0)
    v_cmp_le_u32 vcc, 8, v12
    s_sleep 8
    s_cbranch_vccz Lpc_134
    v_lshlrev_b32 v1, 4, v0
    v_and_b32 v3, 15, v0
    v_lshrrev_b32 v4, 4, v0
    s_mul_i32 s24, s20, 28672
    s_add_u32 s24, s24, 48402432
    s_add_u32 s25, s24, 14336
    buffer_load_dwordx4 v[64:67], v1, s[4:7], s24 offen offset:0
    buffer_load_dwordx4 v[68:71], v1, s[4:7], s25 offen offset:0
    buffer_load_dwordx4 v[72:75], v1, s[4:7], s24 offen offset:1024
    buffer_load_dwordx4 v[76:79], v1, s[4:7], s25 offen offset:1024
    buffer_load_dwordx4 v[80:83], v1, s[4:7], s24 offen offset:2048
    buffer_load_dwordx4 v[84:87], v1, s[4:7], s25 offen offset:2048
    s_mul_i32 s22, s27, 86016
    s_add_u32 s22, s22, 50237440
    buffer_load_dwordx4 a[0:3], v1, s[4:7], s22 offen offset:0 sc1
    buffer_load_dwordx4 a[4:7], v1, s[4:7], s22 offen offset:1024 sc1
    buffer_load_dwordx4 a[8:11], v1, s[4:7], s22 offen offset:2048 sc1
    buffer_load_dwordx4 a[12:15], v1, s[4:7], s22 offen offset:3072 sc1
    s_add_u32 s22, s22, 4096
    buffer_load_dwordx4 a[16:19], v1, s[4:7], s22 offen offset:0 sc1
    buffer_load_dwordx4 a[20:23], v1, s[4:7], s22 offen offset:1024 sc1
    buffer_load_dwordx4 a[24:27], v1, s[4:7], s22 offen offset:2048 sc1
    buffer_load_dwordx4 a[28:31], v1, s[4:7], s22 offen offset:3072 sc1
    s_add_u32 s22, s22, 4096
    buffer_load_dwordx4 a[32:35], v1, s[4:7], s22 offen offset:0 sc1
    buffer_load_dwordx4 a[36:39], v1, s[4:7], s22 offen offset:1024 sc1
    buffer_load_dwordx4 a[40:43], v1, s[4:7], s22 offen offset:2048 sc1
    buffer_load_dwordx4 a[44:47], v1, s[4:7], s22 offen offset:3072 sc1
    s_add_u32 s22, s22, 4096
    buffer_load_dwordx4 a[48:51], v1, s[4:7], s22 offen offset:0 sc1
    buffer_load_dwordx4 a[52:55], v1, s[4:7], s22 offen offset:1024 sc1
    buffer_load_dwordx4 a[56:59], v1, s[4:7], s22 offen offset:2048 sc1
    buffer_load_dwordx4 a[60:63], v1, s[4:7], s22 offen offset:3072 sc1
    s_add_u32 s22, s22, 4096
    buffer_load_dwordx4 a[64:67], v1, s[4:7], s22 offen offset:0 sc1
    buffer_load_dwordx4 a[68:71], v1, s[4:7], s22 offen offset:1024 sc1
    buffer_load_dwordx4 a[72:75], v1, s[4:7], s22 offen offset:2048 sc1
    buffer_load_dwordx4 a[76:79], v1, s[4:7], s22 offen offset:3072 sc1
    s_add_u32 s22, s22, 4096
    buffer_load_dwordx4 a[80:83], v1, s[4:7], s22 offen offset:0 sc1
    buffer_load_dwordx4 a[84:87], v1, s[4:7], s22 offen offset:1024 sc1
    buffer_load_dwordx4 a[88:91], v1, s[4:7], s22 offen offset:2048 sc1
    buffer_load_dwordx4 a[92:95], v1, s[4:7], s22 offen offset:3072 sc1
    s_add_u32 s22, s22, 4096
    buffer_load_dwordx4 a[96:99], v1, s[4:7], s22 offen offset:0 sc1
    buffer_load_dwordx4 a[100:103], v1, s[4:7], s22 offen offset:1024 sc1
    buffer_load_dwordx4 a[104:107], v1, s[4:7], s22 offen offset:2048 sc1
    buffer_load_dwordx4 a[108:111], v1, s[4:7], s22 offen offset:3072 sc1
    s_add_u32 s22, s22, 4096
    buffer_load_dwordx4 a[112:115], v1, s[4:7], s22 offen offset:0 sc1
    buffer_load_dwordx4 a[116:119], v1, s[4:7], s22 offen offset:1024 sc1
    buffer_load_dwordx4 a[120:123], v1, s[4:7], s22 offen offset:2048 sc1
    buffer_load_dwordx4 a[124:127], v1, s[4:7], s22 offen offset:3072 sc1
    s_add_u32 s22, s22, 4096
    buffer_load_dwordx4 a[128:131], v1, s[4:7], s22 offen offset:0 sc1
    buffer_load_dwordx4 a[132:135], v1, s[4:7], s22 offen offset:1024 sc1
    buffer_load_dwordx4 a[136:139], v1, s[4:7], s22 offen offset:2048 sc1
    buffer_load_dwordx4 a[140:143], v1, s[4:7], s22 offen offset:3072 sc1
    s_add_u32 s22, s22, 4096
    buffer_load_dwordx4 a[144:147], v1, s[4:7], s22 offen offset:0 sc1
    buffer_load_dwordx4 a[148:151], v1, s[4:7], s22 offen offset:1024 sc1
    buffer_load_dwordx4 a[152:155], v1, s[4:7], s22 offen offset:2048 sc1
    buffer_load_dwordx4 a[156:159], v1, s[4:7], s22 offen offset:3072 sc1
    s_add_u32 s22, s22, 4096
    buffer_load_dwordx4 a[160:163], v1, s[4:7], s22 offen offset:0 sc1
    buffer_load_dwordx4 a[164:167], v1, s[4:7], s22 offen offset:1024 sc1
    buffer_load_dwordx4 a[168:171], v1, s[4:7], s22 offen offset:2048 sc1
    buffer_load_dwordx4 a[172:175], v1, s[4:7], s22 offen offset:3072 sc1
    s_add_u32 s22, s22, 4096
    buffer_load_dwordx4 a[176:179], v1, s[4:7], s22 offen offset:0 sc1
    buffer_load_dwordx4 a[180:183], v1, s[4:7], s22 offen offset:1024 sc1
    buffer_load_dwordx4 a[184:187], v1, s[4:7], s22 offen offset:2048 sc1
    buffer_load_dwordx4 a[188:191], v1, s[4:7], s22 offen offset:3072 sc1
    s_add_u32 s22, s22, 4096
    s_waitcnt vmcnt(40)
    buffer_load_dwordx4 a[192:195], v1, s[4:7], s22 offen offset:0 sc1
    buffer_load_dwordx4 a[196:199], v1, s[4:7], s22 offen offset:1024 sc1
    buffer_load_dwordx4 a[200:203], v1, s[4:7], s22 offen offset:2048 sc1
    buffer_load_dwordx4 a[204:207], v1, s[4:7], s22 offen offset:3072 sc1
    s_add_u32 s22, s22, 4096
    buffer_load_dwordx4 a[208:211], v1, s[4:7], s22 offen offset:0 sc1
    buffer_load_dwordx4 a[212:215], v1, s[4:7], s22 offen offset:1024 sc1
    buffer_load_dwordx4 a[216:219], v1, s[4:7], s22 offen offset:2048 sc1
    buffer_load_dwordx4 a[220:223], v1, s[4:7], s22 offen offset:3072 sc1
    s_add_u32 s22, s22, 4096
    buffer_load_dwordx4 a[224:227], v1, s[4:7], s22 offen offset:0 sc1
    buffer_load_dwordx4 a[228:231], v1, s[4:7], s22 offen offset:1024 sc1
    buffer_load_dwordx4 a[232:235], v1, s[4:7], s22 offen offset:2048 sc1
    buffer_load_dwordx4 a[236:239], v1, s[4:7], s22 offen offset:3072 sc1
    s_add_u32 s22, s22, 4096
    s_waitcnt vmcnt(40)
    buffer_load_dwordx4 a[240:243], v1, s[4:7], s22 offen offset:0 sc1
    buffer_load_dwordx4 a[244:247], v1, s[4:7], s22 offen offset:1024 sc1
    buffer_load_dwordx4 a[248:251], v1, s[4:7], s22 offen offset:2048 sc1
    buffer_load_dwordx4 a[252:255], v1, s[4:7], s22 offen offset:3072 sc1
    s_add_u32 s22, s22, 4096
    buffer_load_dwordx4 v[176:179], v1, s[4:7], s22 offen offset:0 sc1
    buffer_load_dwordx4 v[180:183], v1, s[4:7], s22 offen offset:1024 sc1
    buffer_load_dwordx4 v[184:187], v1, s[4:7], s22 offen offset:2048 sc1
    buffer_load_dwordx4 v[188:191], v1, s[4:7], s22 offen offset:3072 sc1
    s_add_u32 s22, s22, 4096
    buffer_load_dwordx4 v[192:195], v1, s[4:7], s22 offen offset:0 sc1
    buffer_load_dwordx4 v[196:199], v1, s[4:7], s22 offen offset:1024 sc1
    buffer_load_dwordx4 v[200:203], v1, s[4:7], s22 offen offset:2048 sc1
    buffer_load_dwordx4 v[204:207], v1, s[4:7], s22 offen offset:3072 sc1
    s_add_u32 s22, s22, 4096
    s_waitcnt vmcnt(40)
    buffer_load_dwordx4 v[208:211], v1, s[4:7], s22 offen offset:0 sc1
    buffer_load_dwordx4 v[212:215], v1, s[4:7], s22 offen offset:1024 sc1
    buffer_load_dwordx4 v[216:219], v1, s[4:7], s22 offen offset:2048 sc1
    buffer_load_dwordx4 v[220:223], v1, s[4:7], s22 offen offset:3072 sc1
    s_add_u32 s22, s22, 4096
    buffer_load_dwordx4 v[224:227], v1, s[4:7], s22 offen offset:0 sc1
    buffer_load_dwordx4 v[228:231], v1, s[4:7], s22 offen offset:1024 sc1
    buffer_load_dwordx4 v[232:235], v1, s[4:7], s22 offen offset:2048 sc1
    buffer_load_dwordx4 v[236:239], v1, s[4:7], s22 offen offset:3072 sc1
    s_add_u32 s22, s22, 4096
    buffer_load_dwordx4 v[240:243], v1, s[4:7], s22 offen offset:0 sc1
    buffer_load_dwordx4 v[244:247], v1, s[4:7], s22 offen offset:1024 sc1
    buffer_load_dwordx4 v[248:251], v1, s[4:7], s22 offen offset:2048 sc1
    buffer_load_dwordx4 v[252:255], v1, s[4:7], s22 offen offset:3072 sc1
    s_add_u32 s22, s22, 4096
    s_waitcnt vmcnt(40)
    v_and_b32 v6, 8, v0
    v_and_b32 v12, 1, v0
    v_lshl_add_u32 v6, v12, 2, v6
    v_bfe_u32 v12, v0, 2, 1
    v_lshl_add_u32 v6, v12, 1, v6
    v_bfe_u32 v12, v0, 1, 1
    v_add_u32 v6, v6, v12
    v_lshlrev_b32 v6, 2, v6
    v_cmp_eq_u32 vcc, 12, v3
    v_cmp_gt_u32 s[48:49], 3, v4
    v_cmp_gt_u32 s[50:51], 12, v3
    v_cndmask_b32 v8, 0, 1.0, vcc
    v_mov_b32 v9, v8
    v_mov_b32 v10, v8
    v_mov_b32 v11, v8
    s_lshl_b32 s26, s16, 15
    v_add_u32 v5, s26, v1
    s_mov_b32 s28, 0
    v_mov_b32 v96, 0
    v_mov_b32 v97, 0
    v_mov_b32 v98, 0
    v_mov_b32 v99, 0
    v_mov_b32 v100, 0
    v_mov_b32 v101, 0
    v_mov_b32 v102, 0
    v_mov_b32 v103, 0
    v_mov_b32 v104, 0
    v_mov_b32 v105, 0
    v_mov_b32 v106, 0
    v_mov_b32 v107, 0
    v_mov_b32 v108, 0
    v_mov_b32 v109, 0
    v_mov_b32 v110, 0
    v_mov_b32 v111, 0
    v_mov_b32 v112, 0
    v_mov_b32 v113, 0
    v_mov_b32 v114, 0
    v_mov_b32 v115, 0
    v_mov_b32 v116, 0
    v_mov_b32 v117, 0
    v_mov_b32 v118, 0
    v_mov_b32 v119, 0
    v_mov_b32 v120, 0
    v_mov_b32 v121, 0
    v_mov_b32 v122, 0
    v_mov_b32 v123, 0
    v_mov_b32 v124, 0
    v_mov_b32 v125, 0
    v_mov_b32 v126, 0
    v_mov_b32 v127, 0
    s_waitcnt vmcnt(0)
LH_135:
    buffer_load_dwordx4 v[88:91], v1, s[4:7], s24 offen offset:3072
    buffer_load_dwordx4 v[92:95], v1, s[4:7], s25 offen offset:3072
    s_waitcnt vmcnt(6)
    v_mfma_f32_16x16x32_bf16 v[16:19], a[0:3], v[64:67], 0
    v_mfma_f32_16x16x32_bf16 v[40:43], a[0:3], v[68:71], 0
    v_mfma_f32_16x16x32_bf16 v[20:23], a[56:59], v[64:67], 0
    v_mfma_f32_16x16x32_bf16 v[44:47], a[56:59], v[68:71], 0
    v_mfma_f32_16x16x32_bf16 v[24:27], v[64:67], a[112:115], 0
    v_mfma_f32_16x16x32_bf16 v[48:51], v[68:71], a[112:115], 0
    v_mfma_f32_16x16x32_bf16 v[28:31], v[64:67], a[168:171], 0
    v_mfma_f32_16x16x32_bf16 v[52:55], v[68:71], a[168:171], 0
    v_mfma_f32_16x16x32_bf16 v[32:35], v[64:67], a[224:227], 0
    v_mfma_f32_16x16x32_bf16 v[56:59], v[68:71], a[224:227], 0
    v_mfma_f32_16x16x32_bf16 v[36:39], v[64:67], v[200:203], v[8:11]
    v_mfma_f32_16x16x32_bf16 v[60:63], v[68:71], v[200:203], v[8:11]
    s_add_u32 s26, s24, 4096
    buffer_load_dwordx4 v[64:67], v1, s[4:7], s26 offen offset:0
    s_add_u32 s26, s25, 4096
    buffer_load_dwordx4 v[68:71], v1, s[4:7], s26 offen offset:0
    s_waitcnt vmcnt(6)
    v_mfma_f32_16x16x32_bf16 v[16:19], a[4:7], v[72:75], v[16:19]
    v_mfma_f32_16x16x32_bf16 v[40:43], a[4:7], v[76:79], v[40:43]
    v_mfma_f32_16x16x32_bf16 v[20:23], a[60:63], v[72:75], v[20:23]
    v_mfma_f32_16x16x32_bf16 v[44:47], a[60:63], v[76:79], v[44:47]
    v_mfma_f32_16x16x32_bf16 v[24:27], v[72:75], a[116:119], v[24:27]
    v_mfma_f32_16x16x32_bf16 v[48:51], v[76:79], a[116:119], v[48:51]
    v_mfma_f32_16x16x32_bf16 v[28:31], v[72:75], a[172:175], v[28:31]
    v_mfma_f32_16x16x32_bf16 v[52:55], v[76:79], a[172:175], v[52:55]
    v_mfma_f32_16x16x32_bf16 v[32:35], v[72:75], a[228:231], v[32:35]
    v_mfma_f32_16x16x32_bf16 v[56:59], v[76:79], a[228:231], v[56:59]
    v_mfma_f32_16x16x32_bf16 v[36:39], v[72:75], v[204:207], v[36:39]
    v_mfma_f32_16x16x32_bf16 v[60:63], v[76:79], v[204:207], v[60:63]
    s_add_u32 s26, s24, 4096
    buffer_load_dwordx4 v[72:75], v1, s[4:7], s26 offen offset:1024
    s_add_u32 s26, s25, 4096
    buffer_load_dwordx4 v[76:79], v1, s[4:7], s26 offen offset:1024
    s_waitcnt vmcnt(6)
    v_mfma_f32_16x16x32_bf16 v[16:19], a[8:11], v[80:83], v[16:19]
    v_mfma_f32_16x16x32_bf16 v[40:43], a[8:11], v[84:87], v[40:43]
    v_mfma_f32_16x16x32_bf16 v[20:23], a[64:67], v[80:83], v[20:23]
    v_mfma_f32_16x16x32_bf16 v[44:47], a[64:67], v[84:87], v[44:47]
    v_mfma_f32_16x16x32_bf16 v[24:27], v[80:83], a[120:123], v[24:27]
    v_mfma_f32_16x16x32_bf16 v[48:51], v[84:87], a[120:123], v[48:51]
    v_mfma_f32_16x16x32_bf16 v[28:31], v[80:83], a[176:179], v[28:31]
    v_mfma_f32_16x16x32_bf16 v[52:55], v[84:87], a[176:179], v[52:55]
    v_mfma_f32_16x16x32_bf16 v[32:35], v[80:83], a[232:235], v[32:35]
    v_mfma_f32_16x16x32_bf16 v[56:59], v[84:87], a[232:235], v[56:59]
    v_mfma_f32_16x16x32_bf16 v[36:39], v[80:83], v[208:211], v[36:39]
    v_mfma_f32_16x16x32_bf16 v[60:63], v[84:87], v[208:211], v[60:63]
    s_add_u32 s26, s24, 4096
    buffer_load_dwordx4 v[80:83], v1, s[4:7], s26 offen offset:2048
    s_add_u32 s26, s25, 4096
    buffer_load_dwordx4 v[84:87], v1, s[4:7], s26 offen offset:2048
    s_waitcnt vmcnt(6)
    v_mfma_f32_16x16x32_bf16 v[16:19], a[12:15], v[88:91], v[16:19]
    v_mfma_f32_16x16x32_bf16 v[40:43], a[12:15], v[92:95], v[40:43]
    v_mfma_f32_16x16x32_bf16 v[20:23], a[68:71], v[88:91], v[20:23]
    v_mfma_f32_16x16x32_bf16 v[44:47], a[68:71], v[92:95], v[44:47]
    v_mfma_f32_16x16x32_bf16 v[24:27], v[88:91], a[124:127], v[24:27]
    v_mfma_f32_16x16x32_bf16 v[48:51], v[92:95], a[124:127], v[48:51]
    v_mfma_f32_16x16x32_bf16 v[28:31], v[88:91], a[180:183], v[28:31]
    v_mfma_f32_16x16x32_bf16 v[52:55], v[92:95], a[180:183], v[52:55]
    v_mfma_f32_16x16x32_bf16 v[32:35], v[88:91], a[236:239], v[32:35]
    v_mfma_f32_16x16x32_bf16 v[56:59], v[92:95], a[236:239], v[56:59]
    v_mfma_f32_16x16x32_bf16 v[36:39], v[88:91], v[212:215], v[36:39]
    v_mfma_f32_16x16x32_bf16 v[60:63], v[92:95], v[212:215], v[60:63]
    s_add_u32 s26, s24, 4096
    buffer_load_dwordx4 v[88:91], v1, s[4:7], s26 offen offset:3072
    s_add_u32 s26, s25, 4096
    buffer_load_dwordx4 v[92:95], v1, s[4:7], s26 offen offset:3072
    s_waitcnt vmcnt(6)
    v_mfma_f32_16x16x32_bf16 v[16:19], a[16:19], v[64:67], v[16:19]
    v_mfma_f32_16x16x32_bf16 v[40:43], a[16:19], v[68:71], v[40:43]
    v_mfma_f32_16x16x32_bf16 v[20:23], a[72:75], v[64:67], v[20:23]
    v_mfma_f32_16x16x32_bf16 v[44:47], a[72:75], v[68:71], v[44:47]
    v_mfma_f32_16x16x32_bf16 v[24:27], v[64:67], a[128:131], v[24:27]
    v_mfma_f32_16x16x32_bf16 v[48:51], v[68:71], a[128:131], v[48:51]
    v_mfma_f32_16x16x32_bf16 v[28:31], v[64:67], a[184:187], v[28:31]
    v_mfma_f32_16x16x32_bf16 v[52:55], v[68:71], a[184:187], v[52:55]
    v_mfma_f32_16x16x32_bf16 v[32:35], v[64:67], a[240:243], v[32:35]
    v_mfma_f32_16x16x32_bf16 v[56:59], v[68:71], a[240:243], v[56:59]
    v_mfma_f32_16x16x32_bf16 v[36:39], v[64:67], v[216:219], v[36:39]
    v_mfma_f32_16x16x32_bf16 v[60:63], v[68:71], v[216:219], v[60:63]
    s_add_u32 s26, s24, 8192
    buffer_load_dwordx4 v[64:67], v1, s[4:7], s26 offen offset:0
    s_add_u32 s26, s25, 8192
    buffer_load_dwordx4 v[68:71], v1, s[4:7], s26 offen offset:0
    s_waitcnt vmcnt(6)
    v_mfma_f32_16x16x32_bf16 v[16:19], a[20:23], v[72:75], v[16:19]
    v_mfma_f32_16x16x32_bf16 v[40:43], a[20:23], v[76:79], v[40:43]
    v_mfma_f32_16x16x32_bf16 v[20:23], a[76:79], v[72:75], v[20:23]
    v_mfma_f32_16x16x32_bf16 v[44:47], a[76:79], v[76:79], v[44:47]
    v_mfma_f32_16x16x32_bf16 v[24:27], v[72:75], a[132:135], v[24:27]
    v_mfma_f32_16x16x32_bf16 v[48:51], v[76:79], a[132:135], v[48:51]
    v_mfma_f32_16x16x32_bf16 v[28:31], v[72:75], a[188:191], v[28:31]
    v_mfma_f32_16x16x32_bf16 v[52:55], v[76:79], a[188:191], v[52:55]
    v_mfma_f32_16x16x32_bf16 v[32:35], v[72:75], a[244:247], v[32:35]
    v_mfma_f32_16x16x32_bf16 v[56:59], v[76:79], a[244:247], v[56:59]
    v_mfma_f32_16x16x32_bf16 v[36:39], v[72:75], v[220:223], v[36:39]
    v_mfma_f32_16x16x32_bf16 v[60:63], v[76:79], v[220:223], v[60:63]
    s_add_u32 s26, s24, 8192
    buffer_load_dwordx4 v[72:75], v1, s[4:7], s26 offen offset:1024
    s_add_u32 s26, s25, 8192
    buffer_load_dwordx4 v[76:79], v1, s[4:7], s26 offen offset:1024
    s_waitcnt vmcnt(6)
    v_mfma_f32_16x16x32_bf16 v[16:19], a[24:27], v[80:83], v[16:19]
    v_mfma_f32_16x16x32_bf16 v[40:43], a[24:27], v[84:87], v[40:43]
    v_mfma_f32_16x16x32_bf16 v[20:23], a[80:83], v[80:83], v[20:23]
    v_mfma_f32_16x16x32_bf16 v[44:47], a[80:83], v[84:87], v[44:47]
    v_mfma_f32_16x16x32_bf16 v[24:27], v[80:83], a[136:139], v[24:27]
    v_mfma_f32_16x16x32_bf16 v[48:51], v[84:87], a[136:139], v[48:51]
    v_mfma_f32_16x16x32_bf16 v[28:31], v[80:83], a[192:195], v[28:31]
    v_mfma_f32_16x16x32_bf16 v[52:55], v[84:87], a[192:195], v[52:55]
    v_mfma_f32_16x16x32_bf16 v[32:35], v[80:83], a[248:251], v[32:35]
    v_mfma_f32_16x16x32_bf16 v[56:59], v[84:87], a[248:251], v[56:59]
    v_mfma_f32_16x16x32_bf16 v[36:39], v[80:83], v[224:227], v[36:39]
    v_mfma_f32_16x16x32_bf16 v[60:63], v[84:87], v[224:227], v[60:63]
    s_add_u32 s26, s24, 8192
    buffer_load_dwordx4 v[80:83], v1, s[4:7], s26 offen offset:2048
    s_add_u32 s26, s25, 8192
    buffer_load_dwordx4 v[84:87], v1, s[4:7], s26 offen offset:2048
    s_waitcnt vmcnt(6)
    v_mfma_f32_16x16x32_bf16 v[16:19], a[28:31], v[88:91], v[16:19]
    v_mfma_f32_16x16x32_bf16 v[40:43], a[28:31], v[92:95], v[40:43]
    v_mfma_f32_16x16x32_bf16 v[20:23], a[84:87], v[88:91], v[20:23]
    v_mfma_f32_16x16x32_bf16 v[44:47], a[84:87], v[92:95], v[44:47]
    v_mfma_f32_16x16x32_bf16 v[24:27], v[88:91], a[140:143], v[24:27]
    v_mfma_f32_16x16x32_bf16 v[48:51], v[92:95], a[140:143], v[48:51]
    v_mfma_f32_16x16x32_bf16 v[28:31], v[88:91], a[196:199], v[28:31]
    v_mfma_f32_16x16x32_bf16 v[52:55], v[92:95], a[196:199], v[52:55]
    v_mfma_f32_16x16x32_bf16 v[32:35], v[88:91], a[252:255], v[32:35]
    v_mfma_f32_16x16x32_bf16 v[56:59], v[92:95], a[252:255], v[56:59]
    v_mfma_f32_16x16x32_bf16 v[36:39], v[88:91], v[228:231], v[36:39]
    v_mfma_f32_16x16x32_bf16 v[60:63], v[92:95], v[228:231], v[60:63]
    s_add_u32 s26, s24, 8192
    buffer_load_dwordx4 v[88:91], v1, s[4:7], s26 offen offset:3072
    s_add_u32 s26, s25, 8192
    buffer_load_dwordx4 v[92:95], v1, s[4:7], s26 offen offset:3072
    s_waitcnt vmcnt(6)
    v_mfma_f32_16x16x32_bf16 v[16:19], a[32:35], v[64:67], v[16:19]
    v_mfma_f32_16x16x32_bf16 v[40:43], a[32:35], v[68:71], v[40:43]
    v_mfma_f32_16x16x32_bf16 v[20:23], a[88:91], v[64:67], v[20:23]
    v_mfma_f32_16x16x32_bf16 v[44:47], a[88:91], v[68:71], v[44:47]
    v_mfma_f32_16x16x32_bf16 v[24:27], v[64:67], a[144:147], v[24:27]
    v_mfma_f32_16x16x32_bf16 v[48:51], v[68:71], a[144:147], v[48:51]
    v_mfma_f32_16x16x32_bf16 v[28:31], v[64:67], a[200:203], v[28:31]
    v_mfma_f32_16x16x32_bf16 v[52:55], v[68:71], a[200:203], v[52:55]
    v_mfma_f32_16x16x32_bf16 v[32:35], v[64:67], v[176:179], v[32:35]
    v_mfma_f32_16x16x32_bf16 v[56:59], v[68:71], v[176:179], v[56:59]
    v_mfma_f32_16x16x32_bf16 v[36:39], v[64:67], v[232:235], v[36:39]
    v_mfma_f32_16x16x32_bf16 v[60:63], v[68:71], v[232:235], v[60:63]
    s_add_u32 s26, s24, 12288
    buffer_load_dwordx4 v[64:67], v1, s[4:7], s26 offen offset:0
    s_add_u32 s26, s25, 12288
    buffer_load_dwordx4 v[68:71], v1, s[4:7], s26 offen offset:0
    s_waitcnt vmcnt(6)
    v_mfma_f32_16x16x32_bf16 v[16:19], a[36:39], v[72:75], v[16:19]
    v_mfma_f32_16x16x32_bf16 v[40:43], a[36:39], v[76:79], v[40:43]
    v_mfma_f32_16x16x32_bf16 v[20:23], a[92:95], v[72:75], v[20:23]
    v_mfma_f32_16x16x32_bf16 v[44:47], a[92:95], v[76:79], v[44:47]
    v_mfma_f32_16x16x32_bf16 v[24:27], v[72:75], a[148:151], v[24:27]
    v_mfma_f32_16x16x32_bf16 v[48:51], v[76:79], a[148:151], v[48:51]
    v_mfma_f32_16x16x32_bf16 v[28:31], v[72:75], a[204:207], v[28:31]
    v_mfma_f32_16x16x32_bf16 v[52:55], v[76:79], a[204:207], v[52:55]
    v_mfma_f32_16x16x32_bf16 v[32:35], v[72:75], v[180:183], v[32:35]
    v_mfma_f32_16x16x32_bf16 v[56:59], v[76:79], v[180:183], v[56:59]
    v_mfma_f32_16x16x32_bf16 v[36:39], v[72:75], v[236:239], v[36:39]
    v_mfma_f32_16x16x32_bf16 v[60:63], v[76:79], v[236:239], v[60:63]
    s_add_u32 s26, s24, 12288
    buffer_load_dwordx4 v[72:75], v1, s[4:7], s26 offen offset:1024
    s_add_u32 s26, s25, 12288
    buffer_load_dwordx4 v[76:79], v1, s[4:7], s26 offen offset:1024
    s_waitcnt vmcnt(6)
    v_mfma_f32_16x16x32_bf16 v[16:19], a[40:43], v[80:83], v[16:19]
    v_mfma_f32_16x16x32_bf16 v[40:43], a[40:43], v[84:87], v[40:43]
    v_mfma_f32_16x16x32_bf16 v[20:23], a[96:99], v[80:83], v[20:23]
    v_mfma_f32_16x16x32_bf16 v[44:47], a[96:99], v[84:87], v[44:47]
    v_mfma_f32_16x16x32_bf16 v[24:27], v[80:83], a[152:155], v[24:27]
    v_mfma_f32_16x16x32_bf16 v[48:51], v[84:87], a[152:155], v[48:51]
    v_mfma_f32_16x16x32_bf16 v[28:31], v[80:83], a[208:211], v[28:31]
    v_mfma_f32_16x16x32_bf16 v[52:55], v[84:87], a[208:211], v[52:55]
    v_mfma_f32_16x16x32_bf16 v[32:35], v[80:83], v[184:187], v[32:35]
    v_mfma_f32_16x16x32_bf16 v[56:59], v[84:87], v[184:187], v[56:59]
    v_mfma_f32_16x16x32_bf16 v[36:39], v[80:83], v[240:243], v[36:39]
    v_mfma_f32_16x16x32_bf16 v[60:63], v[84:87], v[240:243], v[60:63]
    s_waitcnt vmcnt(4)
    v_mfma_f32_16x16x32_bf16 v[16:19], a[44:47], v[88:91], v[16:19]
    v_mfma_f32_16x16x32_bf16 v[40:43], a[44:47], v[92:95], v[40:43]
    v_mfma_f32_16x16x32_bf16 v[20:23], a[100:103], v[88:91], v[20:23]
    v_mfma_f32_16x16x32_bf16 v[44:47], a[100:103], v[92:95], v[44:47]
    v_mfma_f32_16x16x32_bf16 v[24:27], v[88:91], a[156:159], v[24:27]
    v_mfma_f32_16x16x32_bf16 v[48:51], v[92:95], a[156:159], v[48:51]
    v_mfma_f32_16x16x32_bf16 v[28:31], v[88:91], a[212:215], v[28:31]
    v_mfma_f32_16x16x32_bf16 v[52:55], v[92:95], a[212:215], v[52:55]
    v_mfma_f32_16x16x32_bf16 v[32:35], v[88:91], v[188:191], v[32:35]
    v_mfma_f32_16x16x32_bf16 v[56:59], v[92:95], v[188:191], v[56:59]
    v_mfma_f32_16x16x32_bf16 v[36:39], v[88:91], v[244:247], v[36:39]
    v_mfma_f32_16x16x32_bf16 v[60:63], v[92:95], v[244:247], v[60:63]
    s_waitcnt vmcnt(2)
    v_mfma_f32_16x16x32_bf16 v[16:19], a[48:51], v[64:67], v[16:19]
    v_mfma_f32_16x16x32_bf16 v[40:43], a[48:51], v[68:71], v[40:43]
    v_mfma_f32_16x16x32_bf16 v[20:23], a[104:107], v[64:67], v[20:23]
    v_mfma_f32_16x16x32_bf16 v[44:47], a[104:107], v[68:71], v[44:47]
    v_mfma_f32_16x16x32_bf16 v[24:27], v[64:67], a[160:163], v[24:27]
    v_mfma_f32_16x16x32_bf16 v[48:51], v[68:71], a[160:163], v[48:51]
    v_mfma_f32_16x16x32_bf16 v[28:31], v[64:67], a[216:219], v[28:31]
    v_mfma_f32_16x16x32_bf16 v[52:55], v[68:71], a[216:219], v[52:55]
    v_mfma_f32_16x16x32_bf16 v[32:35], v[64:67], v[192:195], v[32:35]
    v_mfma_f32_16x16x32_bf16 v[56:59], v[68:71], v[192:195], v[56:59]
    v_mfma_f32_16x16x32_bf16 v[36:39], v[64:67], v[248:251], v[36:39]
    v_mfma_f32_16x16x32_bf16 v[60:63], v[68:71], v[248:251], v[60:63]
    s_waitcnt vmcnt(0)
    v_mfma_f32_16x16x32_bf16 v[16:19], a[52:55], v[72:75], v[16:19]
    v_mfma_f32_16x16x32_bf16 v[40:43], a[52:55], v[76:79], v[40:43]
    v_mfma_f32_16x16x32_bf16 v[20:23], a[108:111], v[72:75], v[20:23]
    v_mfma_f32_16x16x32_bf16 v[44:47], a[108:111], v[76:79], v[44:47]
    v_mfma_f32_16x16x32_bf16 v[24:27], v[72:75], a[164:167], v[24:27]
    v_mfma_f32_16x16x32_bf16 v[48:51], v[76:79], a[164:167], v[48:51]
    v_mfma_f32_16x16x32_bf16 v[28:31], v[72:75], a[220:223], v[28:31]
    v_mfma_f32_16x16x32_bf16 v[52:55], v[76:79], a[220:223], v[52:55]
    v_mfma_f32_16x16x32_bf16 v[32:35], v[72:75], v[196:199], v[32:35]
    v_mfma_f32_16x16x32_bf16 v[56:59], v[76:79], v[196:199], v[56:59]
    v_mfma_f32_16x16x32_bf16 v[36:39], v[72:75], v[252:255], v[36:39]
    v_mfma_f32_16x16x32_bf16 v[60:63], v[76:79], v[252:255], v[60:63]
    s_add_u32 s20, s20, 1
    s_min_u32 s31, s20, 63
    s_mul_i32 s24, s31, 28672
    s_add_u32 s24, s24, 48402432
    s_add_u32 s25, s24, 14336
    buffer_load_dwordx4 v[64:67], v1, s[4:7], s24 offen offset:0
    buffer_load_dwordx4 v[68:71], v1, s[4:7], s25 offen offset:0
    buffer_load_dwordx4 v[72:75], v1, s[4:7], s24 offen offset:1024
    buffer_load_dwordx4 v[76:79], v1, s[4:7], s25 offen offset:1024
    buffer_load_dwordx4 v[80:83], v1, s[4:7], s24 offen offset:2048
    buffer_load_dwordx4 v[84:87], v1, s[4:7], s25 offen offset:2048
    v_cndmask_b32 v20, v16, v20, s[48:49]
    v_cndmask_b32 v21, v16, v21, s[48:49]
    v_cndmask_b32 v22, v16, v22, s[48:49]
    v_cndmask_b32 v23, v16, v23, s[48:49]
    v_max3_f32 v128, v16, v17, v18
    v_min3_f32 v129, v16, v17, v18
    v_max3_f32 v128, v128, v19, v20
    v_min3_f32 v129, v129, v19, v20
    v_max3_f32 v128, v128, v21, v22
    v_min3_f32 v129, v129, v21, v22
    v_max_f32 v128, v128, v23
    v_min_f32 v129, v129, v23
    v_mov_b32 v130, v128
    s_nop 1
    v_permlane16_swap_b32 v128, v130
    v_max_f32 v128, v128, v130
    v_mov_b32 v130, v128
    s_nop 1
    v_permlane32_swap_b32 v128, v130
    v_max_f32 v128, v128, v130
    v_mov_b32 v130, v129
    s_nop 1
    v_permlane16_swap_b32 v129, v130
    v_min_f32 v129, v129, v130
    v_mov_b32 v130, v129
    s_nop 1
    v_permlane32_swap_b32 v129, v130
    v_min_f32 v129, v129, v130
    v_sub_f32 v136, v16, v128
    v_sub_f32 v144, v129, v16
    v_sub_f32 v137, v17, v128
    v_sub_f32 v145, v129, v17
    v_sub_f32 v138, v18, v128
    v_sub_f32 v146, v129, v18
    v_sub_f32 v139, v19, v128
    v_sub_f32 v147, v129, v19
    v_sub_f32 v140, v20, v128
    v_sub_f32 v148, v129, v20
    v_sub_f32 v141, v21, v128
    v_sub_f32 v149, v129, v21
    v_sub_f32 v142, v22, v128
    v_sub_f32 v150, v129, v22
    v_sub_f32 v143, v23, v128
    v_sub_f32 v151, v129, v23
    v_exp_f32 v136, v136
    v_exp_f32 v144, v144
    v_exp_f32 v137, v137
    v_exp_f32 v145, v145
    v_exp_f32 v138, v138
    v_exp_f32 v146, v146
    v_exp_f32 v139, v139
    v_exp_f32 v147, v147
    v_exp_f32 v140, v140
    v_exp_f32 v148, v148
    v_exp_f32 v141, v141
    v_exp_f32 v149, v149
    v_exp_f32 v142, v142
    v_exp_f32 v150, v150
    v_exp_f32 v143, v143
    v_exp_f32 v151, v151
    s_nop 0
    v_cndmask_b32 v140, 0, v140, s[48:49]
    v_cndmask_b32 v148, 0, v148, s[48:49]
    v_cndmask_b32 v141, 0, v141, s[48:49]
    v_cndmask_b32 v149, 0, v149, s[48:49]
    v_cndmask_b32 v142, 0, v142, s[48:49]
    v_cndmask_b32 v150, 0, v150, s[48:49]
    v_cndmask_b32 v143, 0, v143, s[48:49]
    v_cndmask_b32 v151, 0, v151, s[48:49]
    v_add_f32 v128, v136, v137
    v_add_f32 v129, v144, v145
    v_add_f32 v128, v128, v138
    v_add_f32 v129, v129, v146
    v_add_f32 v128, v128, v139
    v_add_f32 v129, v129, v147
    v_add_f32 v128, v128, v140
    v_add_f32 v129, v129, v148
    v_add_f32 v128, v128, v141
    v_add_f32 v129, v129, v149
    v_add_f32 v128, v128, v142
    v_add_f32 v129, v129, v150
    v_add_f32 v128, v128, v143
    v_add_f32 v129, v129, v151
    v_mov_b32 v130, v128
    s_nop 1
    v_permlane16_swap_b32 v128, v130
    v_add_f32 v128, v128, v130
    v_mov_b32 v130, v128
    s_nop 1
    v_permlane32_swap_b32 v128, v130
    v_add_f32 v128, v128, v130
    v_mov_b32 v130, v129
    s_nop 1
    v_permlane16_swap_b32 v129, v130
    v_add_f32 v129, v129, v130
    v_mov_b32 v130, v129
    s_nop 1
    v_permlane32_swap_b32 v129, v130
    v_add_f32 v129, v129, v130
    v_rcp_f32 v128, v128
    v_rcp_f32 v129, v129
    s_nop 0
    v_mul_f32 v136, v136, v128
    v_mul_f32 v144, v144, v129
    v_mul_f32 v137, v137, v128
    v_mul_f32 v145, v145, v129
    v_mul_f32 v138, v138, v128
    v_mul_f32 v146, v146, v129
    v_mul_f32 v139, v139, v128
    v_mul_f32 v147, v147, v129
    v_mul_f32 v140, v140, v128
    v_mul_f32 v148, v148, v129
    v_mul_f32 v141, v141, v128
    v_mul_f32 v149, v149, v129
    v_mul_f32 v142, v142, v128
    v_mul_f32 v150, v150, v129
    v_mul_f32 v143, v143, v128
    v_mul_f32 v151, v151, v129
    v_cvt_pk_bf16_f32 v136, v136, v137
    v_cvt_pk_bf16_f32 v137, v138, v139
    v_cvt_pk_bf16_f32 v138, v140, v141
    v_cvt_pk_bf16_f32 v139, v142, v143
    v_cvt_pk_bf16_f32 v144, v144, v145
    v_cvt_pk_bf16_f32 v145, v146, v147
    v_cvt_pk_bf16_f32 v146, v148, v149
    v_cvt_pk_bf16_f32 v147, v150, v151
    ds_write_b128 v5, v[136:139] offset:0
    ds_write_b128 v5, v[144:147] offset:1024
    v_cndmask_b32 v44, v40, v44, s[48:49]
    v_cndmask_b32 v45, v40, v45, s[48:49]
    v_cndmask_b32 v46, v40, v46, s[48:49]
    v_cndmask_b32 v47, v40, v47, s[48:49]
    v_max3_f32 v128, v40, v41, v42
    v_min3_f32 v129, v40, v41, v42
    v_max3_f32 v128, v128, v43, v44
    v_min3_f32 v129, v129, v43, v44
    v_max3_f32 v128, v128, v45, v46
    v_min3_f32 v129, v129, v45, v46
    v_max_f32 v128, v128, v47
    v_min_f32 v129, v129, v47
    v_mov_b32 v130, v128
    s_nop 1
    v_permlane16_swap_b32 v128, v130
    v_max_f32 v128, v128, v130
    v_mov_b32 v130, v128
    s_nop 1
    v_permlane32_swap_b32 v128, v130
    v_max_f32 v128, v128, v130
    v_mov_b32 v130, v129
    s_nop 1
    v_permlane16_swap_b32 v129, v130
    v_min_f32 v129, v129, v130
    v_mov_b32 v130, v129
    s_nop 1
    v_permlane32_swap_b32 v129, v130
    v_min_f32 v129, v129, v130
    v_sub_f32 v136, v40, v128
    v_sub_f32 v144, v129, v40
    v_sub_f32 v137, v41, v128
    v_sub_f32 v145, v129, v41
    v_sub_f32 v138, v42, v128
    v_sub_f32 v146, v129, v42
    v_sub_f32 v139, v43, v128
    v_sub_f32 v147, v129, v43
    v_sub_f32 v140, v44, v128
    v_sub_f32 v148, v129, v44
    v_sub_f32 v141, v45, v128
    v_sub_f32 v149, v129, v45
    v_sub_f32 v142, v46, v128
    v_sub_f32 v150, v129, v46
    v_sub_f32 v143, v47, v128
    v_sub_f32 v151, v129, v47
    v_exp_f32 v136, v136
    v_exp_f32 v144, v144
    v_exp_f32 v137, v137
    v_exp_f32 v145, v145
    v_exp_f32 v138, v138
    v_exp_f32 v146, v146
    v_exp_f32 v139, v139
    v_exp_f32 v147, v147
    v_exp_f32 v140, v140
    v_exp_f32 v148, v148
    v_exp_f32 v141, v141
    v_exp_f32 v149, v149
    v_exp_f32 v142, v142
    v_exp_f32 v150, v150
    v_exp_f32 v143, v143
    v_exp_f32 v151, v151
    s_nop 0
    v_cndmask_b32 v140, 0, v140, s[48:49]
    v_cndmask_b32 v148, 0, v148, s[48:49]
    v_cndmask_b32 v141, 0, v141, s[48:49]
    v_cndmask_b32 v149, 0, v149, s[48:49]
    v_cndmask_b32 v142, 0, v142, s[48:49]
    v_cndmask_b32 v150, 0, v150, s[48:49]
    v_cndmask_b32 v143, 0, v143, s[48:49]
    v_cndmask_b32 v151, 0, v151, s[48:49]
    v_add_f32 v128, v136, v137
    v_add_f32 v129, v144, v145
    v_add_f32 v128, v128, v138
    v_add_f32 v129, v129, v146
    v_add_f32 v128, v128, v139
    v_add_f32 v129, v129, v147
    v_add_f32 v128, v128, v140
    v_add_f32 v129, v129, v148
    v_add_f32 v128, v128, v141
    v_add_f32 v129, v129, v149
    v_add_f32 v128, v128, v142
    v_add_f32 v129, v129, v150
    v_add_f32 v128, v128, v143
    v_add_f32 v129, v129, v151
    v_mov_b32 v130, v128
    s_nop 1
    v_permlane16_swap_b32 v128, v130
    v_add_f32 v128, v128, v130
    v_mov_b32 v130, v128
    s_nop 1
    v_permlane32_swap_b32 v128, v130
    v_add_f32 v128, v128, v130
    v_mov_b32 v130, v129
    s_nop 1
    v_permlane16_swap_b32 v129, v130
    v_add_f32 v129, v129, v130
    v_mov_b32 v130, v129
    s_nop 1
    v_permlane32_swap_b32 v129, v130
    v_add_f32 v129, v129, v130
    v_rcp_f32 v128, v128
    v_rcp_f32 v129, v129
    s_nop 0
    v_mul_f32 v136, v136, v128
    v_mul_f32 v144, v144, v129
    v_mul_f32 v137, v137, v128
    v_mul_f32 v145, v145, v129
    v_mul_f32 v138, v138, v128
    v_mul_f32 v146, v146, v129
    v_mul_f32 v139, v139, v128
    v_mul_f32 v147, v147, v129
    v_mul_f32 v140, v140, v128
    v_mul_f32 v148, v148, v129
    v_mul_f32 v141, v141, v128
    v_mul_f32 v149, v149, v129
    v_mul_f32 v142, v142, v128
    v_mul_f32 v150, v150, v129
    v_mul_f32 v143, v143, v128
    v_mul_f32 v151, v151, v129
    v_cvt_pk_bf16_f32 v136, v136, v137
    v_cvt_pk_bf16_f32 v137, v138, v139
    v_cvt_pk_bf16_f32 v138, v140, v141
    v_cvt_pk_bf16_f32 v139, v142, v143
    v_cvt_pk_bf16_f32 v144, v144, v145
    v_cvt_pk_bf16_f32 v145, v146, v147
    v_cvt_pk_bf16_f32 v146, v148, v149
    v_cvt_pk_bf16_f32 v147, v150, v151
    ds_write_b128 v5, v[136:139] offset:2048
    ds_write_b128 v5, v[144:147] offset:3072
    v_add_u32 v5, 4096, v5
    v_cndmask_b32 v28, v24, v28, s[50:51]
    v_cndmask_b32 v29, v25, v29, s[50:51]
    v_cndmask_b32 v30, v26, v30, s[50:51]
    v_cndmask_b32 v31, v27, v31, s[50:51]
    v_cndmask_b32 v52, v48, v52, s[50:51]
    v_cndmask_b32 v53, v49, v53, s[50:51]
    v_cndmask_b32 v54, v50, v54, s[50:51]
    v_cndmask_b32 v55, v51, v55, s[50:51]
    v_max_f32 v128, v24, v28
    v_min_f32 v136, v24, v28
    v_max_f32 v129, v25, v29
    v_min_f32 v137, v25, v29
    v_max_f32 v130, v26, v30
    v_min_f32 v138, v26, v30
    v_max_f32 v131, v27, v31
    v_min_f32 v139, v27, v31
    v_max_f32 v132, v48, v52
    v_min_f32 v140, v48, v52
    v_max_f32 v133, v49, v53
    v_min_f32 v141, v49, v53
    v_max_f32 v134, v50, v54
    v_min_f32 v142, v50, v54
    v_max_f32 v135, v51, v55
    v_min_f32 v143, v51, v55
    v_max_f32_dpp v128, v128, v128 row_ror:8 row_mask:0xf bank_mask:0xf
    v_max_f32_dpp v129, v129, v129 row_ror:8 row_mask:0xf bank_mask:0xf
    v_max_f32_dpp v130, v130, v130 row_ror:8 row_mask:0xf bank_mask:0xf
    v_max_f32_dpp v131, v131, v131 row_ror:8 row_mask:0xf bank_mask:0xf
    v_max_f32_dpp v132, v132, v132 row_ror:8 row_mask:0xf bank_mask:0xf
    v_max_f32_dpp v133, v133, v133 row_ror:8 row_mask:0xf bank_mask:0xf
    v_max_f32_dpp v134, v134, v134 row_ror:8 row_mask:0xf bank_mask:0xf
    v_max_f32_dpp v135, v135, v135 row_ror:8 row_mask:0xf bank_mask:0xf
    v_min_f32_dpp v136, v136, v136 row_ror:8 row_mask:0xf bank_mask:0xf
    v_min_f32_dpp v137, v137, v137 row_ror:8 row_mask:0xf bank_mask:0xf
    v_min_f32_dpp v138, v138, v138 row_ror:8 row_mask:0xf bank_mask:0xf
    v_min_f32_dpp v139, v139, v139 row_ror:8 row_mask:0xf bank_mask:0xf
    v_min_f32_dpp v140, v140, v140 row_ror:8 row_mask:0xf bank_mask:0xf
    v_min_f32_dpp v141, v141, v141 row_ror:8 row_mask:0xf bank_mask:0xf
    v_min_f32_dpp v142, v142, v142 row_ror:8 row_mask:0xf bank_mask:0xf
    v_min_f32_dpp v143, v143, v143 row_ror:8 row_mask:0xf bank_mask:0xf
    v_max_f32_dpp v128, v128, v128 row_ror:4 row_mask:0xf bank_mask:0xf
    v_max_f32_dpp v129, v129, v129 row_ror:4 row_mask:0xf bank_mask:0xf
    v_max_f32_dpp v130, v130, v130 row_ror:4 row_mask:0xf bank_mask:0xf
    v_max_f32_dpp v131, v131, v131 row_ror:4 row_mask:0xf bank_mask:0xf
    v_max_f32_dpp v132, v132, v132 row_ror:4 row_mask:0xf bank_mask:0xf
    v_max_f32_dpp v133, v133, v133 row_ror:4 row_mask:0xf bank_mask:0xf
    v_max_f32_dpp v134, v134, v134 row_ror:4 row_mask:0xf bank_mask:0xf
    v_max_f32_dpp v135, v135, v135 row_ror:4 row_mask:0xf bank_mask:0xf
    v_min_f32_dpp v136, v136, v136 row_ror:4 row_mask:0xf bank_mask:0xf
    v_min_f32_dpp v137, v137, v137 row_ror:4 row_mask:0xf bank_mask:0xf
    v_min_f32_dpp v138, v138, v138 row_ror:4 row_mask:0xf bank_mask:0xf
    v_min_f32_dpp v139, v139, v139 row_ror:4 row_mask:0xf bank_mask:0xf
    v_min_f32_dpp v140, v140, v140 row_ror:4 row_mask:0xf bank_mask:0xf
    v_min_f32_dpp v141, v141, v141 row_ror:4 row_mask:0xf bank_mask:0xf
    v_min_f32_dpp v142, v142, v142 row_ror:4 row_mask:0xf bank_mask:0xf
    v_min_f32_dpp v143, v143, v143 row_ror:4 row_mask:0xf bank_mask:0xf
    v_max_f32_dpp v128, v128, v128 row_ror:2 row_mask:0xf bank_mask:0xf
    v_max_f32_dpp v129, v129, v129 row_ror:2 row_mask:0xf bank_mask:0xf
    v_max_f32_dpp v130, v130, v130 row_ror:2 row_mask:0xf bank_mask:0xf
    v_max_f32_dpp v131, v131, v131 row_ror:2 row_mask:0xf bank_mask:0xf
    v_max_f32_dpp v132, v132, v132 row_ror:2 row_mask:0xf bank_mask:0xf
    v_max_f32_dpp v133, v133, v133 row_ror:2 row_mask:0xf bank_mask:0xf
    v_max_f32_dpp v134, v134, v134 row_ror:2 row_mask:0xf bank_mask:0xf
    v_max_f32_dpp v135, v135, v135 row_ror:2 row_mask:0xf bank_mask:0xf
    v_min_f32_dpp v136, v136, v136 row_ror:2 row_mask:0xf bank_mask:0xf
    v_min_f32_dpp v137, v137, v137 row_ror:2 row_mask:0xf bank_mask:0xf
    v_min_f32_dpp v138, v138, v138 row_ror:2 row_mask:0xf bank_mask:0xf
    v_min_f32_dpp v139, v139, v139 row_ror:2 row_mask:0xf bank_mask:0xf
    v_min_f32_dpp v140, v140, v140 row_ror:2 row_mask:0xf bank_mask:0xf
    v_min_f32_dpp v141, v141, v141 row_ror:2 row_mask:0xf bank_mask:0xf
    v_min_f32_dpp v142, v142, v142 row_ror:2 row_mask:0xf bank_mask:0xf
    v_min_f32_dpp v143, v143, v143 row_ror:2 row_mask:0xf bank_mask:0xf
    v_max_f32_dpp v128, v128, v128 row_ror:1 row_mask:0xf bank_mask:0xf
    v_max_f32_dpp v129, v129, v129 row_ror:1 row_mask:0xf bank_mask:0xf
    v_max_f32_dpp v130, v130, v130 row_ror:1 row_mask:0xf bank_mask:0xf
    v_max_f32_dpp v131, v131, v131 row_ror:1 row_mask:0xf bank_mask:0xf
    v_max_f32_dpp v132, v132, v132 row_ror:1 row_mask:0xf bank_mask:0xf
    v_max_f32_dpp v133, v133, v133 row_ror:1 row_mask:0xf bank_mask:0xf
    v_max_f32_dpp v134, v134, v134 row_ror:1 row_mask:0xf bank_mask:0xf
    v_max_f32_dpp v135, v135, v135 row_ror:1 row_mask:0xf bank_mask:0xf
    v_min_f32_dpp v136, v136, v136 row_ror:1 row_mask:0xf bank_mask:0xf
    v_min_f32_dpp v137, v137, v137 row_ror:1 row_mask:0xf bank_mask:0xf
    v_min_f32_dpp v138, v138, v138 row_ror:1 row_mask:0xf bank_mask:0xf
    v_min_f32_dpp v139, v139, v139 row_ror:1 row_mask:0xf bank_mask:0xf
    v_min_f32_dpp v140, v140, v140 row_ror:1 row_mask:0xf bank_mask:0xf
    v_min_f32_dpp v141, v141, v141 row_ror:1 row_mask:0xf bank_mask:0xf
    v_min_f32_dpp v142, v142, v142 row_ror:1 row_mask:0xf bank_mask:0xf
    v_min_f32_dpp v143, v143, v143 row_ror:1 row_mask:0xf bank_mask:0xf
    v_sub_f32 v144, v136, v24
    v_sub_f32 v152, v136, v28
    v_sub_f32 v24, v24, v128
    v_sub_f32 v28, v28, v128
    v_sub_f32 v145, v137, v25
    v_sub_f32 v153, v137, v29
    v_sub_f32 v25, v25, v129
    v_sub_f32 v29, v29, v129
    v_sub_f32 v146, v138, v26
    v_sub_f32 v154, v138, v30
    v_sub_f32 v26, v26, v130
    v_sub_f32 v30, v30, v130
    v_sub_f32 v147, v139, v27
    v_sub_f32 v155, v139, v31
    v_sub_f32 v27, v27, v131
    v_sub_f32 v31, v31, v131
    v_sub_f32 v148, v140, v48
    v_sub_f32 v156, v140, v52
    v_sub_f32 v48, v48, v132
    v_sub_f32 v52, v52, v132
    v_sub_f32 v149, v141, v49
    v_sub_f32 v157, v141, v53
    v_sub_f32 v49, v49, v133
    v_sub_f32 v53, v53, v133
    v_sub_f32 v150, v142, v50
    v_sub_f32 v158, v142, v54
    v_sub_f32 v50, v50, v134
    v_sub_f32 v54, v54, v134
    v_sub_f32 v151, v143, v51
    v_sub_f32 v159, v143, v55
    v_sub_f32 v51, v51, v135
    v_sub_f32 v55, v55, v135
    v_exp_f32 v144, v144
    v_exp_f32 v152, v152
    v_exp_f32 v24, v24
    v_exp_f32 v28, v28
    v_exp_f32 v145, v145
    v_exp_f32 v153, v153
    v_exp_f32 v25, v25
    v_exp_f32 v29, v29
    v_exp_f32 v146, v146
    v_exp_f32 v154, v154
    v_exp_f32 v26, v26
    v_exp_f32 v30, v30
    v_exp_f32 v147, v147
    v_exp_f32 v155, v155
    v_exp_f32 v27, v27
    v_exp_f32 v31, v31
    v_exp_f32 v148, v148
    v_exp_f32 v156, v156
    v_exp_f32 v48, v48
    v_exp_f32 v52, v52
    v_exp_f32 v149, v149
    v_exp_f32 v157, v157
    v_exp_f32 v49, v49
    v_exp_f32 v53, v53
    v_exp_f32 v150, v150
    v_exp_f32 v158, v158
    v_exp_f32 v50, v50
    v_exp_f32 v54, v54
    v_exp_f32 v151, v151
    v_exp_f32 v159, v159
    v_exp_f32 v51, v51
    v_exp_f32 v55, v55
    s_nop 0
    v_cndmask_b32 v28, 0, v28, s[50:51]
    v_cndmask_b32 v152, 0, v152, s[50:51]
    v_cndmask_b32 v29, 0, v29, s[50:51]
    v_cndmask_b32 v153, 0, v153, s[50:51]
    v_cndmask_b32 v30, 0, v30, s[50:51]
    v_cndmask_b32 v154, 0, v154, s[50:51]
    v_cndmask_b32 v31, 0, v31, s[50:51]
    v_cndmask_b32 v155, 0, v155, s[50:51]
    v_cndmask_b32 v52, 0, v52, s[50:51]
    v_cndmask_b32 v156, 0, v156, s[50:51]
    v_cndmask_b32 v53, 0, v53, s[50:51]
    v_cndmask_b32 v157, 0, v157, s[50:51]
    v_cndmask_b32 v54, 0, v54, s[50:51]
    v_cndmask_b32 v158, 0, v158, s[50:51]
    v_cndmask_b32 v55, 0, v55, s[50:51]
    v_cndmask_b32 v159, 0, v159, s[50:51]
    v_add_f32 v128, v24, v28
    v_add_f32 v136, v144, v152
    v_add_f32 v129, v25, v29
    v_add_f32 v137, v145, v153
    v_add_f32 v130, v26, v30
    v_add_f32 v138, v146, v154
    v_add_f32 v131, v27, v31
    v_add_f32 v139, v147, v155
    v_add_f32 v132, v48, v52
    v_add_f32 v140, v148, v156
    v_add_f32 v133, v49, v53
    v_add_f32 v141, v149, v157
    v_add_f32 v134, v50, v54
    v_add_f32 v142, v150, v158
    v_add_f32 v135, v51, v55
    v_add_f32 v143, v151, v159
    v_add_f32_dpp v128, v128, v128 row_ror:8 row_mask:0xf bank_mask:0xf
    v_add_f32_dpp v129, v129, v129 row_ror:8 row_mask:0xf bank_mask:0xf
    v_add_f32_dpp v130, v130, v130 row_ror:8 row_mask:0xf bank_mask:0xf
    v_add_f32_dpp v131, v131, v131 row_ror:8 row_mask:0xf bank_mask:0xf
    v_add_f32_dpp v132, v132, v132 row_ror:8 row_mask:0xf bank_mask:0xf
    v_add_f32_dpp v133, v133, v133 row_ror:8 row_mask:0xf bank_mask:0xf
    v_add_f32_dpp v134, v134, v134 row_ror:8 row_mask:0xf bank_mask:0xf
    v_add_f32_dpp v135, v135, v135 row_ror:8 row_mask:0xf bank_mask:0xf
    v_add_f32_dpp v136, v136, v136 row_ror:8 row_mask:0xf bank_mask:0xf
    v_add_f32_dpp v137, v137, v137 row_ror:8 row_mask:0xf bank_mask:0xf
    v_add_f32_dpp v138, v138, v138 row_ror:8 row_mask:0xf bank_mask:0xf
    v_add_f32_dpp v139, v139, v139 row_ror:8 row_mask:0xf bank_mask:0xf
    v_add_f32_dpp v140, v140, v140 row_ror:8 row_mask:0xf bank_mask:0xf
    v_add_f32_dpp v141, v141, v141 row_ror:8 row_mask:0xf bank_mask:0xf
    v_add_f32_dpp v142, v142, v142 row_ror:8 row_mask:0xf bank_mask:0xf
    v_add_f32_dpp v143, v143, v143 row_ror:8 row_mask:0xf bank_mask:0xf
    v_add_f32_dpp v128, v128, v128 row_ror:4 row_mask:0xf bank_mask:0xf
    v_add_f32_dpp v129, v129, v129 row_ror:4 row_mask:0xf bank_mask:0xf
    v_add_f32_dpp v130, v130, v130 row_ror:4 row_mask:0xf bank_mask:0xf
    v_add_f32_dpp v131, v131, v131 row_ror:4 row_mask:0xf bank_mask:0xf
    v_add_f32_dpp v132, v132, v132 row_ror:4 row_mask:0xf bank_mask:0xf
    v_add_f32_dpp v133, v133, v133 row_ror:4 row_mask:0xf bank_mask:0xf
    v_add_f32_dpp v134, v134, v134 row_ror:4 row_mask:0xf bank_mask:0xf
    v_add_f32_dpp v135, v135, v135 row_ror:4 row_mask:0xf bank_mask:0xf
    v_add_f32_dpp v136, v136, v136 row_ror:4 row_mask:0xf bank_mask:0xf
    v_add_f32_dpp v137, v137, v137 row_ror:4 row_mask:0xf bank_mask:0xf
    v_add_f32_dpp v138, v138, v138 row_ror:4 row_mask:0xf bank_mask:0xf
    v_add_f32_dpp v139, v139, v139 row_ror:4 row_mask:0xf bank_mask:0xf
    v_add_f32_dpp v140, v140, v140 row_ror:4 row_mask:0xf bank_mask:0xf
    v_add_f32_dpp v141, v141, v141 row_ror:4 row_mask:0xf bank_mask:0xf
    v_add_f32_dpp v142, v142, v142 row_ror:4 row_mask:0xf bank_mask:0xf
    v_add_f32_dpp v143, v143, v143 row_ror:4 row_mask:0xf bank_mask:0xf
    v_add_f32_dpp v128, v128, v128 row_ror:2 row_mask:0xf bank_mask:0xf
    v_add_f32_dpp v129, v129, v129 row_ror:2 row_mask:0xf bank_mask:0xf
    v_add_f32_dpp v130, v130, v130 row_ror:2 row_mask:0xf bank_mask:0xf
    v_add_f32_dpp v131, v131, v131 row_ror:2 row_mask:0xf bank_mask:0xf
    v_add_f32_dpp v132, v132, v132 row_ror:2 row_mask:0xf bank_mask:0xf
    v_add_f32_dpp v133, v133, v133 row_ror:2 row_mask:0xf bank_mask:0xf
    v_add_f32_dpp v134, v134, v134 row_ror:2 row_mask:0xf bank_mask:0xf
    v_add_f32_dpp v135, v135, v135 row_ror:2 row_mask:0xf bank_mask:0xf
    v_add_f32_dpp v136, v136, v136 row_ror:2 row_mask:0xf bank_mask:0xf
    v_add_f32_dpp v137, v137, v137 row_ror:2 row_mask:0xf bank_mask:0xf
    v_add_f32_dpp v138, v138, v138 row_ror:2 row_mask:0xf bank_mask:0xf
    v_add_f32_dpp v139, v139, v139 row_ror:2 row_mask:0xf bank_mask:0xf
    v_add_f32_dpp v140, v140, v140 row_ror:2 row_mask:0xf bank_mask:0xf
    v_add_f32_dpp v141, v141, v141 row_ror:2 row_mask:0xf bank_mask:0xf
    v_add_f32_dpp v142, v142, v142 row_ror:2 row_mask:0xf bank_mask:0xf
    v_add_f32_dpp v143, v143, v143 row_ror:2 row_mask:0xf bank_mask:0xf
    v_add_f32_dpp v128, v128, v128 row_ror:1 row_mask:0xf bank_mask:0xf
    v_add_f32_dpp v129, v129, v129 row_ror:1 row_mask:0xf bank_mask:0xf
    v_add_f32_dpp v130, v130, v130 row_ror:1 row_mask:0xf bank_mask:0xf
    v_add_f32_dpp v131, v131, v131 row_ror:1 row_mask:0xf bank_mask:0xf
    v_add_f32_dpp v132, v132, v132 row_ror:1 row_mask:0xf bank_mask:0xf
    v_add_f32_dpp v133, v133, v133 row_ror:1 row_mask:0xf bank_mask:0xf
    v_add_f32_dpp v134, v134, v134 row_ror:1 row_mask:0xf bank_mask:0xf
    v_add_f32_dpp v135, v135, v135 row_ror:1 row_mask:0xf bank_mask:0xf
    v_add_f32_dpp v136, v136, v136 row_ror:1 row_mask:0xf bank_mask:0xf
    v_add_f32_dpp v137, v137, v137 row_ror:1 row_mask:0xf bank_mask:0xf
    v_add_f32_dpp v138, v138, v138 row_ror:1 row_mask:0xf bank_mask:0xf
    v_add_f32_dpp v139, v139, v139 row_ror:1 row_mask:0xf bank_mask:0xf
    v_add_f32_dpp v140, v140, v140 row_ror:1 row_mask:0xf bank_mask:0xf
    v_add_f32_dpp v141, v141, v141 row_ror:1 row_mask:0xf bank_mask:0xf
    v_add_f32_dpp v142, v142, v142 row_ror:1 row_mask:0xf bank_mask:0xf
    v_add_f32_dpp v143, v143, v143 row_ror:1 row_mask:0xf bank_mask:0xf
    v_rcp_f32 v128, v128
    v_rcp_f32 v129, v129
    v_rcp_f32 v130, v130
    v_rcp_f32 v131, v131
    v_rcp_f32 v132, v132
    v_rcp_f32 v133, v133
    v_rcp_f32 v134, v134
    v_rcp_f32 v135, v135
    v_rcp_f32 v136, v136
    v_rcp_f32 v137, v137
    v_rcp_f32 v138, v138
    v_rcp_f32 v139, v139
    v_rcp_f32 v140, v140
    v_rcp_f32 v141, v141
    v_rcp_f32 v142, v142
    v_rcp_f32 v143, v143
    s_nop 0
    v_mul_f32 v24, v24, v128
    v_mul_f32 v28, v28, v128
    v_mul_f32 v144, v144, v136
    v_mul_f32 v152, v152, v136
    v_mul_f32 v25, v25, v129
    v_mul_f32 v29, v29, v129
    v_mul_f32 v145, v145, v137
    v_mul_f32 v153, v153, v137
    v_mul_f32 v26, v26, v130
    v_mul_f32 v30, v30, v130
    v_mul_f32 v146, v146, v138
    v_mul_f32 v154, v154, v138
    v_mul_f32 v27, v27, v131
    v_mul_f32 v31, v31, v131
    v_mul_f32 v147, v147, v139
    v_mul_f32 v155, v155, v139
    v_mul_f32 v48, v48, v132
    v_mul_f32 v52, v52, v132
    v_mul_f32 v148, v148, v140
    v_mul_f32 v156, v156, v140
    v_mul_f32 v49, v49, v133
    v_mul_f32 v53, v53, v133
    v_mul_f32 v149, v149, v141
    v_mul_f32 v157, v157, v141
    v_mul_f32 v50, v50, v134
    v_mul_f32 v54, v54, v134
    v_mul_f32 v150, v150, v142
    v_mul_f32 v158, v158, v142
    v_mul_f32 v51, v51, v135
    v_mul_f32 v55, v55, v135
    v_mul_f32 v151, v151, v143
    v_mul_f32 v159, v159, v143
    v_cvt_pk_bf16_f32 v160, v24, v25
    v_cvt_pk_bf16_f32 v164, v28, v29
    v_cvt_pk_bf16_f32 v168, v144, v145
    v_cvt_pk_bf16_f32 v172, v152, v153
    v_cvt_pk_bf16_f32 v161, v26, v27
    v_cvt_pk_bf16_f32 v165, v30, v31
    v_cvt_pk_bf16_f32 v169, v146, v147
    v_cvt_pk_bf16_f32 v173, v154, v155
    v_cvt_pk_bf16_f32 v162, v48, v49
    v_cvt_pk_bf16_f32 v166, v52, v53
    v_cvt_pk_bf16_f32 v170, v148, v149
    v_cvt_pk_bf16_f32 v174, v156, v157
    v_cvt_pk_bf16_f32 v163, v50, v51
    v_cvt_pk_bf16_f32 v167, v54, v55
    v_cvt_pk_bf16_f32 v171, v150, v151
    v_cvt_pk_bf16_f32 v175, v158, v159
    v_cvt_pk_bf16_f32 v128, v32, v33
    v_cvt_pk_bf16_f32 v129, v34, v35
    v_cvt_pk_bf16_f32 v130, v56, v57
    v_cvt_pk_bf16_f32 v131, v58, v59
    v_cvt_pk_bf16_f32 v132, v36, v37
    v_cvt_pk_bf16_f32 v133, v38, v39
    v_cvt_pk_bf16_f32 v134, v60, v61
    v_cvt_pk_bf16_f32 v135, v62, v63
    s_nop 1
    v_mfma_f32_16x16x32_bf16 v[96:99], v[160:163], v[128:131], v[96:99]
    v_mfma_f32_16x16x32_bf16 v[100:103], v[160:163], v[132:135], v[100:103]
    v_mfma_f32_16x16x32_bf16 v[104:107], v[164:167], v[128:131], v[104:107]
    v_mfma_f32_16x16x32_bf16 v[108:111], v[164:167], v[132:135], v[108:111]
    v_mfma_f32_16x16x32_bf16 v[112:115], v[168:171], v[128:131], v[112:115]
    v_mfma_f32_16x16x32_bf16 v[116:119], v[168:171], v[132:135], v[116:119]
    v_mfma_f32_16x16x32_bf16 v[120:123], v[172:175], v[128:131], v[120:123]
    v_mfma_f32_16x16x32_bf16 v[124:127], v[172:175], v[132:135], v[124:127]
    s_add_u32 s28, s28, 1
    s_cmp_lt_u32 s28, 8
    s_cbranch_scc1 LH_135
    s_lshl_b32 s29, s27, 16
    s_add_u32 s29, s29, 53710848
    s_lshl_b32 s22, s18, 13
    s_add_u32 s22, s22, s29
    s_add_u32 s23, s22, 4096
    s_nop 7
    buffer_store_dwordx4 v[96:99], v1, s[4:7], s22 offen offset:0 sc1
    buffer_store_dwordx4 v[100:103], v1, s[4:7], s22 offen offset:1024 sc1
    buffer_store_dwordx4 v[104:107], v1, s[4:7], s22 offen offset:2048 sc1
    buffer_store_dwordx4 v[108:111], v1, s[4:7], s22 offen offset:3072 sc1
    buffer_store_dwordx4 v[112:115], v1, s[4:7], s23 offen offset:0 sc1
    buffer_store_dwordx4 v[116:119], v1, s[4:7], s23 offen offset:1024 sc1
    buffer_store_dwordx4 v[120:123], v1, s[4:7], s23 offen offset:2048 sc1
    buffer_store_dwordx4 v[124:127], v1, s[4:7], s23 offen offset:3072 sc1
    s_lshl_b32 s30, s17, 7
    s_add_u32 s30, s30, 54771712
    s_waitcnt vmcnt(0)
    s_barrier
    s_cmp_lg_u32 s16, 0
    s_cbranch_scc1 Lsg_136
    v_mov_b32 v12, 1
    v_mov_b32 v13, 0
    s_mov_b64 exec, 1
    buffer_atomic_add v12, v13, s[4:7], s30 offen
    s_mov_b64 exec, -1
Lsg_136:
    v_mov_b32 v13, 0
Lpc_137:
    buffer_load_dword v12, v13, s[4:7], s30 offen sc1
    s_sub_u32 s19, s19, 1
    s_cbranch_scc1 main_kernel_exit
    s_waitcnt vmcnt(0)
    v_cmp_le_u32 vcc, 8, v12
    s_sleep 8
    s_cbranch_vccz Lpc_137
    s_add_u32 s23, s29, 4096
    buffer_load_dwordx4 v[96:99], v1, s[4:7], s29 offen offset:0 sc1
    buffer_load_dwordx4 v[100:103], v1, s[4:7], s29 offen offset:1024 sc1
    buffer_load_dwordx4 v[104:107], v1, s[4:7], s29 offen offset:2048 sc1
    buffer_load_dwordx4 v[108:111], v1, s[4:7], s29 offen offset:3072 sc1
    buffer_load_dwordx4 v[112:115], v1, s[4:7], s23 offen offset:0 sc1
    buffer_load_dwordx4 v[116:119], v1, s[4:7], s23 offen offset:1024 sc1
    buffer_load_dwordx4 v[120:123], v1, s[4:7], s23 offen offset:2048 sc1
    buffer_load_dwordx4 v[124:127], v1, s[4:7], s23 offen offset:3072 sc1
    s_add_u32 s29, s29, 8192
    s_add_u32 s23, s29, 4096
    buffer_load_dwordx4 v[16:19], v1, s[4:7], s29 offen offset:0 sc1
    buffer_load_dwordx4 v[20:23], v1, s[4:7], s29 offen offset:1024 sc1
    buffer_load_dwordx4 v[24:27], v1, s[4:7], s29 offen offset:2048 sc1
    buffer_load_dwordx4 v[28:31], v1, s[4:7], s29 offen offset:3072 sc1
    buffer_load_dwordx4 v[32:35], v1, s[4:7], s23 offen offset:0 sc1
    buffer_load_dwordx4 v[36:39], v1, s[4:7], s23 offen offset:1024 sc1
    buffer_load_dwordx4 v[40:43], v1, s[4:7], s23 offen offset:2048 sc1
    buffer_load_dwordx4 v[44:47], v1, s[4:7], s23 offen offset:3072 sc1
    s_add_u32 s29, s29, 8192
    s_add_u32 s23, s29, 4096
    buffer_load_dwordx4 v[48:51], v1, s[4:7], s29 offen offset:0 sc1
    buffer_load_dwordx4 v[52:55], v1, s[4:7], s29 offen offset:1024 sc1
    buffer_load_dwordx4 v[56:59], v1, s[4:7], s29 offen offset:2048 sc1
    buffer_load_dwordx4 v[60:63], v1, s[4:7], s29 offen offset:3072 sc1
    buffer_load_dwordx4 v[64:67], v1, s[4:7], s23 offen offset:0 sc1
    buffer_load_dwordx4 v[68:71], v1, s[4:7], s23 offen offset:1024 sc1
    buffer_load_dwordx4 v[72:75], v1, s[4:7], s23 offen offset:2048 sc1
    buffer_load_dwordx4 v[76:79], v1, s[4:7], s23 offen offset:3072 sc1
    s_add_u32 s29, s29, 8192
    s_waitcnt vmcnt(8)
    v_add_f32 v96, v96, v16
    v_add_f32 v97, v97, v17
    v_add_f32 v98, v98, v18
    v_add_f32 v99, v99, v19
    v_add_f32 v100, v100, v20
    v_add_f32 v101, v101, v21
    v_add_f32 v102, v102, v22
    v_add_f32 v103, v103, v23
    v_add_f32 v104, v104, v24
    v_add_f32 v105, v105, v25
    v_add_f32 v106, v106, v26
    v_add_f32 v107, v107, v27
    v_add_f32 v108, v108, v28
    v_add_f32 v109, v109, v29
    v_add_f32 v110, v110, v30
    v_add_f32 v111, v111, v31
    v_add_f32 v112, v112, v32
    v_add_f32 v113, v113, v33
    v_add_f32 v114, v114, v34
    v_add_f32 v115, v115, v35
    v_add_f32 v116, v116, v36
    v_add_f32 v117, v117, v37
    v_add_f32 v118, v118, v38
    v_add_f32 v119, v119, v39
    v_add_f32 v120, v120, v40
    v_add_f32 v121, v121, v41
    v_add_f32 v122, v122, v42
    v_add_f32 v123, v123, v43
    v_add_f32 v124, v124, v44
    v_add_f32 v125, v125, v45
    v_add_f32 v126, v126, v46
    v_add_f32 v127, v127, v47
    s_add_u32 s23, s29, 4096
    buffer_load_dwordx4 v[16:19], v1, s[4:7], s29 offen offset:0 sc1
    buffer_load_dwordx4 v[20:23], v1, s[4:7], s29 offen offset:1024 sc1
    buffer_load_dwordx4 v[24:27], v1, s[4:7], s29 offen offset:2048 sc1
    buffer_load_dwordx4 v[28:31], v1, s[4:7], s29 offen offset:3072 sc1
    buffer_load_dwordx4 v[32:35], v1, s[4:7], s23 offen offset:0 sc1
    buffer_load_dwordx4 v[36:39], v1, s[4:7], s23 offen offset:1024 sc1
    buffer_load_dwordx4 v[40:43], v1, s[4:7], s23 offen offset:2048 sc1
    buffer_load_dwordx4 v[44:47], v1, s[4:7], s23 offen offset:3072 sc1
    s_add_u32 s29, s29, 8192
    s_waitcnt vmcnt(8)
    v_add_f32 v96, v96, v48
    v_add_f32 v97, v97, v49
    v_add_f32 v98, v98, v50
    v_add_f32 v99, v99, v51
    v_add_f32 v100, v100, v52
    v_add_f32 v101, v101, v53
    v_add_f32 v102, v102, v54
    v_add_f32 v103, v103, v55
    v_add_f32 v104, v104, v56
    v_add_f32 v105, v105, v57
    v_add_f32 v106, v106, v58
    v_add_f32 v107, v107, v59
    v_add_f32 v108, v108, v60
    v_add_f32 v109, v109, v61
    v_add_f32 v110, v110, v62
    v_add_f32 v111, v111, v63
    v_add_f32 v112, v112, v64
    v_add_f32 v113, v113, v65
    v_add_f32 v114, v114, v66
    v_add_f32 v115, v115, v67
    v_add_f32 v116, v116, v68
    v_add_f32 v117, v117, v69
    v_add_f32 v118, v118, v70
    v_add_f32 v119, v119, v71
    v_add_f32 v120, v120, v72
    v_add_f32 v121, v121, v73
    v_add_f32 v122, v122, v74
    v_add_f32 v123, v123, v75
    v_add_f32 v124, v124, v76
    v_add_f32 v125, v125, v77
    v_add_f32 v126, v126, v78
    v_add_f32 v127, v127, v79
    s_add_u32 s23, s29, 4096
    buffer_load_dwordx4 v[48:51], v1, s[4:7], s29 offen offset:0 sc1
    buffer_load_dwordx4 v[52:55], v1, s[4:7], s29 offen offset:1024 sc1
    buffer_load_dwordx4 v[56:59], v1, s[4:7], s29 offen offset:2048 sc1
    buffer_load_dwordx4 v[60:63], v1, s[4:7], s29 offen offset:3072 sc1
    buffer_load_dwordx4 v[64:67], v1, s[4:7], s23 offen offset:0 sc1
    buffer_load_dwordx4 v[68:71], v1, s[4:7], s23 offen offset:1024 sc1
    buffer_load_dwordx4 v[72:75], v1, s[4:7], s23 offen offset:2048 sc1
    buffer_load_dwordx4 v[76:79], v1, s[4:7], s23 offen offset:3072 sc1
    s_add_u32 s29, s29, 8192
    s_waitcnt vmcnt(8)
    v_add_f32 v96, v96, v16
    v_add_f32 v97, v97, v17
    v_add_f32 v98, v98, v18
    v_add_f32 v99, v99, v19
    v_add_f32 v100, v100, v20
    v_add_f32 v101, v101, v21
    v_add_f32 v102, v102, v22
    v_add_f32 v103, v103, v23
    v_add_f32 v104, v104, v24
    v_add_f32 v105, v105, v25
    v_add_f32 v106, v106, v26
    v_add_f32 v107, v107, v27
    v_add_f32 v108, v108, v28
    v_add_f32 v109, v109, v29
    v_add_f32 v110, v110, v30
    v_add_f32 v111, v111, v31
    v_add_f32 v112, v112, v32
    v_add_f32 v113, v113, v33
    v_add_f32 v114, v114, v34
    v_add_f32 v115, v115, v35
    v_add_f32 v116, v116, v36
    v_add_f32 v117, v117, v37
    v_add_f32 v118, v118, v38
    v_add_f32 v119, v119, v39
    v_add_f32 v120, v120, v40
    v_add_f32 v121, v121, v41
    v_add_f32 v122, v122, v42
    v_add_f32 v123, v123, v43
    v_add_f32 v124, v124, v44
    v_add_f32 v125, v125, v45
    v_add_f32 v126, v126, v46
    v_add_f32 v127, v127, v47
    s_add_u32 s23, s29, 4096
    buffer_load_dwordx4 v[16:19], v1, s[4:7], s29 offen offset:0 sc1
    buffer_load_dwordx4 v[20:23], v1, s[4:7], s29 offen offset:1024 sc1
    buffer_load_dwordx4 v[24:27], v1, s[4:7], s29 offen offset:2048 sc1
    buffer_load_dwordx4 v[28:31], v1, s[4:7], s29 offen offset:3072 sc1
    buffer_load_dwordx4 v[32:35], v1, s[4:7], s23 offen offset:0 sc1
    buffer_load_dwordx4 v[36:39], v1, s[4:7], s23 offen offset:1024 sc1
    buffer_load_dwordx4 v[40:43], v1, s[4:7], s23 offen offset:2048 sc1
    buffer_load_dwordx4 v[44:47], v1, s[4:7], s23 offen offset:3072 sc1
    s_add_u32 s29, s29, 8192
    s_waitcnt vmcnt(8)
    v_add_f32 v96, v96, v48
    v_add_f32 v97, v97, v49
    v_add_f32 v98, v98, v50
    v_add_f32 v99, v99, v51
    v_add_f32 v100, v100, v52
    v_add_f32 v101, v101, v53
    v_add_f32 v102, v102, v54
    v_add_f32 v103, v103, v55
    v_add_f32 v104, v104, v56
    v_add_f32 v105, v105, v57
    v_add_f32 v106, v106, v58
    v_add_f32 v107, v107, v59
    v_add_f32 v108, v108, v60
    v_add_f32 v109, v109, v61
    v_add_f32 v110, v110, v62
    v_add_f32 v111, v111, v63
    v_add_f32 v112, v112, v64
    v_add_f32 v113, v113, v65
    v_add_f32 v114, v114, v66
    v_add_f32 v115, v115, v67
    v_add_f32 v116, v116, v68
    v_add_f32 v117, v117, v69
    v_add_f32 v118, v118, v70
    v_add_f32 v119, v119, v71
    v_add_f32 v120, v120, v72
    v_add_f32 v121, v121, v73
    v_add_f32 v122, v122, v74
    v_add_f32 v123, v123, v75
    v_add_f32 v124, v124, v76
    v_add_f32 v125, v125, v77
    v_add_f32 v126, v126, v78
    v_add_f32 v127, v127, v79
    s_add_u32 s23, s29, 4096
    buffer_load_dwordx4 v[48:51], v1, s[4:7], s29 offen offset:0 sc1
    buffer_load_dwordx4 v[52:55], v1, s[4:7], s29 offen offset:1024 sc1
    buffer_load_dwordx4 v[56:59], v1, s[4:7], s29 offen offset:2048 sc1
    buffer_load_dwordx4 v[60:63], v1, s[4:7], s29 offen offset:3072 sc1
    buffer_load_dwordx4 v[64:67], v1, s[4:7], s23 offen offset:0 sc1
    buffer_load_dwordx4 v[68:71], v1, s[4:7], s23 offen offset:1024 sc1
    buffer_load_dwordx4 v[72:75], v1, s[4:7], s23 offen offset:2048 sc1
    buffer_load_dwordx4 v[76:79], v1, s[4:7], s23 offen offset:3072 sc1
    s_add_u32 s29, s29, 8192
    s_waitcnt vmcnt(8)
    v_add_f32 v96, v96, v16
    v_add_f32 v97, v97, v17
    v_add_f32 v98, v98, v18
    v_add_f32 v99, v99, v19
    v_add_f32 v100, v100, v20
    v_add_f32 v101, v101, v21
    v_add_f32 v102, v102, v22
    v_add_f32 v103, v103, v23
    v_add_f32 v104, v104, v24
    v_add_f32 v105, v105, v25
    v_add_f32 v106, v106, v26
    v_add_f32 v107, v107, v27
    v_add_f32 v108, v108, v28
    v_add_f32 v109, v109, v29
    v_add_f32 v110, v110, v30
    v_add_f32 v111, v111, v31
    v_add_f32 v112, v112, v32
    v_add_f32 v113, v113, v33
    v_add_f32 v114, v114, v34
    v_add_f32 v115, v115, v35
    v_add_f32 v116, v116, v36
    v_add_f32 v117, v117, v37
    v_add_f32 v118, v118, v38
    v_add_f32 v119, v119, v39
    v_add_f32 v120, v120, v40
    v_add_f32 v121, v121, v41
    v_add_f32 v122, v122, v42
    v_add_f32 v123, v123, v43
    v_add_f32 v124, v124, v44
    v_add_f32 v125, v125, v45
    v_add_f32 v126, v126, v46
    v_add_f32 v127, v127, v47
    s_add_u32 s23, s29, 4096
    buffer_load_dwordx4 v[16:19], v1, s[4:7], s29 offen offset:0 sc1
    buffer_load_dwordx4 v[20:23], v1, s[4:7], s29 offen offset:1024 sc1
    buffer_load_dwordx4 v[24:27], v1, s[4:7], s29 offen offset:2048 sc1
    buffer_load_dwordx4 v[28:31], v1, s[4:7], s29 offen offset:3072 sc1
    buffer_load_dwordx4 v[32:35], v1, s[4:7], s23 offen offset:0 sc1
    buffer_load_dwordx4 v[36:39], v1, s[4:7], s23 offen offset:1024 sc1
    buffer_load_dwordx4 v[40:43], v1, s[4:7], s23 offen offset:2048 sc1
    buffer_load_dwordx4 v[44:47], v1, s[4:7], s23 offen offset:3072 sc1
    s_add_u32 s29, s29, 8192
    s_waitcnt vmcnt(8)
    v_add_f32 v96, v96, v48
    v_add_f32 v97, v97, v49
    v_add_f32 v98, v98, v50
    v_add_f32 v99, v99, v51
    v_add_f32 v100, v100, v52
    v_add_f32 v101, v101, v53
    v_add_f32 v102, v102, v54
    v_add_f32 v103, v103, v55
    v_add_f32 v104, v104, v56
    v_add_f32 v105, v105, v57
    v_add_f32 v106, v106, v58
    v_add_f32 v107, v107, v59
    v_add_f32 v108, v108, v60
    v_add_f32 v109, v109, v61
    v_add_f32 v110, v110, v62
    v_add_f32 v111, v111, v63
    v_add_f32 v112, v112, v64
    v_add_f32 v113, v113, v65
    v_add_f32 v114, v114, v66
    v_add_f32 v115, v115, v67
    v_add_f32 v116, v116, v68
    v_add_f32 v117, v117, v69
    v_add_f32 v118, v118, v70
    v_add_f32 v119, v119, v71
    v_add_f32 v120, v120, v72
    v_add_f32 v121, v121, v73
    v_add_f32 v122, v122, v74
    v_add_f32 v123, v123, v75
    v_add_f32 v124, v124, v76
    v_add_f32 v125, v125, v77
    v_add_f32 v126, v126, v78
    v_add_f32 v127, v127, v79
    s_waitcnt vmcnt(0)
    v_add_f32 v96, v96, v16
    v_add_f32 v97, v97, v17
    v_add_f32 v98, v98, v18
    v_add_f32 v99, v99, v19
    v_add_f32 v100, v100, v20
    v_add_f32 v101, v101, v21
    v_add_f32 v102, v102, v22
    v_add_f32 v103, v103, v23
    v_add_f32 v104, v104, v24
    v_add_f32 v105, v105, v25
    v_add_f32 v106, v106, v26
    v_add_f32 v107, v107, v27
    v_add_f32 v108, v108, v28
    v_add_f32 v109, v109, v29
    v_add_f32 v110, v110, v30
    v_add_f32 v111, v111, v31
    v_add_f32 v112, v112, v32
    v_add_f32 v113, v113, v33
    v_add_f32 v114, v114, v34
    v_add_f32 v115, v115, v35
    v_add_f32 v116, v116, v36
    v_add_f32 v117, v117, v37
    v_add_f32 v118, v118, v38
    v_add_f32 v119, v119, v39
    v_add_f32 v120, v120, v40
    v_add_f32 v121, v121, v41
    v_add_f32 v122, v122, v42
    v_add_f32 v123, v123, v43
    v_add_f32 v124, v124, v44
    v_add_f32 v125, v125, v45
    v_add_f32 v126, v126, v46
    v_add_f32 v127, v127, v47
    v_cvt_pk_bf16_f32 v128, v96, v97
    v_cvt_pk_bf16_f32 v129, v98, v99
    v_cvt_pk_bf16_f32 v130, v104, v105
    v_cvt_pk_bf16_f32 v131, v106, v107
    v_cvt_pk_bf16_f32 v132, v100, v101
    v_cvt_pk_bf16_f32 v133, v102, v103
    v_cvt_pk_bf16_f32 v134, v108, v109
    v_cvt_pk_bf16_f32 v135, v110, v111
    v_cvt_pk_bf16_f32 v136, v112, v113
    v_cvt_pk_bf16_f32 v137, v114, v115
    v_cvt_pk_bf16_f32 v138, v120, v121
    v_cvt_pk_bf16_f32 v139, v122, v123
    v_cvt_pk_bf16_f32 v140, v116, v117
    v_cvt_pk_bf16_f32 v141, v118, v119
    v_cvt_pk_bf16_f32 v142, v124, v125
    v_cvt_pk_bf16_f32 v143, v126, v127
    s_lshl_b32 s26, s16, 15
    v_add_u32 v5, s26, v1
    v_add_u32 v7, 48, v3
    v_lshlrev_b32 v7, 2, v7
    s_lshl_b32 s22, s18, 18
    s_lshl_b32 s23, s27, 11
    s_add_u32 s22, s22, s23
    s_add_u32 s22, s22, 51613696
    s_lshl_b32 s23, s18, 10
    s_add_u32 s23, s23, 54759424
    s_mov_b32 s28, 0
LH_138:
    ds_read_b128 v[16:19], v5 offset:0
    ds_read_b128 v[20:23], v5 offset:1024
    ds_read_b128 v[24:27], v5 offset:2048
    ds_read_b128 v[28:31], v5 offset:3072
    buffer_load_dword v48, v6, s[4:7], s23 offen offset:0
    buffer_load_dword v49, v6, s[4:7], s23 offen offset:64
    s_waitcnt lgkmcnt(0)
    v_mfma_f32_16x16x32_bf16 v[32:35], v[128:131], v[16:19], 0
    v_mfma_f32_16x16x32_bf16 v[36:39], v[132:135], v[16:19], 0
    v_mfma_f32_16x16x32_bf16 v[40:43], v[128:131], v[24:27], 0
    v_mfma_f32_16x16x32_bf16 v[44:47], v[132:135], v[24:27], 0
    v_mfma_f32_16x16x32_bf16 v[32:35], v[136:139], v[20:23], v[32:35]
    v_mfma_f32_16x16x32_bf16 v[36:39], v[140:143], v[20:23], v[36:39]
    v_mfma_f32_16x16x32_bf16 v[40:43], v[136:139], v[28:31], v[40:43]
    v_mfma_f32_16x16x32_bf16 v[44:47], v[140:143], v[28:31], v[44:47]
    s_nop 7
    ds_bpermute_b32 v50, v7, v36
    ds_bpermute_b32 v51, v7, v44
    s_waitcnt vmcnt(0) lgkmcnt(0)
    v_add_f32 v50, 0x358637bd, v50
    v_rcp_f32 v50, v50
    v_add_f32 v51, 0x358637bd, v51
    v_rcp_f32 v51, v51
    s_nop 0
    v_mul_f32 v50, v50, v48
    v_mul_f32 v32, v32, v50
    v_mul_f32 v33, v33, v50
    v_mul_f32 v34, v34, v50
    v_mul_f32 v35, v35, v50
    v_mul_f32 v36, v36, v50
    v_mul_f32 v37, v37, v50
    v_mul_f32 v38, v38, v50
    v_mul_f32 v39, v39, v50
    v_cvt_pk_bf16_f32 v56, v32, v33
    v_cvt_pk_bf16_f32 v57, v34, v35
    v_cvt_pk_bf16_f32 v58, v36, v37
    v_cvt_pk_bf16_f32 v59, v38, v39
    v_cndmask_b32 v58, 0, v58, s[48:49]
    v_cndmask_b32 v59, 0, v59, s[48:49]
    buffer_store_dwordx4 v[56:59], v1, s[4:7], s22 offen offset:0 sc1
    v_mul_f32 v51, v51, v49
    v_mul_f32 v40, v40, v51
    v_mul_f32 v41, v41, v51
    v_mul_f32 v42, v42, v51
    v_mul_f32 v43, v43, v51
    v_mul_f32 v44, v44, v51
    v_mul_f32 v45, v45, v51
    v_mul_f32 v46, v46, v51
    v_mul_f32 v47, v47, v51
    v_cvt_pk_bf16_f32 v60, v40, v41
    v_cvt_pk_bf16_f32 v61, v42, v43
    v_cvt_pk_bf16_f32 v62, v44, v45
    v_cvt_pk_bf16_f32 v63, v46, v47
    v_cndmask_b32 v62, 0, v62, s[48:49]
    v_cndmask_b32 v63, 0, v63, s[48:49]
    buffer_store_dwordx4 v[60:63], v1, s[4:7], s22 offen offset:1024 sc1
    v_add_u32 v5, 4096, v5
    s_add_u32 s22, s22, 32768
    s_add_u32 s23, s23, 128
    s_add_u32 s28, s28, 1
    s_cmp_lt_u32 s28, 8
    s_cbranch_scc1 LH_138
    s_lshl_b32 s30, s18, 7
    s_add_u32 s30, s30, 54772736
    s_waitcnt vmcnt(0)
    s_barrier
    s_cmp_lg_u32 s16, 0
    s_cbranch_scc1 Lsg_139
    v_mov_b32 v12, 1
    v_mov_b32 v13, 0
    s_mov_b64 exec, 1
    buffer_atomic_add v12, v13, s[4:7], s30 offen
    s_mov_b64 exec, -1
Lsg_139:
    s_branch main_kernel_exit
main_kernel_exit:
main_kernel_end:
    s_endpgm
.section .rodata,"a"
.p2align 6
.amdhsa_kernel prep_kernel
  .amdhsa_next_free_vgpr 256
  .amdhsa_next_free_sgpr 80
  .amdhsa_accum_offset 256
  .amdhsa_group_segment_fixed_size 0
  .amdhsa_kernarg_size 120
  .amdhsa_user_sgpr_count 2
  .amdhsa_user_sgpr_kernarg_segment_ptr 1
  .amdhsa_system_sgpr_workgroup_id_x 1
  .amdhsa_float_denorm_mode_32 3
  .amdhsa_float_denorm_mode_16_64 3
.end_amdhsa_kernel

.p2align 6
.amdhsa_kernel main_kernel
  .amdhsa_next_free_vgpr 512
  .amdhsa_next_free_sgpr 96
  .amdhsa_accum_offset 256
  .amdhsa_group_segment_fixed_size 0
  .amdhsa_kernarg_size 120
  .amdhsa_user_sgpr_count 2
  .amdhsa_user_sgpr_kernarg_segment_ptr 1
  .amdhsa_system_sgpr_workgroup_id_x 1
  .amdhsa_float_denorm_mode_32 3
  .amdhsa_float_denorm_mode_16_64 3
.end_amdhsa_kernel
```
